```python
import torch

def _softmax(x, axis=-1):
    return torch.softmax(x, dim=axis)

def _gelu(x):
    return torch.nn.functional.gelu(x, approximate='tanh')

def _silu(x):
    return torch.nn.functional.silu(x)

def _sigmoid(x):
    return torch.sigmoid(x)

def _layernorm(x, axis=-1, eps=1e-05):
    m = x.mean(dim=axis, keepdim=True)
    v = x.var(dim=axis, keepdim=True, unbiased=False)
    return (x - m) / torch.sqrt(v + eps)

def _scatter_add(tgt, idx, src, axis=0):
    return tgt.clone().index_add_(axis, idx, src)

def _segment_sum(src, seg, n):
    out = torch.zeros((n,) + src.shape[1:], dtype=src.dtype)
    return out.index_add_(0, seg, src)

def _pad(x, pw):
    flat = tuple((v for pair in reversed(pw) for v in pair))
    return torch.nn.functional.pad(x, flat)
kernel_name = 'adaLN_cond__ssm_conv_s4__glu_gated_swiglu__prompt'

def setup_inputs():

    _w = lambda a: (lambda t: t.to(torch.bfloat16) if t.is_floating_point() else t)(torch.as_tensor(a))

    def _A_setup():
        B, L, D, N = (1, 2048, 576, 128)
        A_re = -(lambda _x: torch.exp(torch.as_tensor(_x)))((lambda *s: torch.randn(*s, dtype=torch.bfloat16) * 3.2)(D, N))
        A_im = torch.pi * (lambda *s: torch.randn(*s, dtype=torch.bfloat16) * 0.1)(D, N)
        B_re = (lambda *s: torch.randn(*s, dtype=torch.bfloat16) * 0.1)(D, N)
        B_im = (lambda *s: torch.randn(*s, dtype=torch.bfloat16) * 0.1)(D, N)
        C_re = (lambda *s: torch.randn(*s, dtype=torch.bfloat16) * 0.1)(D, N)
        C_im = (lambda *s: torch.randn(*s, dtype=torch.bfloat16) * 0.1)(D, N)
        log_dt = (lambda *s: torch.randn(*s, dtype=torch.bfloat16) * 0.1)(D) * 0.5 - 4.0
        Dskip = (lambda *s: torch.randn(*s, dtype=torch.bfloat16) * 0.1)(D)
        return {'u': _w((lambda *s: torch.randn(*s, dtype=torch.bfloat16) * 0.05)(B, L, D)), 'A_re': _w(A_re), 'A_im': _w(A_im), 'B_re': _w(B_re), 'B_im': _w(B_im), 'C_re': _w(C_re), 'C_im': _w(C_im), 'log_dt': _w(log_dt), 'Dskip': _w(Dskip)}
    _A_in = _A_setup()

    def _B_setup():
        B, S, D, F = (1, 2048, 576, 4608)
        return {'x': _w((lambda *s: torch.randn(*s, dtype=torch.bfloat16) * 0.05)(B, S, D)), 'w1': _w((lambda *s: torch.randn(*s, dtype=torch.bfloat16) * 1.6)(D, F) * (2.0 / D) ** 0.5), 'w3': _w((lambda *s: torch.randn(*s, dtype=torch.bfloat16) * 1.6)(D, F) * (2.0 / D) ** 0.5), 'w2': _w((lambda *s: torch.randn(*s, dtype=torch.bfloat16) * 1.6)(F, D) * (2.0 / F) ** 0.5)}
    _B_in = _B_setup()
    return {'A_u': _A_in['u'], 'A_A_re': _A_in['A_re'], 'A_A_im': _A_in['A_im'], 'A_B_re': _A_in['B_re'], 'A_B_im': _A_in['B_im'], 'A_C_re': _A_in['C_re'], 'A_C_im': _A_in['C_im'], 'A_log_dt': _A_in['log_dt'], 'A_Dskip': _A_in['Dskip'], 'B_x': _B_in['x'], 'B_w1': _B_in['w1'], 'B_w3': _B_in['w3'], 'B_w2': _B_in['w2'], 'c': _w((lambda *s: torch.randn(*s, dtype=torch.bfloat16) * 0.4)(1, 576) * 8.0), 'w_mod': _w((lambda *s: torch.randn(*s, dtype=torch.bfloat16) * 0.4)(576, 6 * 576) * 576 ** (-0.5) * 8.0)}

def reference(A_u, A_A_re, A_A_im, A_B_re, A_B_im, A_C_re, A_C_im, A_log_dt, A_Dskip, B_x, B_w1, B_w3, B_w2, c, w_mod):

    def _A_ref(u, A_re, A_im, B_re, B_im, C_re, C_im, log_dt, Dskip):
        Bsz, L, D = u.shape
        dt = torch.exp(log_dt)[:, None]
        A = A_re + 1j * A_im
        Bc = B_re + 1j * B_im
        Cc = C_re + 1j * C_im
        logdA = dt * A
        dB = dt * Bc
        l = (lambda x, dt: x.to(dt))(torch.arange(L), A_re.dtype)
        P = torch.exp(logdA[:, :, None] * l[None, None, :])
        K = torch.einsum('dn,dnl,dn->dl', Cc, P, dB).real
        L2 = 2 * L
        Kp = _pad(K, ((0, 0), (0, L)))
        up = (lambda x, *d: x.permute(*d))(u, 0, 2, 1)
        up = _pad(up, ((0, 0), (0, 0), (0, L)))
        Kf = (lambda x, axes=(-2, -1): torch.fft.rfft2(x.float(), dim=axes))(Kp[:, None, :], axes=(-2, -1))
        Uf = (lambda x, axes=(-2, -1): torch.fft.rfft2(x.float(), dim=axes))(up[:, :, None, :], axes=(-2, -1))
        Yf = Uf * Kf[None, :, :, :]
        y = (lambda x, s, axes=(-2, -1): torch.fft.irfft2(x, s=s, dim=axes).to(torch.bfloat16))(Yf, (1, L2), axes=(-2, -1))[:, :, 0, :L]
        y = (lambda x, *d: x.permute(*d))(y, 0, 2, 1) + u * Dskip[None, None, :]
        return y

    def _B_ref(x, w1, w3, w2):
        gate = torch.einsum('bsd,df->bsf', x, w1)
        up = torch.einsum('bsd,df->bsf', x, w3)
        h = _silu(gate) * up
        out = torch.einsum('bsf,fd->bsd', h, w2)
        return out
    x = A_u
    mod = (_silu(c) @ w_mod).reshape(c.shape[0], 6, 1, -1)
    sa, ca, ga, sb, cb, gb = (mod[:, 0].clone(), mod[:, 1].clone(), mod[:, 2].clone(), mod[:, 3].clone(), mod[:, 4].clone(), mod[:, 5].clone())
    h = _layernorm(x, axis=-1) * (1 + ca) + sa
    x = x + ga * _A_ref(h, A_A_re, A_A_im, A_B_re, A_B_im, A_C_re, A_C_im, A_log_dt, A_Dskip)
    h = _layernorm(x, axis=-1) * (1 + cb) + sb
    x = x + gb * _B_ref(h, B_w1, B_w3, B_w2)
    return x
```

```asm
; @launch kernel=p1_kernel grid=(460,1,1) block=(256,1,1) lds=79872
; @launch kernel=p2_kernel grid=(256,1,1) block=(384,1,1) lds=100608
; @launch kernel=gg_kernel grid=(256,1,1) block=(512,1,1) lds=147456
.amdgcn_target "amdgcn-amd-amdhsa--gfx950"
.text
.globl p1_kernel
.p2align 8
.type p1_kernel,@function
p1_kernel:
    s_cmp_ge_u32 s2, 460
    s_cbranch_scc1 P1_END
    s_cmp_ge_u32 s2, 144
    s_cbranch_scc1 P1_NOT_KG
    s_load_dwordx2 s[8:9], s[0:1], 8
    s_load_dwordx2 s[12:13], s[0:1], 16
    s_load_dwordx2 s[16:17], s[0:1], 24
    s_load_dwordx2 s[20:21], s[0:1], 32
    s_load_dwordx2 s[24:25], s[0:1], 40
    s_load_dwordx2 s[28:29], s[0:1], 48
    s_load_dwordx2 s[32:33], s[0:1], 56
    s_load_dwordx2 s[36:37], s[0:1], 136
    v_lshrrev_b32 v1, 6, v0
    s_nop 0
    v_readfirstlane_b32 s4, v1
    v_and_b32 v1, 63, v0
    s_lshl_b32 s5, s2, 2
    s_add_u32 s5, s5, s4
    s_lshl_b32 s6, s5, 8
    v_lshlrev_b32 v2, 2, v1
    v_add_u32 v2, s6, v2
    s_lshl_b32 s6, s5, 1
    v_mov_b32 v3, s6
    s_mul_i32 s7, s4, 19968
    s_waitcnt lgkmcnt(0)
    s_mov_b32 s10, 0x24000
    s_mov_b32 s11, 0x00020000
    s_mov_b32 s14, 0x24000
    s_mov_b32 s15, 0x00020000
    s_mov_b32 s18, 0x24000
    s_mov_b32 s19, 0x00020000
    s_mov_b32 s22, 0x24000
    s_mov_b32 s23, 0x00020000
    s_mov_b32 s26, 0x24000
    s_mov_b32 s27, 0x00020000
    s_mov_b32 s30, 0x24000
    s_mov_b32 s31, 0x00020000
    s_mov_b32 s34, 0x480
    s_mov_b32 s35, 0x00020000
    s_add_u32 s36, s36, 0x400000
    s_addc_u32 s37, s37, 0
    s_mov_b32 s38, 0x244800
    s_mov_b32 s39, 0x00020000
    buffer_load_ushort v4, v3, s[32:35], 0 offen
    buffer_load_dword v10, v2, s[8:11], 0 offen
    buffer_load_dword v11, v2, s[12:15], 0 offen
    buffer_load_dword v12, v2, s[16:19], 0 offen
    buffer_load_dword v13, v2, s[20:23], 0 offen
    buffer_load_dword v14, v2, s[24:27], 0 offen
    buffer_load_dword v15, v2, s[28:31], 0 offen
    v_lshlrev_b32 v5, 3, v1
    v_add_u32 v5, s7, v5
    v_and_b32 v6, 15, v1
    v_lshrrev_b32 v7, 4, v1
    v_mul_u32_u24 v8, 528, v6
    v_lshlrev_b32 v9, 4, v7
    v_add_u32 v8, v8, v9
    v_add_u32 v8, s7, v8
    s_waitcnt vmcnt(6)
    v_lshlrev_b32 v4, 16, v4
    v_mul_f32 v4, 0x3fb8aa3b, v4
    v_exp_f32 v4, v4
    s_nop 0
    v_cvt_pk_bf16_f32 v4, v4, v4
    v_lshlrev_b32 v4, 16, v4
    s_waitcnt vmcnt(0)
    v_lshlrev_b32 v80, 16, v10
    v_lshlrev_b32 v81, 16, v11
    v_lshlrev_b32 v82, 16, v12
    v_lshlrev_b32 v83, 16, v13
    v_lshlrev_b32 v84, 16, v14
    v_lshlrev_b32 v85, 16, v15
    v_and_b32 v86, 0xffff0000, v10
    v_and_b32 v87, 0xffff0000, v11
    v_and_b32 v88, 0xffff0000, v12
    v_and_b32 v89, 0xffff0000, v13
    v_and_b32 v90, 0xffff0000, v14
    v_and_b32 v91, 0xffff0000, v15
    v_mul_f32 v80, v4, v80
    v_mul_f32 v81, v4, v81
    v_mul_f32 v82, v4, v82
    v_mul_f32 v83, v4, v83
    v_mul_f32 v80, 0x3fb8aa3b, v80
    v_mul_f32 v81, 0x3e22f983, v81
    v_exp_f32 v80, v80
    v_fract_f32 v81, v81
    v_cos_f32 v20, v81
    v_sin_f32 v22, v81
    s_nop 0
    v_mul_f32 v20, v80, v20
    v_mul_f32 v22, v80, v22
    v_mul_f32 v86, v4, v86
    v_mul_f32 v87, v4, v87
    v_mul_f32 v88, v4, v88
    v_mul_f32 v89, v4, v89
    v_mul_f32 v86, 0x3fb8aa3b, v86
    v_mul_f32 v87, 0x3e22f983, v87
    v_exp_f32 v86, v86
    v_fract_f32 v87, v87
    v_cos_f32 v21, v87
    v_sin_f32 v23, v87
    s_nop 0
    v_mul_f32 v21, v86, v21
    v_mul_f32 v23, v86, v23
    v_mul_f32 v60, v85, v83
    v_mul_f32 v62, v85, v82
    v_fma_f32 v56, v84, v82, -v60
    v_fma_f32 v58, v84, v83, v62
    v_mul_f32 v60, v91, v89
    v_mul_f32 v62, v91, v88
    v_fma_f32 v57, v90, v88, -v60
    v_fma_f32 v59, v90, v89, v62
    v_pk_mul_f32 v[60:61], v[22:23], v[22:23]
    v_pk_mul_f32 v[62:63], v[22:23], v[20:21]
    v_pk_fma_f32 v[24:25], v[20:21], v[20:21], v[60:61] neg_lo:[0,0,1] neg_hi:[0,0,1]
    v_pk_fma_f32 v[26:27], v[20:21], v[22:23], v[62:63]
    v_pk_mul_f32 v[60:61], v[26:27], v[26:27]
    v_pk_mul_f32 v[62:63], v[26:27], v[24:25]
    v_pk_fma_f32 v[28:29], v[24:25], v[24:25], v[60:61] neg_lo:[0,0,1] neg_hi:[0,0,1]
    v_pk_fma_f32 v[30:31], v[24:25], v[26:27], v[62:63]
    v_pk_mul_f32 v[60:61], v[30:31], v[30:31]
    v_pk_mul_f32 v[62:63], v[30:31], v[28:29]
    v_pk_fma_f32 v[32:33], v[28:29], v[28:29], v[60:61] neg_lo:[0,0,1] neg_hi:[0,0,1]
    v_pk_fma_f32 v[34:35], v[28:29], v[30:31], v[62:63]
    v_pk_mul_f32 v[60:61], v[34:35], v[34:35]
    v_pk_mul_f32 v[62:63], v[34:35], v[32:33]
    v_pk_fma_f32 v[64:65], v[32:33], v[32:33], v[60:61] neg_lo:[0,0,1] neg_hi:[0,0,1]
    v_pk_fma_f32 v[66:67], v[32:33], v[34:35], v[62:63]
    v_pk_mul_f32 v[60:61], v[66:67], v[66:67]
    v_pk_mul_f32 v[62:63], v[66:67], v[64:65]
    v_pk_fma_f32 v[68:69], v[64:65], v[64:65], v[60:61] neg_lo:[0,0,1] neg_hi:[0,0,1]
    v_pk_fma_f32 v[70:71], v[64:65], v[66:67], v[62:63]
    v_pk_mul_f32 v[60:61], v[70:71], v[70:71]
    v_pk_mul_f32 v[62:63], v[70:71], v[68:69]
    v_pk_fma_f32 v[64:65], v[68:69], v[68:69], v[60:61] neg_lo:[0,0,1] neg_hi:[0,0,1]
    v_pk_fma_f32 v[66:67], v[68:69], v[70:71], v[62:63]
    v_pk_mul_f32 v[60:61], v[66:67], v[66:67]
    v_pk_mul_f32 v[62:63], v[66:67], v[64:65]
    v_pk_fma_f32 v[36:37], v[64:65], v[64:65], v[60:61] neg_lo:[0,0,1] neg_hi:[0,0,1]
    v_pk_fma_f32 v[38:39], v[64:65], v[66:67], v[62:63]
    v_pk_mul_f32 v[60:61], v[38:39], v[38:39]
    v_pk_mul_f32 v[62:63], v[38:39], v[36:37]
    v_pk_fma_f32 v[40:41], v[36:37], v[36:37], v[60:61] neg_lo:[0,0,1] neg_hi:[0,0,1]
    v_pk_fma_f32 v[42:43], v[36:37], v[38:39], v[62:63]
    v_pk_mul_f32 v[60:61], v[42:43], v[42:43]
    v_pk_mul_f32 v[62:63], v[42:43], v[40:41]
    v_pk_fma_f32 v[44:45], v[40:41], v[40:41], v[60:61] neg_lo:[0,0,1] neg_hi:[0,0,1]
    v_pk_fma_f32 v[46:47], v[40:41], v[42:43], v[62:63]
    v_pk_mul_f32 v[60:61], v[46:47], v[46:47]
    v_pk_mul_f32 v[62:63], v[46:47], v[44:45]
    v_pk_fma_f32 v[48:49], v[44:45], v[44:45], v[60:61] neg_lo:[0,0,1] neg_hi:[0,0,1]
    v_pk_fma_f32 v[50:51], v[44:45], v[46:47], v[62:63]
    v_pk_mul_f32 v[60:61], v[50:51], v[50:51]
    v_pk_mul_f32 v[62:63], v[50:51], v[48:49]
    v_pk_fma_f32 v[52:53], v[48:49], v[48:49], v[60:61] neg_lo:[0,0,1] neg_hi:[0,0,1]
    v_pk_fma_f32 v[54:55], v[48:49], v[50:51], v[62:63]
    v_cvt_pk_bf16_f32 v92, v56, v58
    v_cvt_pk_bf16_f32 v93, v57, v59
    ds_write_b64 v5, v[92:93] offset:0
    v_pk_mul_f32 v[60:61], v[58:59], v[34:35]
    v_pk_mul_f32 v[62:63], v[58:59], v[32:33]
    v_pk_fma_f32 v[64:65], v[56:57], v[32:33], v[60:61] neg_lo:[0,0,1] neg_hi:[0,0,1]
    v_pk_fma_f32 v[66:67], v[56:57], v[34:35], v[62:63]
    v_cvt_pk_bf16_f32 v94, v64, v66
    v_cvt_pk_bf16_f32 v95, v65, v67
    ds_write_b64 v5, v[94:95] offset:528
    v_pk_mul_f32 v[60:61], v[66:67], v[34:35]
    v_pk_mul_f32 v[62:63], v[66:67], v[32:33]
    v_pk_fma_f32 v[68:69], v[64:65], v[32:33], v[60:61] neg_lo:[0,0,1] neg_hi:[0,0,1]
    v_pk_fma_f32 v[70:71], v[64:65], v[34:35], v[62:63]
    v_cvt_pk_bf16_f32 v96, v68, v70
    v_cvt_pk_bf16_f32 v97, v69, v71
    ds_write_b64 v5, v[96:97] offset:1056
    v_pk_mul_f32 v[60:61], v[70:71], v[34:35]
    v_pk_mul_f32 v[62:63], v[70:71], v[32:33]
    v_pk_fma_f32 v[64:65], v[68:69], v[32:33], v[60:61] neg_lo:[0,0,1] neg_hi:[0,0,1]
    v_pk_fma_f32 v[66:67], v[68:69], v[34:35], v[62:63]
    v_cvt_pk_bf16_f32 v98, v64, v66
    v_cvt_pk_bf16_f32 v99, v65, v67
    ds_write_b64 v5, v[98:99] offset:1584
    v_pk_mul_f32 v[60:61], v[66:67], v[34:35]
    v_pk_mul_f32 v[62:63], v[66:67], v[32:33]
    v_pk_fma_f32 v[68:69], v[64:65], v[32:33], v[60:61] neg_lo:[0,0,1] neg_hi:[0,0,1]
    v_pk_fma_f32 v[70:71], v[64:65], v[34:35], v[62:63]
    v_cvt_pk_bf16_f32 v92, v68, v70
    v_cvt_pk_bf16_f32 v93, v69, v71
    ds_write_b64 v5, v[92:93] offset:2112
    v_pk_mul_f32 v[60:61], v[70:71], v[34:35]
    v_pk_mul_f32 v[62:63], v[70:71], v[32:33]
    v_pk_fma_f32 v[64:65], v[68:69], v[32:33], v[60:61] neg_lo:[0,0,1] neg_hi:[0,0,1]
    v_pk_fma_f32 v[66:67], v[68:69], v[34:35], v[62:63]
    v_cvt_pk_bf16_f32 v94, v64, v66
    v_cvt_pk_bf16_f32 v95, v65, v67
    ds_write_b64 v5, v[94:95] offset:2640
    v_pk_mul_f32 v[60:61], v[66:67], v[34:35]
    v_pk_mul_f32 v[62:63], v[66:67], v[32:33]
    v_pk_fma_f32 v[68:69], v[64:65], v[32:33], v[60:61] neg_lo:[0,0,1] neg_hi:[0,0,1]
    v_pk_fma_f32 v[70:71], v[64:65], v[34:35], v[62:63]
    v_cvt_pk_bf16_f32 v96, v68, v70
    v_cvt_pk_bf16_f32 v97, v69, v71
    ds_write_b64 v5, v[96:97] offset:3168
    v_pk_mul_f32 v[60:61], v[70:71], v[34:35]
    v_pk_mul_f32 v[62:63], v[70:71], v[32:33]
    v_pk_fma_f32 v[64:65], v[68:69], v[32:33], v[60:61] neg_lo:[0,0,1] neg_hi:[0,0,1]
    v_pk_fma_f32 v[66:67], v[68:69], v[34:35], v[62:63]
    v_cvt_pk_bf16_f32 v98, v64, v66
    v_cvt_pk_bf16_f32 v99, v65, v67
    ds_write_b64 v5, v[98:99] offset:3696
    v_pk_mul_f32 v[60:61], v[66:67], v[34:35]
    v_pk_mul_f32 v[62:63], v[66:67], v[32:33]
    v_pk_fma_f32 v[68:69], v[64:65], v[32:33], v[60:61] neg_lo:[0,0,1] neg_hi:[0,0,1]
    v_pk_fma_f32 v[70:71], v[64:65], v[34:35], v[62:63]
    v_cvt_pk_bf16_f32 v92, v68, v70
    v_cvt_pk_bf16_f32 v93, v69, v71
    ds_write_b64 v5, v[92:93] offset:4224
    v_pk_mul_f32 v[60:61], v[70:71], v[34:35]
    v_pk_mul_f32 v[62:63], v[70:71], v[32:33]
    v_pk_fma_f32 v[64:65], v[68:69], v[32:33], v[60:61] neg_lo:[0,0,1] neg_hi:[0,0,1]
    v_pk_fma_f32 v[66:67], v[68:69], v[34:35], v[62:63]
    v_cvt_pk_bf16_f32 v94, v64, v66
    v_cvt_pk_bf16_f32 v95, v65, v67
    ds_write_b64 v5, v[94:95] offset:4752
    v_pk_mul_f32 v[60:61], v[66:67], v[34:35]
    v_pk_mul_f32 v[62:63], v[66:67], v[32:33]
    v_pk_fma_f32 v[68:69], v[64:65], v[32:33], v[60:61] neg_lo:[0,0,1] neg_hi:[0,0,1]
    v_pk_fma_f32 v[70:71], v[64:65], v[34:35], v[62:63]
    v_cvt_pk_bf16_f32 v96, v68, v70
    v_cvt_pk_bf16_f32 v97, v69, v71
    ds_write_b64 v5, v[96:97] offset:5280
    v_pk_mul_f32 v[60:61], v[70:71], v[34:35]
    v_pk_mul_f32 v[62:63], v[70:71], v[32:33]
    v_pk_fma_f32 v[64:65], v[68:69], v[32:33], v[60:61] neg_lo:[0,0,1] neg_hi:[0,0,1]
    v_pk_fma_f32 v[66:67], v[68:69], v[34:35], v[62:63]
    v_cvt_pk_bf16_f32 v98, v64, v66
    v_cvt_pk_bf16_f32 v99, v65, v67
    ds_write_b64 v5, v[98:99] offset:5808
    v_pk_mul_f32 v[60:61], v[66:67], v[34:35]
    v_pk_mul_f32 v[62:63], v[66:67], v[32:33]
    v_pk_fma_f32 v[68:69], v[64:65], v[32:33], v[60:61] neg_lo:[0,0,1] neg_hi:[0,0,1]
    v_pk_fma_f32 v[70:71], v[64:65], v[34:35], v[62:63]
    v_cvt_pk_bf16_f32 v92, v68, v70
    v_cvt_pk_bf16_f32 v93, v69, v71
    ds_write_b64 v5, v[92:93] offset:6336
    v_pk_mul_f32 v[60:61], v[70:71], v[34:35]
    v_pk_mul_f32 v[62:63], v[70:71], v[32:33]
    v_pk_fma_f32 v[64:65], v[68:69], v[32:33], v[60:61] neg_lo:[0,0,1] neg_hi:[0,0,1]
    v_pk_fma_f32 v[66:67], v[68:69], v[34:35], v[62:63]
    v_cvt_pk_bf16_f32 v94, v64, v66
    v_cvt_pk_bf16_f32 v95, v65, v67
    ds_write_b64 v5, v[94:95] offset:6864
    v_pk_mul_f32 v[60:61], v[66:67], v[34:35]
    v_pk_mul_f32 v[62:63], v[66:67], v[32:33]
    v_pk_fma_f32 v[68:69], v[64:65], v[32:33], v[60:61] neg_lo:[0,0,1] neg_hi:[0,0,1]
    v_pk_fma_f32 v[70:71], v[64:65], v[34:35], v[62:63]
    v_cvt_pk_bf16_f32 v96, v68, v70
    v_cvt_pk_bf16_f32 v97, v69, v71
    ds_write_b64 v5, v[96:97] offset:7392
    v_pk_mul_f32 v[60:61], v[70:71], v[34:35]
    v_pk_mul_f32 v[62:63], v[70:71], v[32:33]
    v_pk_fma_f32 v[64:65], v[68:69], v[32:33], v[60:61] neg_lo:[0,0,1] neg_hi:[0,0,1]
    v_pk_fma_f32 v[66:67], v[68:69], v[34:35], v[62:63]
    v_cvt_pk_bf16_f32 v98, v64, v66
    v_cvt_pk_bf16_f32 v99, v65, v67
    ds_write_b64 v5, v[98:99] offset:7920
    ds_read_b128 v[100:103], v8 offset:0
    ds_read_b128 v[104:107], v8 offset:64
    ds_read_b128 v[108:111], v8 offset:128
    ds_read_b128 v[112:115], v8 offset:192
    ds_read_b128 v[116:119], v8 offset:256
    ds_read_b128 v[120:123], v8 offset:320
    ds_read_b128 v[124:127], v8 offset:384
    ds_read_b128 v[128:131], v8 offset:448
    v_mov_b32 v176, 1.0
    v_mov_b32 v177, 1.0
    v_mov_b32 v178, 0
    v_mov_b32 v179, 0
    v_pk_mul_f32 v[60:61], v[26:27], v[22:23]
    v_pk_mul_f32 v[62:63], v[26:27], v[20:21]
    v_pk_fma_f32 v[180:181], v[24:25], v[20:21], v[60:61] neg_lo:[0,0,1] neg_hi:[0,0,1]
    v_pk_fma_f32 v[182:183], v[24:25], v[22:23], v[62:63]
    v_pk_mul_f32 v[60:61], v[30:31], v[22:23]
    v_pk_mul_f32 v[62:63], v[30:31], v[20:21]
    v_pk_fma_f32 v[184:185], v[28:29], v[20:21], v[60:61] neg_lo:[0,0,1] neg_hi:[0,0,1]
    v_pk_fma_f32 v[186:187], v[28:29], v[22:23], v[62:63]
    v_pk_mul_f32 v[60:61], v[30:31], v[26:27]
    v_pk_mul_f32 v[62:63], v[30:31], v[24:25]
    v_pk_fma_f32 v[188:189], v[28:29], v[24:25], v[60:61] neg_lo:[0,0,1] neg_hi:[0,0,1]
    v_pk_fma_f32 v[190:191], v[28:29], v[26:27], v[62:63]
    v_pk_mul_f32 v[60:61], v[30:31], v[182:183]
    v_pk_mul_f32 v[62:63], v[30:31], v[180:181]
    v_pk_fma_f32 v[192:193], v[28:29], v[180:181], v[60:61] neg_lo:[0,0,1] neg_hi:[0,0,1]
    v_pk_fma_f32 v[194:195], v[28:29], v[182:183], v[62:63]
    v_cvt_pk_bf16_f32 v92, v176, -v178
    v_cvt_pk_bf16_f32 v93, v177, -v179
    ds_write_b64 v5, v[92:93] offset:8448
    v_cvt_pk_bf16_f32 v94, v36, -v38
    v_cvt_pk_bf16_f32 v95, v37, -v39
    ds_write_b64 v5, v[94:95] offset:12672
    v_cvt_pk_bf16_f32 v96, v20, -v22
    v_cvt_pk_bf16_f32 v97, v21, -v23
    ds_write_b64 v5, v[96:97] offset:8976
    v_pk_mul_f32 v[60:61], v[22:23], v[38:39]
    v_pk_mul_f32 v[62:63], v[22:23], v[36:37]
    v_pk_fma_f32 v[64:65], v[20:21], v[36:37], v[60:61] neg_lo:[0,0,1] neg_hi:[0,0,1]
    v_pk_fma_f32 v[66:67], v[20:21], v[38:39], v[62:63]
    v_cvt_pk_bf16_f32 v98, v64, -v66
    v_cvt_pk_bf16_f32 v99, v65, -v67
    ds_write_b64 v5, v[98:99] offset:13200
    v_cvt_pk_bf16_f32 v92, v24, -v26
    v_cvt_pk_bf16_f32 v93, v25, -v27
    ds_write_b64 v5, v[92:93] offset:9504
    v_pk_mul_f32 v[60:61], v[26:27], v[38:39]
    v_pk_mul_f32 v[62:63], v[26:27], v[36:37]
    v_pk_fma_f32 v[64:65], v[24:25], v[36:37], v[60:61] neg_lo:[0,0,1] neg_hi:[0,0,1]
    v_pk_fma_f32 v[66:67], v[24:25], v[38:39], v[62:63]
    v_cvt_pk_bf16_f32 v94, v64, -v66
    v_cvt_pk_bf16_f32 v95, v65, -v67
    ds_write_b64 v5, v[94:95] offset:13728
    v_cvt_pk_bf16_f32 v96, v180, -v182
    v_cvt_pk_bf16_f32 v97, v181, -v183
    ds_write_b64 v5, v[96:97] offset:10032
    v_pk_mul_f32 v[60:61], v[182:183], v[38:39]
    v_pk_mul_f32 v[62:63], v[182:183], v[36:37]
    v_pk_fma_f32 v[64:65], v[180:181], v[36:37], v[60:61] neg_lo:[0,0,1] neg_hi:[0,0,1]
    v_pk_fma_f32 v[66:67], v[180:181], v[38:39], v[62:63]
    v_cvt_pk_bf16_f32 v98, v64, -v66
    v_cvt_pk_bf16_f32 v99, v65, -v67
    ds_write_b64 v5, v[98:99] offset:14256
    v_cvt_pk_bf16_f32 v92, v28, -v30
    v_cvt_pk_bf16_f32 v93, v29, -v31
    ds_write_b64 v5, v[92:93] offset:10560
    v_pk_mul_f32 v[60:61], v[30:31], v[38:39]
    v_pk_mul_f32 v[62:63], v[30:31], v[36:37]
    v_pk_fma_f32 v[64:65], v[28:29], v[36:37], v[60:61] neg_lo:[0,0,1] neg_hi:[0,0,1]
    v_pk_fma_f32 v[66:67], v[28:29], v[38:39], v[62:63]
    v_cvt_pk_bf16_f32 v94, v64, -v66
    v_cvt_pk_bf16_f32 v95, v65, -v67
    ds_write_b64 v5, v[94:95] offset:14784
    v_cvt_pk_bf16_f32 v96, v184, -v186
    v_cvt_pk_bf16_f32 v97, v185, -v187
    ds_write_b64 v5, v[96:97] offset:11088
    v_pk_mul_f32 v[60:61], v[186:187], v[38:39]
    v_pk_mul_f32 v[62:63], v[186:187], v[36:37]
    v_pk_fma_f32 v[64:65], v[184:185], v[36:37], v[60:61] neg_lo:[0,0,1] neg_hi:[0,0,1]
    v_pk_fma_f32 v[66:67], v[184:185], v[38:39], v[62:63]
    v_cvt_pk_bf16_f32 v98, v64, -v66
    v_cvt_pk_bf16_f32 v99, v65, -v67
    ds_write_b64 v5, v[98:99] offset:15312
    v_cvt_pk_bf16_f32 v92, v188, -v190
    v_cvt_pk_bf16_f32 v93, v189, -v191
    ds_write_b64 v5, v[92:93] offset:11616
    v_pk_mul_f32 v[60:61], v[190:191], v[38:39]
    v_pk_mul_f32 v[62:63], v[190:191], v[36:37]
    v_pk_fma_f32 v[64:65], v[188:189], v[36:37], v[60:61] neg_lo:[0,0,1] neg_hi:[0,0,1]
    v_pk_fma_f32 v[66:67], v[188:189], v[38:39], v[62:63]
    v_cvt_pk_bf16_f32 v94, v64, -v66
    v_cvt_pk_bf16_f32 v95, v65, -v67
    ds_write_b64 v5, v[94:95] offset:15840
    v_cvt_pk_bf16_f32 v96, v192, -v194
    v_cvt_pk_bf16_f32 v97, v193, -v195
    ds_write_b64 v5, v[96:97] offset:12144
    v_pk_mul_f32 v[60:61], v[194:195], v[38:39]
    v_pk_mul_f32 v[62:63], v[194:195], v[36:37]
    v_pk_fma_f32 v[64:65], v[192:193], v[36:37], v[60:61] neg_lo:[0,0,1] neg_hi:[0,0,1]
    v_pk_fma_f32 v[66:67], v[192:193], v[38:39], v[62:63]
    v_cvt_pk_bf16_f32 v98, v64, -v66
    v_cvt_pk_bf16_f32 v99, v65, -v67
    ds_write_b64 v5, v[98:99] offset:16368
    ds_read_b128 v[132:135], v8 offset:8448
    ds_read_b128 v[136:139], v8 offset:8512
    ds_read_b128 v[140:143], v8 offset:8576
    ds_read_b128 v[144:147], v8 offset:8640
    ds_read_b128 v[148:151], v8 offset:8704
    ds_read_b128 v[152:155], v8 offset:8768
    ds_read_b128 v[156:159], v8 offset:8832
    ds_read_b128 v[160:163], v8 offset:8896
    s_waitcnt lgkmcnt(7)
    v_mfma_f32_16x16x32_bf16 v[164:167], v[132:135], v[100:103], 0
    s_waitcnt lgkmcnt(6)
    v_mfma_f32_16x16x32_bf16 v[164:167], v[136:139], v[104:107], v[164:167]
    s_waitcnt lgkmcnt(5)
    v_mfma_f32_16x16x32_bf16 v[164:167], v[140:143], v[108:111], v[164:167]
    s_waitcnt lgkmcnt(4)
    v_mfma_f32_16x16x32_bf16 v[164:167], v[144:147], v[112:115], v[164:167]
    s_waitcnt lgkmcnt(3)
    v_mfma_f32_16x16x32_bf16 v[164:167], v[148:151], v[116:119], v[164:167]
    s_waitcnt lgkmcnt(2)
    v_mfma_f32_16x16x32_bf16 v[164:167], v[152:155], v[120:123], v[164:167]
    s_waitcnt lgkmcnt(1)
    v_mfma_f32_16x16x32_bf16 v[164:167], v[156:159], v[124:127], v[164:167]
    s_waitcnt lgkmcnt(0)
    v_mfma_f32_16x16x32_bf16 v[164:167], v[160:163], v[128:131], v[164:167]
    v_cvt_pk_bf16_f32 v92, v40, -v42
    v_cvt_pk_bf16_f32 v93, v41, -v43
    ds_write_b64 v5, v[92:93] offset:0
    v_pk_mul_f32 v[60:61], v[42:43], v[38:39]
    v_pk_mul_f32 v[62:63], v[42:43], v[36:37]
    v_pk_fma_f32 v[68:69], v[40:41], v[36:37], v[60:61] neg_lo:[0,0,1] neg_hi:[0,0,1]
    v_pk_fma_f32 v[70:71], v[40:41], v[38:39], v[62:63]
    v_cvt_pk_bf16_f32 v94, v68, -v70
    v_cvt_pk_bf16_f32 v95, v69, -v71
    ds_write_b64 v5, v[94:95] offset:2112
    v_pk_mul_f32 v[60:61], v[26:27], v[42:43]
    v_pk_mul_f32 v[62:63], v[26:27], v[40:41]
    v_pk_fma_f32 v[64:65], v[24:25], v[40:41], v[60:61] neg_lo:[0,0,1] neg_hi:[0,0,1]
    v_pk_fma_f32 v[66:67], v[24:25], v[42:43], v[62:63]
    v_cvt_pk_bf16_f32 v96, v64, -v66
    v_cvt_pk_bf16_f32 v97, v65, -v67
    ds_write_b64 v5, v[96:97] offset:528
    v_pk_mul_f32 v[60:61], v[66:67], v[38:39]
    v_pk_mul_f32 v[62:63], v[66:67], v[36:37]
    v_pk_fma_f32 v[68:69], v[64:65], v[36:37], v[60:61] neg_lo:[0,0,1] neg_hi:[0,0,1]
    v_pk_fma_f32 v[70:71], v[64:65], v[38:39], v[62:63]
    v_cvt_pk_bf16_f32 v98, v68, -v70
    v_cvt_pk_bf16_f32 v99, v69, -v71
    ds_write_b64 v5, v[98:99] offset:2640
    v_pk_mul_f32 v[60:61], v[30:31], v[42:43]
    v_pk_mul_f32 v[62:63], v[30:31], v[40:41]
    v_pk_fma_f32 v[64:65], v[28:29], v[40:41], v[60:61] neg_lo:[0,0,1] neg_hi:[0,0,1]
    v_pk_fma_f32 v[66:67], v[28:29], v[42:43], v[62:63]
    v_cvt_pk_bf16_f32 v92, v64, -v66
    v_cvt_pk_bf16_f32 v93, v65, -v67
    ds_write_b64 v5, v[92:93] offset:1056
    v_pk_mul_f32 v[60:61], v[66:67], v[38:39]
    v_pk_mul_f32 v[62:63], v[66:67], v[36:37]
    v_pk_fma_f32 v[68:69], v[64:65], v[36:37], v[60:61] neg_lo:[0,0,1] neg_hi:[0,0,1]
    v_pk_fma_f32 v[70:71], v[64:65], v[38:39], v[62:63]
    v_cvt_pk_bf16_f32 v94, v68, -v70
    v_cvt_pk_bf16_f32 v95, v69, -v71
    ds_write_b64 v5, v[94:95] offset:3168
    v_pk_mul_f32 v[60:61], v[190:191], v[42:43]
    v_pk_mul_f32 v[62:63], v[190:191], v[40:41]
    v_pk_fma_f32 v[64:65], v[188:189], v[40:41], v[60:61] neg_lo:[0,0,1] neg_hi:[0,0,1]
    v_pk_fma_f32 v[66:67], v[188:189], v[42:43], v[62:63]
    v_cvt_pk_bf16_f32 v96, v64, -v66
    v_cvt_pk_bf16_f32 v97, v65, -v67
    ds_write_b64 v5, v[96:97] offset:1584
    v_pk_mul_f32 v[60:61], v[66:67], v[38:39]
    v_pk_mul_f32 v[62:63], v[66:67], v[36:37]
    v_pk_fma_f32 v[68:69], v[64:65], v[36:37], v[60:61] neg_lo:[0,0,1] neg_hi:[0,0,1]
    v_pk_fma_f32 v[70:71], v[64:65], v[38:39], v[62:63]
    v_cvt_pk_bf16_f32 v98, v68, -v70
    v_cvt_pk_bf16_f32 v99, v69, -v71
    ds_write_b64 v5, v[98:99] offset:3696
    v_pk_mul_f32 v[60:61], v[46:47], v[30:31]
    v_pk_mul_f32 v[62:63], v[46:47], v[28:29]
    v_pk_fma_f32 v[72:73], v[44:45], v[28:29], v[60:61] neg_lo:[0,0,1] neg_hi:[0,0,1]
    v_pk_fma_f32 v[74:75], v[44:45], v[30:31], v[62:63]
    v_cvt_pk_bf16_f32 v92, v44, -v46
    v_cvt_pk_bf16_f32 v93, v45, -v47
    ds_write_b64 v5, v[92:93] offset:4224
    v_cvt_pk_bf16_f32 v94, v72, -v74
    v_cvt_pk_bf16_f32 v95, v73, -v75
    ds_write_b64 v5, v[94:95] offset:4752
    v_pk_mul_f32 v[60:61], v[46:47], v[38:39]
    v_pk_mul_f32 v[62:63], v[46:47], v[36:37]
    v_pk_fma_f32 v[196:197], v[44:45], v[36:37], v[60:61] neg_lo:[0,0,1] neg_hi:[0,0,1]
    v_pk_fma_f32 v[198:199], v[44:45], v[38:39], v[62:63]
    v_cvt_pk_bf16_f32 v96, v196, -v198
    v_cvt_pk_bf16_f32 v97, v197, -v199
    ds_write_b64 v5, v[96:97] offset:5280
    v_pk_mul_f32 v[60:61], v[74:75], v[38:39]
    v_pk_mul_f32 v[62:63], v[74:75], v[36:37]
    v_pk_fma_f32 v[200:201], v[72:73], v[36:37], v[60:61] neg_lo:[0,0,1] neg_hi:[0,0,1]
    v_pk_fma_f32 v[202:203], v[72:73], v[38:39], v[62:63]
    v_cvt_pk_bf16_f32 v98, v200, -v202
    v_cvt_pk_bf16_f32 v99, v201, -v203
    ds_write_b64 v5, v[98:99] offset:5808
    v_pk_mul_f32 v[60:61], v[198:199], v[38:39]
    v_pk_mul_f32 v[62:63], v[198:199], v[36:37]
    v_pk_fma_f32 v[64:65], v[196:197], v[36:37], v[60:61] neg_lo:[0,0,1] neg_hi:[0,0,1]
    v_pk_fma_f32 v[66:67], v[196:197], v[38:39], v[62:63]
    v_cvt_pk_bf16_f32 v92, v64, -v66
    v_cvt_pk_bf16_f32 v93, v65, -v67
    ds_write_b64 v5, v[92:93] offset:6336
    v_pk_mul_f32 v[60:61], v[202:203], v[38:39]
    v_pk_mul_f32 v[62:63], v[202:203], v[36:37]
    v_pk_fma_f32 v[68:69], v[200:201], v[36:37], v[60:61] neg_lo:[0,0,1] neg_hi:[0,0,1]
    v_pk_fma_f32 v[70:71], v[200:201], v[38:39], v[62:63]
    v_cvt_pk_bf16_f32 v94, v68, -v70
    v_cvt_pk_bf16_f32 v95, v69, -v71
    ds_write_b64 v5, v[94:95] offset:6864
    v_pk_mul_f32 v[60:61], v[66:67], v[38:39]
    v_pk_mul_f32 v[62:63], v[66:67], v[36:37]
    v_pk_fma_f32 v[196:197], v[64:65], v[36:37], v[60:61] neg_lo:[0,0,1] neg_hi:[0,0,1]
    v_pk_fma_f32 v[198:199], v[64:65], v[38:39], v[62:63]
    v_cvt_pk_bf16_f32 v96, v196, -v198
    v_cvt_pk_bf16_f32 v97, v197, -v199
    ds_write_b64 v5, v[96:97] offset:7392
    v_pk_mul_f32 v[60:61], v[70:71], v[38:39]
    v_pk_mul_f32 v[62:63], v[70:71], v[36:37]
    v_pk_fma_f32 v[200:201], v[68:69], v[36:37], v[60:61] neg_lo:[0,0,1] neg_hi:[0,0,1]
    v_pk_fma_f32 v[202:203], v[68:69], v[38:39], v[62:63]
    v_cvt_pk_bf16_f32 v98, v200, -v202
    v_cvt_pk_bf16_f32 v99, v201, -v203
    ds_write_b64 v5, v[98:99] offset:7920
    ds_read_b128 v[132:135], v8 offset:0
    ds_read_b128 v[136:139], v8 offset:64
    ds_read_b128 v[140:143], v8 offset:128
    ds_read_b128 v[144:147], v8 offset:192
    ds_read_b128 v[148:151], v8 offset:256
    ds_read_b128 v[152:155], v8 offset:320
    ds_read_b128 v[156:159], v8 offset:384
    ds_read_b128 v[160:163], v8 offset:448
    s_waitcnt lgkmcnt(7)
    v_mfma_f32_16x16x32_bf16 v[168:171], v[132:135], v[100:103], 0
    s_waitcnt lgkmcnt(6)
    v_mfma_f32_16x16x32_bf16 v[168:171], v[136:139], v[104:107], v[168:171]
    s_waitcnt lgkmcnt(5)
    v_mfma_f32_16x16x32_bf16 v[168:171], v[140:143], v[108:111], v[168:171]
    s_waitcnt lgkmcnt(4)
    v_mfma_f32_16x16x32_bf16 v[168:171], v[144:147], v[112:115], v[168:171]
    s_waitcnt lgkmcnt(3)
    v_mfma_f32_16x16x32_bf16 v[168:171], v[148:151], v[116:119], v[168:171]
    s_waitcnt lgkmcnt(2)
    v_mfma_f32_16x16x32_bf16 v[168:171], v[152:155], v[120:123], v[168:171]
    s_waitcnt lgkmcnt(1)
    v_mfma_f32_16x16x32_bf16 v[168:171], v[156:159], v[124:127], v[168:171]
    s_waitcnt lgkmcnt(0)
    v_mfma_f32_16x16x32_bf16 v[168:171], v[160:163], v[128:131], v[168:171]
    v_cvt_pk_bf16_f32 v92, v48, -v50
    v_cvt_pk_bf16_f32 v93, v49, -v51
    ds_write_b64 v5, v[92:93] offset:8448
    v_pk_mul_f32 v[60:61], v[50:51], v[38:39]
    v_pk_mul_f32 v[62:63], v[50:51], v[36:37]
    v_pk_fma_f32 v[64:65], v[48:49], v[36:37], v[60:61] neg_lo:[0,0,1] neg_hi:[0,0,1]
    v_pk_fma_f32 v[66:67], v[48:49], v[38:39], v[62:63]
    v_cvt_pk_bf16_f32 v94, v64, -v66
    v_cvt_pk_bf16_f32 v95, v65, -v67
    ds_write_b64 v5, v[94:95] offset:8976
    v_pk_mul_f32 v[60:61], v[66:67], v[38:39]
    v_pk_mul_f32 v[62:63], v[66:67], v[36:37]
    v_pk_fma_f32 v[68:69], v[64:65], v[36:37], v[60:61] neg_lo:[0,0,1] neg_hi:[0,0,1]
    v_pk_fma_f32 v[70:71], v[64:65], v[38:39], v[62:63]
    v_cvt_pk_bf16_f32 v96, v68, -v70
    v_cvt_pk_bf16_f32 v97, v69, -v71
    ds_write_b64 v5, v[96:97] offset:9504
    v_pk_mul_f32 v[60:61], v[70:71], v[38:39]
    v_pk_mul_f32 v[62:63], v[70:71], v[36:37]
    v_pk_fma_f32 v[64:65], v[68:69], v[36:37], v[60:61] neg_lo:[0,0,1] neg_hi:[0,0,1]
    v_pk_fma_f32 v[66:67], v[68:69], v[38:39], v[62:63]
    v_cvt_pk_bf16_f32 v98, v64, -v66
    v_cvt_pk_bf16_f32 v99, v65, -v67
    ds_write_b64 v5, v[98:99] offset:10032
    v_pk_mul_f32 v[60:61], v[66:67], v[38:39]
    v_pk_mul_f32 v[62:63], v[66:67], v[36:37]
    v_pk_fma_f32 v[68:69], v[64:65], v[36:37], v[60:61] neg_lo:[0,0,1] neg_hi:[0,0,1]
    v_pk_fma_f32 v[70:71], v[64:65], v[38:39], v[62:63]
    v_cvt_pk_bf16_f32 v92, v68, -v70
    v_cvt_pk_bf16_f32 v93, v69, -v71
    ds_write_b64 v5, v[92:93] offset:10560
    v_pk_mul_f32 v[60:61], v[70:71], v[38:39]
    v_pk_mul_f32 v[62:63], v[70:71], v[36:37]
    v_pk_fma_f32 v[64:65], v[68:69], v[36:37], v[60:61] neg_lo:[0,0,1] neg_hi:[0,0,1]
    v_pk_fma_f32 v[66:67], v[68:69], v[38:39], v[62:63]
    v_cvt_pk_bf16_f32 v94, v64, -v66
    v_cvt_pk_bf16_f32 v95, v65, -v67
    ds_write_b64 v5, v[94:95] offset:11088
    v_pk_mul_f32 v[60:61], v[66:67], v[38:39]
    v_pk_mul_f32 v[62:63], v[66:67], v[36:37]
    v_pk_fma_f32 v[68:69], v[64:65], v[36:37], v[60:61] neg_lo:[0,0,1] neg_hi:[0,0,1]
    v_pk_fma_f32 v[70:71], v[64:65], v[38:39], v[62:63]
    v_cvt_pk_bf16_f32 v96, v68, -v70
    v_cvt_pk_bf16_f32 v97, v69, -v71
    ds_write_b64 v5, v[96:97] offset:11616
    v_pk_mul_f32 v[60:61], v[70:71], v[38:39]
    v_pk_mul_f32 v[62:63], v[70:71], v[36:37]
    v_pk_fma_f32 v[64:65], v[68:69], v[36:37], v[60:61] neg_lo:[0,0,1] neg_hi:[0,0,1]
    v_pk_fma_f32 v[66:67], v[68:69], v[38:39], v[62:63]
    v_cvt_pk_bf16_f32 v98, v64, -v66
    v_cvt_pk_bf16_f32 v99, v65, -v67
    ds_write_b64 v5, v[98:99] offset:12144
    v_cvt_pk_bf16_f32 v92, v52, -v54
    v_cvt_pk_bf16_f32 v93, v53, -v55
    ds_write_b64 v5, v[92:93] offset:12672
    ds_read_b128 v[132:135], v8 offset:8448
    ds_read_b128 v[136:139], v8 offset:8512
    ds_read_b128 v[140:143], v8 offset:8576
    ds_read_b128 v[144:147], v8 offset:8640
    ds_read_b128 v[148:151], v8 offset:8704
    ds_read_b128 v[152:155], v8 offset:8768
    ds_read_b128 v[156:159], v8 offset:8832
    ds_read_b128 v[160:163], v8 offset:8896
    s_waitcnt lgkmcnt(7)
    v_mfma_f32_16x16x32_bf16 v[172:175], v[132:135], v[100:103], 0
    s_waitcnt lgkmcnt(6)
    v_mfma_f32_16x16x32_bf16 v[172:175], v[136:139], v[104:107], v[172:175]
    s_waitcnt lgkmcnt(5)
    v_mfma_f32_16x16x32_bf16 v[172:175], v[140:143], v[108:111], v[172:175]
    s_waitcnt lgkmcnt(4)
    v_mfma_f32_16x16x32_bf16 v[172:175], v[144:147], v[112:115], v[172:175]
    s_waitcnt lgkmcnt(3)
    v_mfma_f32_16x16x32_bf16 v[172:175], v[148:151], v[116:119], v[172:175]
    s_waitcnt lgkmcnt(2)
    v_mfma_f32_16x16x32_bf16 v[172:175], v[152:155], v[120:123], v[172:175]
    s_waitcnt lgkmcnt(1)
    v_mfma_f32_16x16x32_bf16 v[172:175], v[156:159], v[124:127], v[172:175]
    s_waitcnt lgkmcnt(0)
    v_mfma_f32_16x16x32_bf16 v[172:175], v[160:163], v[128:131], v[172:175]
    v_and_b32 v10, 1, v7
    v_lshlrev_b32 v10, 2, v10
    v_lshrrev_b32 v11, 1, v7
    v_lshlrev_b32 v12, 7, v11
    v_add_u32 v10, v10, v12
    v_lshlrev_b32 v12, 3, v6
    v_add_u32 v10, v10, v12
    v_lshlrev_b32 v10, 2, v10
    v_add_u32 v10, s7, v10
    ds_write_b128 v10, v[164:167] offset:16896
    v_lshlrev_b32 v10, 6, v7
    v_lshlrev_b32 v12, 1, v6
    v_cmp_gt_u32 vcc, 2, v7
    v_lshlrev_b32 v13, 2, v6
    s_nop 0
    v_cndmask_b32 v12, v12, v13, vcc
    v_add_u32 v10, v10, v12
    v_mov_b32 v13, 32
    v_mov_b32 v14, 2
    v_cndmask_b32 v13, v13, v14, vcc
    v_add_u32 v13, v10, v13
    v_lshlrev_b32 v10, 2, v10
    v_add_u32 v10, s7, v10
    v_lshlrev_b32 v13, 2, v13
    v_add_u32 v13, s7, v13
    ds_write_b64 v10, v[168:169] offset:17920
    ds_write_b64 v13, v[170:171] offset:17920
    v_lshlrev_b32 v10, 6, v7
    v_add_u32 v10, v10, v6
    v_lshlrev_b32 v10, 2, v10
    v_add_u32 v10, s7, v10
    ds_write_b32 v10, v172 offset:18944
    ds_write_b32 v10, v173 offset:19008
    ds_write_b32 v10, v174 offset:19072
    ds_write_b32 v10, v175 offset:19136
    v_sub_u32 v10, 575, v1
    v_lshlrev_b32 v10, 2, v10
    v_add_u32 v10, s7, v10
    v_add_u32 v10, 16896, v10
    ds_read2_b32 v[20:21], v10 offset0:64 offset1:65
    ds_read2_b32 v[22:23], v10 offset0:0 offset1:1
    v_lshlrev_b32 v11, 1, v1
    v_sub_u32 v11, 510, v11
    v_lshlrev_b32 v11, 2, v11
    v_add_u32 v11, s7, v11
    v_add_u32 v11, 16896, v11
    ds_read2_b32 v[24:25], v11 offset0:0 offset1:1
    ds_read_b32 v26, v11 offset:8
    v_lshlrev_b32 v12, 2, v1
    v_sub_u32 v12, 377, v12
    v_lshlrev_b32 v13, 3, v1
    v_sub_u32 v13, 504, v13
    v_cmp_gt_u32 vcc, 32, v1
    s_nop 1
    v_cndmask_b32 v12, v13, v12, vcc
    v_lshlrev_b32 v12, 2, v12
    v_add_u32 v12, s7, v12
    v_add_u32 v12, 16896, v12
    ds_read2_b32 v[28:29], v12 offset0:0 offset1:1
    ds_read2_b32 v[30:31], v12 offset0:2 offset1:3
    ds_read2_b32 v[32:33], v12 offset0:4 offset1:5
    ds_read2_b32 v[34:35], v12 offset0:6 offset1:7
    s_mul_i32 s6, s5, 4128
    v_lshlrev_b32 v14, 4, v1
    v_add_u32 v14, s6, v14
    v_and_b32 v15, 1, v1
    v_cmp_eq_u32 s[40:41], 0, v15
    s_waitcnt lgkmcnt(0)
    s_nop 0
    v_cndmask_b32 v15, v20, v21, s[40:41]
    v_cvt_pk_bf16_f32 v40, v21, v21
    v_cvt_pk_bf16_f32 v41, v21, v15
    v_cvt_pk_bf16_f32 v42, v20, v20
    v_mov_b32 v43, v42
    buffer_store_dwordx4 v[40:43], v14, s[36:39], 0 offen offset:0
    v_cndmask_b32 v15, v22, v23, s[40:41]
    v_cvt_pk_bf16_f32 v44, v23, v23
    v_cvt_pk_bf16_f32 v45, v23, v15
    v_cvt_pk_bf16_f32 v46, v22, v22
    v_mov_b32 v47, v46
    buffer_store_dwordx4 v[44:47], v14, s[36:39], 0 offen offset:1024
    v_cvt_pk_bf16_f32 v48, v26, v26
    v_cvt_pk_bf16_f32 v49, v25, v25
    v_cvt_pk_bf16_f32 v50, v25, v24
    v_cvt_pk_bf16_f32 v51, v24, v24
    buffer_store_dwordx4 v[48:51], v14, s[36:39], 0 offen offset:2048
    v_mov_b32 v60, v35
    v_mov_b32 v61, v34
    v_mov_b32 v62, v33
    v_cndmask_b32 v63, v32, v33, vcc
    v_cndmask_b32 v64, v31, v33, vcc
    v_cndmask_b32 v65, v30, v32, vcc
    v_cndmask_b32 v66, v29, v31, vcc
    v_cndmask_b32 v67, v28, v31, vcc
    v_cvt_pk_bf16_f32 v52, v60, v61
    v_cvt_pk_bf16_f32 v53, v62, v63
    v_cvt_pk_bf16_f32 v54, v64, v65
    v_cvt_pk_bf16_f32 v55, v66, v67
    buffer_store_dwordx4 v[52:55], v14, s[36:39], 0 offen offset:3072
    v_mov_b32 v56, 0
    v_mov_b32 v57, 0
    v_mov_b32 v58, 0
    v_mov_b32 v59, 0
    s_mov_b64 exec, 3
    s_movk_i32 s6, 0x1000
    buffer_store_dwordx4 v[56:59], v14, s[36:39], s6 offen
    s_branch P1_END
P1_NOT_KG:
    s_sub_u32 s2, s2, 144
    s_cmp_ge_u32 s2, 108
    s_cbranch_scc1 P1_TR
    s_load_dwordx2 s[8:9], s[0:1], 112
    s_load_dwordx2 s[12:13], s[0:1], 104
    s_load_dwordx2 s[16:17], s[0:1], 136
    v_and_b32 v1, 3, v0
    v_lshrrev_b32 v2, 2, v0
    v_mul_u32_u24 v3, 6912, v2
    v_lshlrev_b32 v4, 4, v1
    v_add_u32 v3, v3, v4
    s_lshl_b32 s3, s2, 6
    v_add_u32 v3, s3, v3
    v_lshlrev_b32 v4, 1, v2
    s_waitcnt lgkmcnt(0)
    s_mov_b32 s10, 0x3cc000
    s_mov_b32 s11, 0x00020000
    s_mov_b32 s14, 0x480
    s_mov_b32 s15, 0x00020000
    s_add_u32 s16, s16, 0x310000
    s_addc_u32 s17, s17, 0
    s_mov_b32 s18, 0x3600
    s_mov_b32 s19, 0x00020000
    buffer_load_ushort v10, v4, s[12:15], 0 offen offset:0
    buffer_load_ushort v11, v4, s[12:15], 0 offen offset:128
    buffer_load_ushort v12, v4, s[12:15], 0 offen offset:256
    buffer_load_ushort v13, v4, s[12:15], 0 offen offset:384
    buffer_load_ushort v14, v4, s[12:15], 0 offen offset:512
    buffer_load_ushort v15, v4, s[12:15], 0 offen offset:640
    buffer_load_ushort v16, v4, s[12:15], 0 offen offset:768
    buffer_load_ushort v17, v4, s[12:15], 0 offen offset:896
    buffer_load_ushort v18, v4, s[12:15], 0 offen offset:1024
    s_mov_b32 s4, 0
    buffer_load_dwordx4 v[20:23], v3, s[8:11], s4 offen
    s_add_u32 s4, s4, 442368
    buffer_load_dwordx4 v[24:27], v3, s[8:11], s4 offen
    s_add_u32 s4, s4, 442368
    buffer_load_dwordx4 v[28:31], v3, s[8:11], s4 offen
    s_add_u32 s4, s4, 442368
    buffer_load_dwordx4 v[32:35], v3, s[8:11], s4 offen
    s_add_u32 s4, s4, 442368
    buffer_load_dwordx4 v[36:39], v3, s[8:11], s4 offen
    s_add_u32 s4, s4, 442368
    buffer_load_dwordx4 v[40:43], v3, s[8:11], s4 offen
    s_add_u32 s4, s4, 442368
    buffer_load_dwordx4 v[44:47], v3, s[8:11], s4 offen
    s_add_u32 s4, s4, 442368
    buffer_load_dwordx4 v[48:51], v3, s[8:11], s4 offen
    s_add_u32 s4, s4, 442368
    buffer_load_dwordx4 v[52:55], v3, s[8:11], s4 offen
    v_mov_b32 v60, 0
    v_mov_b32 v61, 0
    v_mov_b32 v62, 0
    v_mov_b32 v63, 0
    v_mov_b32 v64, 0
    v_mov_b32 v65, 0
    v_mov_b32 v66, 0
    v_mov_b32 v67, 0
    s_waitcnt vmcnt(9)
    v_lshlrev_b32 v10, 16, v10
    v_mul_f32 v70, 0xbfb8aa3b, v10
    v_exp_f32 v70, v70
    s_nop 0
    v_add_f32 v70, 1.0, v70
    v_rcp_f32 v70, v70
    s_nop 0
    v_mul_f32 v10, v10, v70
    v_cvt_pk_bf16_f32 v10, v10, v10
    v_lshlrev_b32 v10, 16, v10
    v_lshlrev_b32 v11, 16, v11
    v_mul_f32 v70, 0xbfb8aa3b, v11
    v_exp_f32 v70, v70
    s_nop 0
    v_add_f32 v70, 1.0, v70
    v_rcp_f32 v70, v70
    s_nop 0
    v_mul_f32 v11, v11, v70
    v_cvt_pk_bf16_f32 v11, v11, v11
    v_lshlrev_b32 v11, 16, v11
    v_lshlrev_b32 v12, 16, v12
    v_mul_f32 v70, 0xbfb8aa3b, v12
    v_exp_f32 v70, v70
    s_nop 0
    v_add_f32 v70, 1.0, v70
    v_rcp_f32 v70, v70
    s_nop 0
    v_mul_f32 v12, v12, v70
    v_cvt_pk_bf16_f32 v12, v12, v12
    v_lshlrev_b32 v12, 16, v12
    v_lshlrev_b32 v13, 16, v13
    v_mul_f32 v70, 0xbfb8aa3b, v13
    v_exp_f32 v70, v70
    s_nop 0
    v_add_f32 v70, 1.0, v70
    v_rcp_f32 v70, v70
    s_nop 0
    v_mul_f32 v13, v13, v70
    v_cvt_pk_bf16_f32 v13, v13, v13
    v_lshlrev_b32 v13, 16, v13
    v_lshlrev_b32 v14, 16, v14
    v_mul_f32 v70, 0xbfb8aa3b, v14
    v_exp_f32 v70, v70
    s_nop 0
    v_add_f32 v70, 1.0, v70
    v_rcp_f32 v70, v70
    s_nop 0
    v_mul_f32 v14, v14, v70
    v_cvt_pk_bf16_f32 v14, v14, v14
    v_lshlrev_b32 v14, 16, v14
    v_lshlrev_b32 v15, 16, v15
    v_mul_f32 v70, 0xbfb8aa3b, v15
    v_exp_f32 v70, v70
    s_nop 0
    v_add_f32 v70, 1.0, v70
    v_rcp_f32 v70, v70
    s_nop 0
    v_mul_f32 v15, v15, v70
    v_cvt_pk_bf16_f32 v15, v15, v15
    v_lshlrev_b32 v15, 16, v15
    v_lshlrev_b32 v16, 16, v16
    v_mul_f32 v70, 0xbfb8aa3b, v16
    v_exp_f32 v70, v70
    s_nop 0
    v_add_f32 v70, 1.0, v70
    v_rcp_f32 v70, v70
    s_nop 0
    v_mul_f32 v16, v16, v70
    v_cvt_pk_bf16_f32 v16, v16, v16
    v_lshlrev_b32 v16, 16, v16
    v_lshlrev_b32 v17, 16, v17
    v_mul_f32 v70, 0xbfb8aa3b, v17
    v_exp_f32 v70, v70
    s_nop 0
    v_add_f32 v70, 1.0, v70
    v_rcp_f32 v70, v70
    s_nop 0
    v_mul_f32 v17, v17, v70
    v_cvt_pk_bf16_f32 v17, v17, v17
    v_lshlrev_b32 v17, 16, v17
    v_lshlrev_b32 v18, 16, v18
    v_mul_f32 v70, 0xbfb8aa3b, v18
    v_exp_f32 v70, v70
    s_nop 0
    v_add_f32 v70, 1.0, v70
    v_rcp_f32 v70, v70
    s_nop 0
    v_mul_f32 v18, v18, v70
    v_cvt_pk_bf16_f32 v18, v18, v18
    v_lshlrev_b32 v18, 16, v18
    s_waitcnt vmcnt(8)
    v_lshlrev_b32 v70, 16, v20
    v_and_b32 v71, 0xffff0000, v20
    v_fmac_f32 v60, v10, v70
    v_fmac_f32 v61, v10, v71
    v_lshlrev_b32 v70, 16, v21
    v_and_b32 v71, 0xffff0000, v21
    v_fmac_f32 v62, v10, v70
    v_fmac_f32 v63, v10, v71
    v_lshlrev_b32 v70, 16, v22
    v_and_b32 v71, 0xffff0000, v22
    v_fmac_f32 v64, v10, v70
    v_fmac_f32 v65, v10, v71
    v_lshlrev_b32 v70, 16, v23
    v_and_b32 v71, 0xffff0000, v23
    v_fmac_f32 v66, v10, v70
    v_fmac_f32 v67, v10, v71
    s_waitcnt vmcnt(7)
    v_lshlrev_b32 v70, 16, v24
    v_and_b32 v71, 0xffff0000, v24
    v_fmac_f32 v60, v11, v70
    v_fmac_f32 v61, v11, v71
    v_lshlrev_b32 v70, 16, v25
    v_and_b32 v71, 0xffff0000, v25
    v_fmac_f32 v62, v11, v70
    v_fmac_f32 v63, v11, v71
    v_lshlrev_b32 v70, 16, v26
    v_and_b32 v71, 0xffff0000, v26
    v_fmac_f32 v64, v11, v70
    v_fmac_f32 v65, v11, v71
    v_lshlrev_b32 v70, 16, v27
    v_and_b32 v71, 0xffff0000, v27
    v_fmac_f32 v66, v11, v70
    v_fmac_f32 v67, v11, v71
    s_waitcnt vmcnt(6)
    v_lshlrev_b32 v70, 16, v28
    v_and_b32 v71, 0xffff0000, v28
    v_fmac_f32 v60, v12, v70
    v_fmac_f32 v61, v12, v71
    v_lshlrev_b32 v70, 16, v29
    v_and_b32 v71, 0xffff0000, v29
    v_fmac_f32 v62, v12, v70
    v_fmac_f32 v63, v12, v71
    v_lshlrev_b32 v70, 16, v30
    v_and_b32 v71, 0xffff0000, v30
    v_fmac_f32 v64, v12, v70
    v_fmac_f32 v65, v12, v71
    v_lshlrev_b32 v70, 16, v31
    v_and_b32 v71, 0xffff0000, v31
    v_fmac_f32 v66, v12, v70
    v_fmac_f32 v67, v12, v71
    s_waitcnt vmcnt(5)
    v_lshlrev_b32 v70, 16, v32
    v_and_b32 v71, 0xffff0000, v32
    v_fmac_f32 v60, v13, v70
    v_fmac_f32 v61, v13, v71
    v_lshlrev_b32 v70, 16, v33
    v_and_b32 v71, 0xffff0000, v33
    v_fmac_f32 v62, v13, v70
    v_fmac_f32 v63, v13, v71
    v_lshlrev_b32 v70, 16, v34
    v_and_b32 v71, 0xffff0000, v34
    v_fmac_f32 v64, v13, v70
    v_fmac_f32 v65, v13, v71
    v_lshlrev_b32 v70, 16, v35
    v_and_b32 v71, 0xffff0000, v35
    v_fmac_f32 v66, v13, v70
    v_fmac_f32 v67, v13, v71
    s_waitcnt vmcnt(4)
    v_lshlrev_b32 v70, 16, v36
    v_and_b32 v71, 0xffff0000, v36
    v_fmac_f32 v60, v14, v70
    v_fmac_f32 v61, v14, v71
    v_lshlrev_b32 v70, 16, v37
    v_and_b32 v71, 0xffff0000, v37
    v_fmac_f32 v62, v14, v70
    v_fmac_f32 v63, v14, v71
    v_lshlrev_b32 v70, 16, v38
    v_and_b32 v71, 0xffff0000, v38
    v_fmac_f32 v64, v14, v70
    v_fmac_f32 v65, v14, v71
    v_lshlrev_b32 v70, 16, v39
    v_and_b32 v71, 0xffff0000, v39
    v_fmac_f32 v66, v14, v70
    v_fmac_f32 v67, v14, v71
    s_waitcnt vmcnt(3)
    v_lshlrev_b32 v70, 16, v40
    v_and_b32 v71, 0xffff0000, v40
    v_fmac_f32 v60, v15, v70
    v_fmac_f32 v61, v15, v71
    v_lshlrev_b32 v70, 16, v41
    v_and_b32 v71, 0xffff0000, v41
    v_fmac_f32 v62, v15, v70
    v_fmac_f32 v63, v15, v71
    v_lshlrev_b32 v70, 16, v42
    v_and_b32 v71, 0xffff0000, v42
    v_fmac_f32 v64, v15, v70
    v_fmac_f32 v65, v15, v71
    v_lshlrev_b32 v70, 16, v43
    v_and_b32 v71, 0xffff0000, v43
    v_fmac_f32 v66, v15, v70
    v_fmac_f32 v67, v15, v71
    s_waitcnt vmcnt(2)
    v_lshlrev_b32 v70, 16, v44
    v_and_b32 v71, 0xffff0000, v44
    v_fmac_f32 v60, v16, v70
    v_fmac_f32 v61, v16, v71
    v_lshlrev_b32 v70, 16, v45
    v_and_b32 v71, 0xffff0000, v45
    v_fmac_f32 v62, v16, v70
    v_fmac_f32 v63, v16, v71
    v_lshlrev_b32 v70, 16, v46
    v_and_b32 v71, 0xffff0000, v46
    v_fmac_f32 v64, v16, v70
    v_fmac_f32 v65, v16, v71
    v_lshlrev_b32 v70, 16, v47
    v_and_b32 v71, 0xffff0000, v47
    v_fmac_f32 v66, v16, v70
    v_fmac_f32 v67, v16, v71
    s_waitcnt vmcnt(1)
    v_lshlrev_b32 v70, 16, v48
    v_and_b32 v71, 0xffff0000, v48
    v_fmac_f32 v60, v17, v70
    v_fmac_f32 v61, v17, v71
    v_lshlrev_b32 v70, 16, v49
    v_and_b32 v71, 0xffff0000, v49
    v_fmac_f32 v62, v17, v70
    v_fmac_f32 v63, v17, v71
    v_lshlrev_b32 v70, 16, v50
    v_and_b32 v71, 0xffff0000, v50
    v_fmac_f32 v64, v17, v70
    v_fmac_f32 v65, v17, v71
    v_lshlrev_b32 v70, 16, v51
    v_and_b32 v71, 0xffff0000, v51
    v_fmac_f32 v66, v17, v70
    v_fmac_f32 v67, v17, v71
    s_waitcnt vmcnt(0)
    v_lshlrev_b32 v70, 16, v52
    v_and_b32 v71, 0xffff0000, v52
    v_fmac_f32 v60, v18, v70
    v_fmac_f32 v61, v18, v71
    v_lshlrev_b32 v70, 16, v53
    v_and_b32 v71, 0xffff0000, v53
    v_fmac_f32 v62, v18, v70
    v_fmac_f32 v63, v18, v71
    v_lshlrev_b32 v70, 16, v54
    v_and_b32 v71, 0xffff0000, v54
    v_fmac_f32 v64, v18, v70
    v_fmac_f32 v65, v18, v71
    v_lshlrev_b32 v70, 16, v55
    v_and_b32 v71, 0xffff0000, v55
    v_fmac_f32 v66, v18, v70
    v_fmac_f32 v67, v18, v71
    v_lshlrev_b32 v5, 7, v2
    v_lshlrev_b32 v6, 5, v1
    v_add_u32 v5, v5, v6
    ds_write_b128 v5, v[60:63]
    ds_write_b128 v5, v[64:67] offset:16
    s_waitcnt lgkmcnt(0)
    s_barrier
    v_readfirstlane_b32 s5, v0
    s_nop 0
    s_cmp_ge_u32 s5, 64
    s_cbranch_scc1 P1_END
    v_and_b32 v1, 31, v0
    v_lshrrev_b32 v2, 5, v0
    v_lshlrev_b32 v5, 12, v2
    v_lshlrev_b32 v6, 2, v1
    v_add_u32 v5, v5, v6
    v_mov_b32 v8, 0
    ds_read_b32 v10, v5 offset:0
    ds_read_b32 v11, v5 offset:128
    ds_read_b32 v12, v5 offset:256
    ds_read_b32 v13, v5 offset:384
    ds_read_b32 v14, v5 offset:512
    ds_read_b32 v15, v5 offset:640
    ds_read_b32 v16, v5 offset:768
    ds_read_b32 v17, v5 offset:896
    s_waitcnt lgkmcnt(0)
    v_add_f32 v8, v8, v10
    v_add_f32 v8, v8, v11
    v_add_f32 v8, v8, v12
    v_add_f32 v8, v8, v13
    v_add_f32 v8, v8, v14
    v_add_f32 v8, v8, v15
    v_add_f32 v8, v8, v16
    v_add_f32 v8, v8, v17
    ds_read_b32 v10, v5 offset:1024
    ds_read_b32 v11, v5 offset:1152
    ds_read_b32 v12, v5 offset:1280
    ds_read_b32 v13, v5 offset:1408
    ds_read_b32 v14, v5 offset:1536
    ds_read_b32 v15, v5 offset:1664
    ds_read_b32 v16, v5 offset:1792
    ds_read_b32 v17, v5 offset:1920
    s_waitcnt lgkmcnt(0)
    v_add_f32 v8, v8, v10
    v_add_f32 v8, v8, v11
    v_add_f32 v8, v8, v12
    v_add_f32 v8, v8, v13
    v_add_f32 v8, v8, v14
    v_add_f32 v8, v8, v15
    v_add_f32 v8, v8, v16
    v_add_f32 v8, v8, v17
    ds_read_b32 v10, v5 offset:2048
    ds_read_b32 v11, v5 offset:2176
    ds_read_b32 v12, v5 offset:2304
    ds_read_b32 v13, v5 offset:2432
    ds_read_b32 v14, v5 offset:2560
    ds_read_b32 v15, v5 offset:2688
    ds_read_b32 v16, v5 offset:2816
    ds_read_b32 v17, v5 offset:2944
    s_waitcnt lgkmcnt(0)
    v_add_f32 v8, v8, v10
    v_add_f32 v8, v8, v11
    v_add_f32 v8, v8, v12
    v_add_f32 v8, v8, v13
    v_add_f32 v8, v8, v14
    v_add_f32 v8, v8, v15
    v_add_f32 v8, v8, v16
    v_add_f32 v8, v8, v17
    ds_read_b32 v10, v5 offset:3072
    ds_read_b32 v11, v5 offset:3200
    ds_read_b32 v12, v5 offset:3328
    ds_read_b32 v13, v5 offset:3456
    ds_read_b32 v14, v5 offset:3584
    ds_read_b32 v15, v5 offset:3712
    ds_read_b32 v16, v5 offset:3840
    ds_read_b32 v17, v5 offset:3968
    s_waitcnt lgkmcnt(0)
    v_add_f32 v8, v8, v10
    v_add_f32 v8, v8, v11
    v_add_f32 v8, v8, v12
    v_add_f32 v8, v8, v13
    v_add_f32 v8, v8, v14
    v_add_f32 v8, v8, v15
    v_add_f32 v8, v8, v16
    v_add_f32 v8, v8, v17
    v_mov_b32 v9, v8
    s_nop 1
    v_permlane32_swap_b32 v8, v9
    v_add_f32 v8, v8, v9
    v_cvt_pk_bf16_f32 v8, v8, v8
    v_lshlrev_b32 v8, 16, v8
    s_mul_i32 s5, s2, 3641
    s_lshr_b32 s5, s5, 16
    s_cmp_eq_u32 s5, 1
    s_cselect_b32 s6, 1, 0
    s_cmp_eq_u32 s5, 4
    s_cselect_b32 s6, 1, s6
    s_cmp_eq_u32 s6, 0
    s_cbranch_scc1 P1_MOD_ST
    v_add_f32 v8, 1.0, v8
    v_cvt_pk_bf16_f32 v8, v8, v8
    v_lshlrev_b32 v8, 16, v8
P1_MOD_ST:
    s_lshl_b32 s3, s2, 7
    v_add_u32 v6, s3, v6
    s_mov_b32 exec_hi, 0
    buffer_store_dword v8, v6, s[16:19], 0 offen
    s_branch P1_END
P1_TR:
    s_sub_u32 s2, s2, 108
    s_cmp_ge_u32 s2, 64
    s_nop 0
    s_cbranch_scc1 P1_W2
    s_load_dwordx2 s[8:9], s[0:1], 0
    s_load_dwordx2 s[16:17], s[0:1], 136
    v_lshrrev_b32 v1, 3, v0
    v_and_b32 v2, 7, v0
    s_lshl_b32 s3, s2, 5
    v_add_u32 v3, s3, v1
    v_mul_u32_u24 v3, 1152, v3
    v_lshlrev_b32 v4, 4, v2
    v_add_u32 v3, v3, v4
    v_mul_u32_u24 v5, 1184, v1
    v_add_u32 v5, v5, v4
    s_waitcnt lgkmcnt(0)
    s_mov_b32 s10, 0x240000
    s_mov_b32 s11, 0x00020000
    s_mov_b32 s12, s16
    s_mov_b32 s13, s17
    s_mov_b32 s14, 0x240000
    s_mov_b32 s15, 0x00020000
    s_add_u32 s20, s16, 0x300000
    s_addc_u32 s21, s17, 0
    s_mov_b32 s22, 0x4000
    s_mov_b32 s23, 0x00020000
    s_add_u32 s28, s16, 0x320000
    s_addc_u32 s29, s17, 0
    s_mov_b32 s30, 0x34000
    s_mov_b32 s31, 0x00020000
    v_mov_b32 v60, 0
    v_mov_b32 v61, 0
    v_mov_b32 v62, 0
    v_mov_b32 v63, 0
    v_lshlrev_b32 v6, 4, v0
    s_lshl_b32 s4, s2, 8
    v_cmp_gt_u32 vcc, 16, v0
    s_nop 0
    s_and_saveexec_b64 s[24:25], vcc
    s_cbranch_execz P1_Z_1
    buffer_store_dwordx4 v[60:63], v6, s[28:31], s4 offen
    s_add_u32 s4, s4, 0x30000
    buffer_store_dwordx4 v[60:63], v6, s[28:31], s4 offen
P1_Z_1:
    s_mov_b64 exec, s[24:25]
    buffer_load_dwordx4 v[20:23], v3, s[8:11], 0 offen offset:0
    buffer_load_dwordx4 v[24:27], v3, s[8:11], 0 offen offset:128
    buffer_load_dwordx4 v[28:31], v3, s[8:11], 0 offen offset:256
    buffer_load_dwordx4 v[32:35], v3, s[8:11], 0 offen offset:384
    buffer_load_dwordx4 v[36:39], v3, s[8:11], 0 offen offset:512
    buffer_load_dwordx4 v[40:43], v3, s[8:11], 0 offen offset:640
    buffer_load_dwordx4 v[44:47], v3, s[8:11], 0 offen offset:768
    buffer_load_dwordx4 v[48:51], v3, s[8:11], 0 offen offset:896
    buffer_load_dwordx4 v[52:55], v3, s[8:11], 0 offen offset:1024
    v_mov_b32 v6, 0
    v_mov_b32 v7, 0
    v_mov_b32 v8, 0x3f803f80
    s_waitcnt vmcnt(8)
    ds_write_b128 v5, v[20:23] offset:0
    v_dot2_f32_bf16 v6, v20, v8, v6
    v_dot2_f32_bf16 v7, v20, v20, v7
    v_dot2_f32_bf16 v6, v21, v8, v6
    v_dot2_f32_bf16 v7, v21, v21, v7
    v_dot2_f32_bf16 v6, v22, v8, v6
    v_dot2_f32_bf16 v7, v22, v22, v7
    v_dot2_f32_bf16 v6, v23, v8, v6
    v_dot2_f32_bf16 v7, v23, v23, v7
    s_waitcnt vmcnt(7)
    ds_write_b128 v5, v[24:27] offset:128
    v_dot2_f32_bf16 v6, v24, v8, v6
    v_dot2_f32_bf16 v7, v24, v24, v7
    v_dot2_f32_bf16 v6, v25, v8, v6
    v_dot2_f32_bf16 v7, v25, v25, v7
    v_dot2_f32_bf16 v6, v26, v8, v6
    v_dot2_f32_bf16 v7, v26, v26, v7
    v_dot2_f32_bf16 v6, v27, v8, v6
    v_dot2_f32_bf16 v7, v27, v27, v7
    s_waitcnt vmcnt(6)
    ds_write_b128 v5, v[28:31] offset:256
    v_dot2_f32_bf16 v6, v28, v8, v6
    v_dot2_f32_bf16 v7, v28, v28, v7
    v_dot2_f32_bf16 v6, v29, v8, v6
    v_dot2_f32_bf16 v7, v29, v29, v7
    v_dot2_f32_bf16 v6, v30, v8, v6
    v_dot2_f32_bf16 v7, v30, v30, v7
    v_dot2_f32_bf16 v6, v31, v8, v6
    v_dot2_f32_bf16 v7, v31, v31, v7
    s_waitcnt vmcnt(5)
    ds_write_b128 v5, v[32:35] offset:384
    v_dot2_f32_bf16 v6, v32, v8, v6
    v_dot2_f32_bf16 v7, v32, v32, v7
    v_dot2_f32_bf16 v6, v33, v8, v6
    v_dot2_f32_bf16 v7, v33, v33, v7
    v_dot2_f32_bf16 v6, v34, v8, v6
    v_dot2_f32_bf16 v7, v34, v34, v7
    v_dot2_f32_bf16 v6, v35, v8, v6
    v_dot2_f32_bf16 v7, v35, v35, v7
    s_waitcnt vmcnt(4)
    ds_write_b128 v5, v[36:39] offset:512
    v_dot2_f32_bf16 v6, v36, v8, v6
    v_dot2_f32_bf16 v7, v36, v36, v7
    v_dot2_f32_bf16 v6, v37, v8, v6
    v_dot2_f32_bf16 v7, v37, v37, v7
    v_dot2_f32_bf16 v6, v38, v8, v6
    v_dot2_f32_bf16 v7, v38, v38, v7
    v_dot2_f32_bf16 v6, v39, v8, v6
    v_dot2_f32_bf16 v7, v39, v39, v7
    s_waitcnt vmcnt(3)
    ds_write_b128 v5, v[40:43] offset:640
    v_dot2_f32_bf16 v6, v40, v8, v6
    v_dot2_f32_bf16 v7, v40, v40, v7
    v_dot2_f32_bf16 v6, v41, v8, v6
    v_dot2_f32_bf16 v7, v41, v41, v7
    v_dot2_f32_bf16 v6, v42, v8, v6
    v_dot2_f32_bf16 v7, v42, v42, v7
    v_dot2_f32_bf16 v6, v43, v8, v6
    v_dot2_f32_bf16 v7, v43, v43, v7
    s_waitcnt vmcnt(2)
    ds_write_b128 v5, v[44:47] offset:768
    v_dot2_f32_bf16 v6, v44, v8, v6
    v_dot2_f32_bf16 v7, v44, v44, v7
    v_dot2_f32_bf16 v6, v45, v8, v6
    v_dot2_f32_bf16 v7, v45, v45, v7
    v_dot2_f32_bf16 v6, v46, v8, v6
    v_dot2_f32_bf16 v7, v46, v46, v7
    v_dot2_f32_bf16 v6, v47, v8, v6
    v_dot2_f32_bf16 v7, v47, v47, v7
    s_waitcnt vmcnt(1)
    ds_write_b128 v5, v[48:51] offset:896
    v_dot2_f32_bf16 v6, v48, v8, v6
    v_dot2_f32_bf16 v7, v48, v48, v7
    v_dot2_f32_bf16 v6, v49, v8, v6
    v_dot2_f32_bf16 v7, v49, v49, v7
    v_dot2_f32_bf16 v6, v50, v8, v6
    v_dot2_f32_bf16 v7, v50, v50, v7
    v_dot2_f32_bf16 v6, v51, v8, v6
    v_dot2_f32_bf16 v7, v51, v51, v7
    s_waitcnt vmcnt(0)
    ds_write_b128 v5, v[52:55] offset:1024
    v_dot2_f32_bf16 v6, v52, v8, v6
    v_dot2_f32_bf16 v7, v52, v52, v7
    v_dot2_f32_bf16 v6, v53, v8, v6
    v_dot2_f32_bf16 v7, v53, v53, v7
    v_dot2_f32_bf16 v6, v54, v8, v6
    v_dot2_f32_bf16 v7, v54, v54, v7
    v_dot2_f32_bf16 v6, v55, v8, v6
    v_dot2_f32_bf16 v7, v55, v55, v7
    s_nop 1
    v_add_f32_dpp v6, v6, v6 quad_perm:[1,0,3,2] row_mask:0xf bank_mask:0xf
    v_add_f32_dpp v7, v7, v7 quad_perm:[1,0,3,2] row_mask:0xf bank_mask:0xf
    s_nop 0
    v_add_f32_dpp v6, v6, v6 quad_perm:[2,3,0,1] row_mask:0xf bank_mask:0xf
    v_add_f32_dpp v7, v7, v7 quad_perm:[2,3,0,1] row_mask:0xf bank_mask:0xf
    s_nop 0
    v_add_f32_dpp v6, v6, v6 row_half_mirror row_mask:0xf bank_mask:0xf
    v_add_f32_dpp v7, v7, v7 row_half_mirror row_mask:0xf bank_mask:0xf
    v_mul_f32 v6, 0x3ae38e39, v6
    v_mul_f32 v7, 0x3ae38e39, v7
    v_fma_f32 v7, -v6, v6, v7
    v_max_f32 v7, 0, v7
    v_cvt_pk_bf16_f32 v6, v6, v6
    v_lshlrev_b32 v6, 16, v6
    v_cvt_pk_bf16_f32 v7, v7, v7
    v_lshlrev_b32 v7, 16, v7
    v_add_f32 v7, 0x3727c5ac, v7
    v_cvt_pk_bf16_f32 v7, v7, v7
    v_lshlrev_b32 v7, 16, v7
    v_sqrt_f32 v7, v7
    s_nop 0
    v_cvt_pk_bf16_f32 v7, v7, v7
    v_lshlrev_b32 v7, 16, v7
    v_rcp_f32 v7, v7
    s_nop 0
    v_mul_f32 v6, -v6, v7
    v_add_u32 v9, s3, v1
    v_lshlrev_b32 v9, 2, v9
    v_cmp_eq_u32 vcc, 0, v2
    s_nop 0
    s_and_saveexec_b64 s[24:25], vcc
    buffer_store_dword v7, v9, s[20:23], 0 offen
    s_movk_i32 s4, 0x2000
    buffer_store_dword v6, v9, s[20:23], s4 offen
    s_mov_b64 exec, s[24:25]
    s_waitcnt lgkmcnt(0)
    s_barrier
    v_and_b32 v1, 63, v0
    v_lshrrev_b32 v2, 4, v1
    v_and_b32 v3, 15, v1
    v_lshrrev_b32 v4, 2, v3
    v_and_b32 v5, 3, v1
    v_lshlrev_b32 v6, 3, v2
    v_add_u32 v6, v6, v4
    v_mul_u32_u24 v6, 1184, v6
    v_lshlrev_b32 v5, 3, v5
    v_add_u32 v6, v6, v5
    v_lshrrev_b32 v7, 6, v0
    v_mul_u32_u24 v8, 288, v7
    v_add_u32 v6, v6, v8
    v_mul_u32_u24 v8, 144, v7
    v_add_u32 v8, v8, v3
    v_lshlrev_b32 v8, 12, v8
    v_lshlrev_b32 v9, 4, v2
    v_add_u32 v8, v8, v9
    s_lshl_b32 s4, s3, 1
    v_add_u32 v8, s4, v8
    ds_read_b64_tr_b16 v[20:21], v6 offset:0
    ds_read_b64_tr_b16 v[22:23], v6 offset:4736
    ds_read_b64_tr_b16 v[24:25], v6 offset:32
    ds_read_b64_tr_b16 v[26:27], v6 offset:4768
    ds_read_b64_tr_b16 v[28:29], v6 offset:64
    ds_read_b64_tr_b16 v[30:31], v6 offset:4800
    ds_read_b64_tr_b16 v[32:33], v6 offset:96
    ds_read_b64_tr_b16 v[34:35], v6 offset:4832
    ds_read_b64_tr_b16 v[36:37], v6 offset:128
    ds_read_b64_tr_b16 v[38:39], v6 offset:4864
    ds_read_b64_tr_b16 v[40:41], v6 offset:160
    ds_read_b64_tr_b16 v[42:43], v6 offset:4896
    ds_read_b64_tr_b16 v[44:45], v6 offset:192
    ds_read_b64_tr_b16 v[46:47], v6 offset:4928
    ds_read_b64_tr_b16 v[48:49], v6 offset:224
    ds_read_b64_tr_b16 v[50:51], v6 offset:4960
    ds_read_b64_tr_b16 v[52:53], v6 offset:256
    ds_read_b64_tr_b16 v[54:55], v6 offset:4992
    s_mov_b32 s4, 0
    s_waitcnt lgkmcnt(14)
    buffer_store_dwordx4 v[20:23], v8, s[12:15], s4 offen
    s_add_u32 s4, s4, 0x10000
    s_waitcnt lgkmcnt(14)
    buffer_store_dwordx4 v[24:27], v8, s[12:15], s4 offen
    s_add_u32 s4, s4, 0x10000
    s_waitcnt lgkmcnt(12)
    buffer_store_dwordx4 v[28:31], v8, s[12:15], s4 offen
    s_add_u32 s4, s4, 0x10000
    s_waitcnt lgkmcnt(10)
    buffer_store_dwordx4 v[32:35], v8, s[12:15], s4 offen
    s_add_u32 s4, s4, 0x10000
    s_waitcnt lgkmcnt(8)
    buffer_store_dwordx4 v[36:39], v8, s[12:15], s4 offen
    s_add_u32 s4, s4, 0x10000
    s_waitcnt lgkmcnt(6)
    buffer_store_dwordx4 v[40:43], v8, s[12:15], s4 offen
    s_add_u32 s4, s4, 0x10000
    s_waitcnt lgkmcnt(4)
    buffer_store_dwordx4 v[44:47], v8, s[12:15], s4 offen
    s_add_u32 s4, s4, 0x10000
    s_waitcnt lgkmcnt(2)
    buffer_store_dwordx4 v[48:51], v8, s[12:15], s4 offen
    s_add_u32 s4, s4, 0x10000
    s_waitcnt lgkmcnt(0)
    buffer_store_dwordx4 v[52:55], v8, s[12:15], s4 offen
    s_branch P1_END
P1_W2:
    s_sub_u32 s2, s2, 64
    s_load_dwordx2 s[8:9], s[0:1], 96
    s_load_dwordx2 s[16:17], s[0:1], 136
    v_lshrrev_b32 v1, 6, v0
    s_nop 0
    v_readfirstlane_b32 s4, v1
    v_and_b32 v1, 63, v0
    v_lshlrev_b32 v2, 4, v0
    s_mul_i32 s40, s2, 57
    s_lshr_b32 s40, s40, 9
    s_mul_i32 s41, s40, 9
    s_sub_u32 s41, s2, s41
    s_lshl_b32 s42, s40, 1
    s_lshr_b32 s43, s41, 2
    s_add_u32 s42, s42, s43
    s_mul_i32 s42, s42, 144
    s_bfe_u32 s43, s41, 0x10001
    s_mul_i32 s43, s43, 80
    s_add_u32 s42, s42, s43
    s_and_b32 s43, s41, 1
    s_lshl_b32 s43, s43, 5
    s_add_u32 s42, s42, s43
    s_mul_i32 s43, s40, 288
    s_add_u32 s43, s43, 64
    s_cmp_eq_u32 s41, 8
    s_cselect_b32 s42, s43, s42
    s_cselect_b32 s30, 1, 0
    s_mul_i32 s5, s42, 1152
    s_mul_i32 s31, s30, 147456
    s_lshl_b32 s6, s4, 10
    s_waitcnt lgkmcnt(0)
    s_mov_b32 s10, 0x510000
    s_mov_b32 s11, 0x00020000
    s_add_u32 s12, s16, 0x3400000
    s_addc_u32 s13, s17, 0
    s_mov_b32 s14, 0x510000
    s_mov_b32 s15, 0x00020000
    s_add_u32 m0, s6, 0
    s_nop 0
    buffer_load_dwordx4 v2, s[8:11], s5 offen lds
    s_add_u32 s5, s5, 4096
    s_add_u32 m0, s6, 4096
    s_nop 0
    buffer_load_dwordx4 v2, s[8:11], s5 offen lds
    s_add_u32 s5, s5, 4096
    s_add_u32 m0, s6, 8192
    s_nop 0
    buffer_load_dwordx4 v2, s[8:11], s5 offen lds
    s_add_u32 s5, s5, 4096
    s_add_u32 m0, s6, 12288
    s_nop 0
    buffer_load_dwordx4 v2, s[8:11], s5 offen lds
    s_add_u32 s5, s5, 4096
    s_add_u32 m0, s6, 16384
    s_cmp_ge_u32 s4, 2
    s_cselect_b32 s29, s31, 0
    s_add_u32 s29, s29, s5
    buffer_load_dwordx4 v2, s[8:11], s29 offen lds
    s_add_u32 s5, s5, s31
    s_add_u32 s5, s5, 4096
    s_add_u32 m0, s6, 20480
    s_nop 0
    buffer_load_dwordx4 v2, s[8:11], s5 offen lds
    s_add_u32 s5, s5, 4096
    s_add_u32 m0, s6, 24576
    s_nop 0
    buffer_load_dwordx4 v2, s[8:11], s5 offen lds
    s_add_u32 s5, s5, 4096
    s_add_u32 m0, s6, 28672
    s_nop 0
    buffer_load_dwordx4 v2, s[8:11], s5 offen lds
    s_add_u32 s5, s5, 4096
    s_add_u32 m0, s6, 32768
    s_nop 0
    buffer_load_dwordx4 v2, s[8:11], s5 offen lds
    v_lshrrev_b32 v4, 4, v1
    v_and_b32 v5, 15, v1
    v_lshrrev_b32 v5, 2, v5
    s_add_u32 s29, s30, 2
    v_lshlrev_b32 v4, s29, v4
    v_add_u32 v4, v4, v5
    v_mul_u32_u24 v4, 1152, v4
    v_and_b32 v5, 3, v1
    v_lshlrev_b32 v5, 3, v5
    v_add_u32 v4, v4, v5
    s_mul_i32 s7, s4, 288
    v_add_u32 v4, s7, v4
    s_cmp_eq_u32 s30, 1
    s_mov_b32 s7, 18432
    s_cselect_b32 s7, 4608, s7
    v_add_u32 v7, s7, v4
    v_lshlrev_b32 v6, 4, v1
    s_mul_i32 s5, s2, 36864
    s_mul_i32 s7, s4, 9216
    s_add_u32 s5, s5, s7
    s_waitcnt vmcnt(0)
    s_barrier
    ds_read_b64_tr_b16 v[20:21], v4 offset:0
    ds_read_b64_tr_b16 v[22:23], v7 offset:0
    ds_read_b64_tr_b16 v[24:25], v4 offset:32
    ds_read_b64_tr_b16 v[26:27], v7 offset:32
    ds_read_b64_tr_b16 v[28:29], v4 offset:64
    ds_read_b64_tr_b16 v[30:31], v7 offset:64
    ds_read_b64_tr_b16 v[32:33], v4 offset:96
    ds_read_b64_tr_b16 v[34:35], v7 offset:96
    ds_read_b64_tr_b16 v[36:37], v4 offset:128
    ds_read_b64_tr_b16 v[38:39], v7 offset:128
    ds_read_b64_tr_b16 v[40:41], v4 offset:160
    ds_read_b64_tr_b16 v[42:43], v7 offset:160
    ds_read_b64_tr_b16 v[44:45], v4 offset:192
    ds_read_b64_tr_b16 v[46:47], v7 offset:192
    ds_read_b64_tr_b16 v[48:49], v4 offset:224
    ds_read_b64_tr_b16 v[50:51], v7 offset:224
    ds_read_b64_tr_b16 v[52:53], v4 offset:256
    ds_read_b64_tr_b16 v[54:55], v7 offset:256
    s_waitcnt lgkmcnt(14)
    buffer_store_dwordx4 v[20:23], v6, s[12:15], s5 offen offset:0
    s_waitcnt lgkmcnt(14)
    buffer_store_dwordx4 v[24:27], v6, s[12:15], s5 offen offset:1024
    s_waitcnt lgkmcnt(12)
    buffer_store_dwordx4 v[28:31], v6, s[12:15], s5 offen offset:2048
    s_waitcnt lgkmcnt(10)
    buffer_store_dwordx4 v[32:35], v6, s[12:15], s5 offen offset:3072
    s_waitcnt lgkmcnt(8)
    s_add_u32 s5, s5, 4096
    buffer_store_dwordx4 v[36:39], v6, s[12:15], s5 offen offset:0
    s_waitcnt lgkmcnt(6)
    buffer_store_dwordx4 v[40:43], v6, s[12:15], s5 offen offset:1024
    s_waitcnt lgkmcnt(4)
    buffer_store_dwordx4 v[44:47], v6, s[12:15], s5 offen offset:2048
    s_waitcnt lgkmcnt(2)
    buffer_store_dwordx4 v[48:51], v6, s[12:15], s5 offen offset:3072
    s_waitcnt lgkmcnt(0)
    s_add_u32 s5, s5, 4096
    buffer_store_dwordx4 v[52:55], v6, s[12:15], s5 offen offset:0
    s_branch P1_END
P1_END:
    s_endpgm
.globl p2_kernel
.p2align 8
.type p2_kernel,@function
p2_kernel:
    s_cmp_ge_u32 s2, 256
    s_cbranch_scc1 P2_END
    s_cmp_ge_u32 s2, 192
    s_nop 0
    s_cbranch_scc1 P2_CS
    s_load_dwordx2 s[8:9], s[0:1], 136
    s_load_dwordx2 s[12:13], s[0:1], 64
    v_lshrrev_b32 v1, 6, v0
    s_nop 0
    v_readfirstlane_b32 s4, v1
    v_and_b32 v1, 63, v0
    s_lshr_b32 s5, s4, 1
    s_and_b32 s6, s4, 1
    s_mul_i32 s7, s2, 3
    s_add_u32 s7, s7, s5
    s_mul_i32 s16, s5, 33536
    v_lshlrev_b32 v2, 4, v1
    s_mov_b32 s92, s2
    s_mov_b32 s93, s4
    s_waitcnt lgkmcnt(0)
    s_lshl_b32 s17, s7, 2
    s_add_u32 s17, s17, 0x310000
    s_add_u32 s18, s8, s17
    s_addc_u32 s19, s9, 0
    s_load_dword s40, s[18:19], 0
    s_load_dword s41, s[18:19], 2304
    s_load_dword s42, s[18:19], 4608
    s_load_dword s43, s[18:19], 9216
    s_add_u32 s20, s8, 0x400000
    s_addc_u32 s21, s9, 0
    s_mov_b32 s22, 0x244800
    s_mov_b32 s23, 0x00020000
    s_mov_b32 s24, s8
    s_mov_b32 s25, s9
    s_mov_b32 s26, 0x240000
    s_mov_b32 s27, 0x00020000
    s_add_u32 s28, s8, 0x300000
    s_addc_u32 s29, s9, 0
    s_mov_b32 s30, 0x4000
    s_mov_b32 s31, 0x00020000
    s_add_u32 s32, s8, 0x800000
    s_addc_u32 s33, s9, 0
    s_mov_b32 s34, 0x240000
    s_mov_b32 s35, 0x00020000
    s_add_u32 s36, s8, 0xb00000
    s_addc_u32 s37, s9, 0
    s_mov_b32 s38, 0x240000
    s_mov_b32 s39, 0x00020000
    s_mov_b32 s14, 0x480
    s_mov_b32 s15, 0x00020000
    s_mul_i32 s44, s7, 4128
    s_lshl_b32 s45, s6, 2
    s_add_u32 s44, s44, s45
    s_mul_i32 s45, s6, 8320
    s_add_u32 s45, s45, s16
    s_mov_b32 m0, s45
    s_nop 0
    buffer_load_dwordx4 v2, s[20:23], s44 offen offset:0 lds
    buffer_load_dwordx4 v2, s[20:23], s44 offen offset:1024 lds
    buffer_load_dwordx4 v2, s[20:23], s44 offen offset:2048 lds
    buffer_load_dwordx4 v2, s[20:23], s44 offen offset:3072 lds
    s_add_u32 s44, s44, 2
    s_add_u32 s45, s45, 4160
    s_mov_b32 m0, s45
    s_nop 0
    buffer_load_dwordx4 v2, s[20:23], s44 offen offset:0 lds
    buffer_load_dwordx4 v2, s[20:23], s44 offen offset:1024 lds
    buffer_load_dwordx4 v2, s[20:23], s44 offen offset:2048 lds
    buffer_load_dwordx4 v2, s[20:23], s44 offen offset:3072 lds
    s_lshl_b32 s44, s7, 12
    s_lshl_b32 s45, s6, 11
    s_add_u32 s44, s44, s45
    buffer_load_dwordx4 v[10:13], v2, s[24:27], s44 offen
    buffer_load_dwordx4 v[14:17], v2, s[24:27], s44 offen offset:1024
    v_lshlrev_b32 v3, 5, v1
    s_lshl_b32 s45, s6, 12
    s_add_u32 s46, s45, 8192
    buffer_load_dwordx4 v[20:23], v3, s[28:31], s45 offen offset:0
    buffer_load_dwordx4 v[24:27], v3, s[28:31], s45 offen offset:16
    buffer_load_dwordx4 v[28:31], v3, s[28:31], s46 offen offset:0
    buffer_load_dwordx4 v[32:35], v3, s[28:31], s46 offen offset:16
    buffer_load_dwordx4 v[36:39], v3, s[28:31], s45 offen offset:2048
    buffer_load_dwordx4 v[40:43], v3, s[28:31], s45 offen offset:2064
    buffer_load_dwordx4 v[44:47], v3, s[28:31], s46 offen offset:2048
    buffer_load_dwordx4 v[48:51], v3, s[28:31], s46 offen offset:2064
    s_lshl_b32 s47, s7, 1
    v_mov_b32 v4, s47
    buffer_load_ushort v5, v4, s[12:15], 0 offen
    v_mov_b32 v60, 0
    v_mov_b32 v61, 0
    v_mov_b32 v62, 0
    v_mov_b32 v63, 0
    v_lshrrev_b32 v6, 1, v1
    v_mul_u32_u24 v6, 4160, v6
    v_and_b32 v7, 1, v1
    v_lshlrev_b32 v7, 4, v7
    v_add_u32 v6, v6, v7
    s_mul_i32 s45, s6, 8320
    s_add_u32 s45, s45, s16
    v_add_u32 v6, s45, v6
    s_mov_b64 exec, 0xf
    ds_write_b128 v6, v[60:63] offset:4096
    s_mov_b64 exec, 0x3fffffff
    v_add_u32 v6, s16, v2
    ds_write_b128 v6, v[60:63] offset:16640
    s_mov_b64 exec, -1
    s_lshl_b32 s45, s6, 11
    s_add_u32 s45, s45, s16
    v_add_u32 v6, s45, v2
    s_waitcnt lgkmcnt(0)
    v_mov_b32 v7, s40
    s_waitcnt vmcnt(5)
    v_lshlrev_b32 v64, 16, v10
    v_and_b32 v65, 0xffff0000, v10
    v_fma_f32 v64, v64, v20, v28
    v_fma_f32 v65, v65, v21, v29
    v_fma_f32 v64, v64, s41, v7
    v_fma_f32 v65, v65, s41, v7
    v_cvt_pk_bf16_f32 v66, v64, v65
    v_lshlrev_b32 v64, 16, v11
    v_and_b32 v65, 0xffff0000, v11
    v_fma_f32 v64, v64, v22, v30
    v_fma_f32 v65, v65, v23, v31
    v_fma_f32 v64, v64, s41, v7
    v_fma_f32 v65, v65, s41, v7
    v_cvt_pk_bf16_f32 v67, v64, v65
    v_lshlrev_b32 v64, 16, v12
    v_and_b32 v65, 0xffff0000, v12
    v_fma_f32 v64, v64, v24, v32
    v_fma_f32 v65, v65, v25, v33
    v_fma_f32 v64, v64, s41, v7
    v_fma_f32 v65, v65, s41, v7
    v_cvt_pk_bf16_f32 v68, v64, v65
    v_lshlrev_b32 v64, 16, v13
    v_and_b32 v65, 0xffff0000, v13
    v_fma_f32 v64, v64, v26, v34
    v_fma_f32 v65, v65, v27, v35
    v_fma_f32 v64, v64, s41, v7
    v_fma_f32 v65, v65, s41, v7
    v_cvt_pk_bf16_f32 v69, v64, v65
    ds_write_b128 v6, v[66:69] offset:17120
    ds_write_b128 v6, v[10:13] offset:21248
    s_waitcnt vmcnt(1)
    v_lshlrev_b32 v64, 16, v14
    v_and_b32 v65, 0xffff0000, v14
    v_fma_f32 v64, v64, v36, v44
    v_fma_f32 v65, v65, v37, v45
    v_fma_f32 v64, v64, s41, v7
    v_fma_f32 v65, v65, s41, v7
    v_cvt_pk_bf16_f32 v66, v64, v65
    v_lshlrev_b32 v64, 16, v15
    v_and_b32 v65, 0xffff0000, v15
    v_fma_f32 v64, v64, v38, v46
    v_fma_f32 v65, v65, v39, v47
    v_fma_f32 v64, v64, s41, v7
    v_fma_f32 v65, v65, s41, v7
    v_cvt_pk_bf16_f32 v67, v64, v65
    v_lshlrev_b32 v64, 16, v16
    v_and_b32 v65, 0xffff0000, v16
    v_fma_f32 v64, v64, v40, v48
    v_fma_f32 v65, v65, v41, v49
    v_fma_f32 v64, v64, s41, v7
    v_fma_f32 v65, v65, s41, v7
    v_cvt_pk_bf16_f32 v68, v64, v65
    v_lshlrev_b32 v64, 16, v17
    v_and_b32 v65, 0xffff0000, v17
    v_fma_f32 v64, v64, v42, v50
    v_fma_f32 v65, v65, v43, v51
    v_fma_f32 v64, v64, s41, v7
    v_fma_f32 v65, v65, s41, v7
    v_cvt_pk_bf16_f32 v69, v64, v65
    ds_write_b128 v6, v[66:69] offset:18144
    ds_write_b128 v6, v[14:17] offset:22272
    v_and_b32 v8, 15, v1
    v_lshrrev_b32 v9, 4, v1
    v_sub_u32 v10, 3, v8
    v_and_b32 v10, 3, v10
    v_mul_u32_u24 v10, 4160, v10
    v_lshrrev_b32 v11, 2, v8
    v_lshlrev_b32 v11, 3, v11
    v_sub_u32 v10, v10, v11
    v_lshlrev_b32 v11, 4, v9
    v_add_u32 v10, v10, v11
    s_lshl_b32 s45, s6, 8
    s_sub_u32 s45, 2328, s45
    s_add_u32 s45, s45, s16
    v_add_u32 v10, s45, v10
    v_subrev_u32 v11, 2048, v10
    v_lshlrev_b32 v12, 5, v8
    v_lshlrev_b32 v13, 4, v9
    v_add_u32 v12, v12, v13
    s_lshl_b32 s45, s6, 8
    s_sub_u32 s45, 16896, s45
    s_add_u32 s45, s45, s16
    v_add_u32 v12, s45, v12
    s_waitcnt vmcnt(0) lgkmcnt(0)
    s_barrier
    ds_read2_b64 v[48:51], v10 offset0:216 offset1:217
    ds_read_b128 v[80:83], v12 offset:192
    ds_read_b128 v[84:87], v12 offset:704
    ds_read_b128 v[88:91], v12 offset:1216
    ds_read_b128 v[92:95], v12 offset:1728
    ds_read_b128 v[96:99], v12 offset:2240
    ds_read_b128 v[100:103], v12 offset:2752
    ds_read_b128 v[104:107], v12 offset:3264
    ds_read_b128 v[108:111], v12 offset:3776
    ds_read2_b64 v[52:55], v10 offset0:152 offset1:153
    ds_read2_b64 v[56:59], v10 offset0:88 offset1:89
    ds_read2_b64 v[60:63], v10 offset0:24 offset1:25
    ds_read2_b64 v[64:67], v11 offset0:216 offset1:217
    ds_read2_b64 v[68:71], v11 offset0:152 offset1:153
    ds_read2_b64 v[72:75], v11 offset0:88 offset1:89
    ds_read2_b64 v[76:79], v11 offset0:24 offset1:25
    s_waitcnt lgkmcnt(0)
    v_mfma_f32_16x16x32_bf16 v[16:19], v[48:51], v[80:83], 0
    v_mfma_f32_16x16x32_bf16 v[20:23], v[48:51], v[84:87], 0
    ds_read2_b64 v[112:115], v10 offset0:208 offset1:209
    v_mfma_f32_16x16x32_bf16 v[24:27], v[48:51], v[88:91], 0
    v_mfma_f32_16x16x32_bf16 v[28:31], v[48:51], v[92:95], 0
    ds_read_b128 v[144:147], v12 offset:128
    v_mfma_f32_16x16x32_bf16 v[32:35], v[48:51], v[96:99], 0
    v_mfma_f32_16x16x32_bf16 v[36:39], v[48:51], v[100:103], 0
    ds_read_b128 v[148:151], v12 offset:640
    v_mfma_f32_16x16x32_bf16 v[40:43], v[48:51], v[104:107], 0
    v_mfma_f32_16x16x32_bf16 v[44:47], v[48:51], v[108:111], 0
    ds_read_b128 v[152:155], v12 offset:1152
    v_mfma_f32_16x16x32_bf16 v[20:23], v[52:55], v[80:83], v[20:23]
    v_mfma_f32_16x16x32_bf16 v[24:27], v[52:55], v[84:87], v[24:27]
    ds_read_b128 v[156:159], v12 offset:1664
    v_mfma_f32_16x16x32_bf16 v[28:31], v[52:55], v[88:91], v[28:31]
    v_mfma_f32_16x16x32_bf16 v[32:35], v[52:55], v[92:95], v[32:35]
    ds_read_b128 v[160:163], v12 offset:2176
    v_mfma_f32_16x16x32_bf16 v[36:39], v[52:55], v[96:99], v[36:39]
    v_mfma_f32_16x16x32_bf16 v[40:43], v[52:55], v[100:103], v[40:43]
    ds_read_b128 v[164:167], v12 offset:2688
    v_mfma_f32_16x16x32_bf16 v[44:47], v[52:55], v[104:107], v[44:47]
    v_mfma_f32_16x16x32_bf16 v[24:27], v[56:59], v[80:83], v[24:27]
    ds_read_b128 v[168:171], v12 offset:3200
    v_mfma_f32_16x16x32_bf16 v[28:31], v[56:59], v[84:87], v[28:31]
    v_mfma_f32_16x16x32_bf16 v[32:35], v[56:59], v[88:91], v[32:35]
    ds_read_b128 v[172:175], v12 offset:3712
    v_mfma_f32_16x16x32_bf16 v[36:39], v[56:59], v[92:95], v[36:39]
    v_mfma_f32_16x16x32_bf16 v[40:43], v[56:59], v[96:99], v[40:43]
    ds_read2_b64 v[116:119], v10 offset0:144 offset1:145
    v_mfma_f32_16x16x32_bf16 v[44:47], v[56:59], v[100:103], v[44:47]
    v_mfma_f32_16x16x32_bf16 v[28:31], v[60:63], v[80:83], v[28:31]
    ds_read2_b64 v[120:123], v10 offset0:80 offset1:81
    v_mfma_f32_16x16x32_bf16 v[32:35], v[60:63], v[84:87], v[32:35]
    v_mfma_f32_16x16x32_bf16 v[36:39], v[60:63], v[88:91], v[36:39]
    ds_read2_b64 v[124:127], v10 offset0:16 offset1:17
    v_mfma_f32_16x16x32_bf16 v[40:43], v[60:63], v[92:95], v[40:43]
    v_mfma_f32_16x16x32_bf16 v[44:47], v[60:63], v[96:99], v[44:47]
    ds_read2_b64 v[128:131], v11 offset0:208 offset1:209
    v_mfma_f32_16x16x32_bf16 v[32:35], v[64:67], v[80:83], v[32:35]
    v_mfma_f32_16x16x32_bf16 v[36:39], v[64:67], v[84:87], v[36:39]
    ds_read2_b64 v[132:135], v11 offset0:144 offset1:145
    v_mfma_f32_16x16x32_bf16 v[40:43], v[64:67], v[88:91], v[40:43]
    v_mfma_f32_16x16x32_bf16 v[44:47], v[64:67], v[92:95], v[44:47]
    ds_read2_b64 v[136:139], v11 offset0:80 offset1:81
    v_mfma_f32_16x16x32_bf16 v[36:39], v[68:71], v[80:83], v[36:39]
    v_mfma_f32_16x16x32_bf16 v[40:43], v[68:71], v[84:87], v[40:43]
    ds_read2_b64 v[140:143], v11 offset0:16 offset1:17
    v_mfma_f32_16x16x32_bf16 v[44:47], v[68:71], v[88:91], v[44:47]
    v_mfma_f32_16x16x32_bf16 v[40:43], v[72:75], v[80:83], v[40:43]
    v_mfma_f32_16x16x32_bf16 v[44:47], v[72:75], v[84:87], v[44:47]
    v_mfma_f32_16x16x32_bf16 v[44:47], v[76:79], v[80:83], v[44:47]
    s_waitcnt lgkmcnt(0)
    v_mfma_f32_16x16x32_bf16 v[16:19], v[112:115], v[144:147], v[16:19]
    v_mfma_f32_16x16x32_bf16 v[20:23], v[112:115], v[148:151], v[20:23]
    ds_read2_b64 v[48:51], v10 offset0:200 offset1:201
    v_mfma_f32_16x16x32_bf16 v[24:27], v[112:115], v[152:155], v[24:27]
    v_mfma_f32_16x16x32_bf16 v[28:31], v[112:115], v[156:159], v[28:31]
    ds_read_b128 v[80:83], v12 offset:64
    v_mfma_f32_16x16x32_bf16 v[32:35], v[112:115], v[160:163], v[32:35]
    v_mfma_f32_16x16x32_bf16 v[36:39], v[112:115], v[164:167], v[36:39]
    ds_read_b128 v[84:87], v12 offset:576
    v_mfma_f32_16x16x32_bf16 v[40:43], v[112:115], v[168:171], v[40:43]
    v_mfma_f32_16x16x32_bf16 v[44:47], v[112:115], v[172:175], v[44:47]
    ds_read_b128 v[88:91], v12 offset:1088
    v_mfma_f32_16x16x32_bf16 v[20:23], v[116:119], v[144:147], v[20:23]
    v_mfma_f32_16x16x32_bf16 v[24:27], v[116:119], v[148:151], v[24:27]
    ds_read_b128 v[92:95], v12 offset:1600
    v_mfma_f32_16x16x32_bf16 v[28:31], v[116:119], v[152:155], v[28:31]
    v_mfma_f32_16x16x32_bf16 v[32:35], v[116:119], v[156:159], v[32:35]
    ds_read_b128 v[96:99], v12 offset:2112
    v_mfma_f32_16x16x32_bf16 v[36:39], v[116:119], v[160:163], v[36:39]
    v_mfma_f32_16x16x32_bf16 v[40:43], v[116:119], v[164:167], v[40:43]
    ds_read_b128 v[100:103], v12 offset:2624
    v_mfma_f32_16x16x32_bf16 v[44:47], v[116:119], v[168:171], v[44:47]
    v_mfma_f32_16x16x32_bf16 v[24:27], v[120:123], v[144:147], v[24:27]
    ds_read_b128 v[104:107], v12 offset:3136
    v_mfma_f32_16x16x32_bf16 v[28:31], v[120:123], v[148:151], v[28:31]
    v_mfma_f32_16x16x32_bf16 v[32:35], v[120:123], v[152:155], v[32:35]
    ds_read_b128 v[108:111], v12 offset:3648
    v_mfma_f32_16x16x32_bf16 v[36:39], v[120:123], v[156:159], v[36:39]
    v_mfma_f32_16x16x32_bf16 v[40:43], v[120:123], v[160:163], v[40:43]
    ds_read2_b64 v[52:55], v10 offset0:136 offset1:137
    v_mfma_f32_16x16x32_bf16 v[44:47], v[120:123], v[164:167], v[44:47]
    v_mfma_f32_16x16x32_bf16 v[28:31], v[124:127], v[144:147], v[28:31]
    ds_read2_b64 v[56:59], v10 offset0:72 offset1:73
    v_mfma_f32_16x16x32_bf16 v[32:35], v[124:127], v[148:151], v[32:35]
    v_mfma_f32_16x16x32_bf16 v[36:39], v[124:127], v[152:155], v[36:39]
    ds_read2_b64 v[60:63], v10 offset0:8 offset1:9
    v_mfma_f32_16x16x32_bf16 v[40:43], v[124:127], v[156:159], v[40:43]
    v_mfma_f32_16x16x32_bf16 v[44:47], v[124:127], v[160:163], v[44:47]
    ds_read2_b64 v[64:67], v11 offset0:200 offset1:201
    v_mfma_f32_16x16x32_bf16 v[32:35], v[128:131], v[144:147], v[32:35]
    v_mfma_f32_16x16x32_bf16 v[36:39], v[128:131], v[148:151], v[36:39]
    ds_read2_b64 v[68:71], v11 offset0:136 offset1:137
    v_mfma_f32_16x16x32_bf16 v[40:43], v[128:131], v[152:155], v[40:43]
    v_mfma_f32_16x16x32_bf16 v[44:47], v[128:131], v[156:159], v[44:47]
    ds_read2_b64 v[72:75], v11 offset0:72 offset1:73
    v_mfma_f32_16x16x32_bf16 v[36:39], v[132:135], v[144:147], v[36:39]
    v_mfma_f32_16x16x32_bf16 v[40:43], v[132:135], v[148:151], v[40:43]
    ds_read2_b64 v[76:79], v11 offset0:8 offset1:9
    v_mfma_f32_16x16x32_bf16 v[44:47], v[132:135], v[152:155], v[44:47]
    v_mfma_f32_16x16x32_bf16 v[40:43], v[136:139], v[144:147], v[40:43]
    v_mfma_f32_16x16x32_bf16 v[44:47], v[136:139], v[148:151], v[44:47]
    v_mfma_f32_16x16x32_bf16 v[44:47], v[140:143], v[144:147], v[44:47]
    s_waitcnt lgkmcnt(0)
    v_mfma_f32_16x16x32_bf16 v[16:19], v[48:51], v[80:83], v[16:19]
    v_mfma_f32_16x16x32_bf16 v[20:23], v[48:51], v[84:87], v[20:23]
    ds_read2_b64 v[112:115], v10 offset0:192 offset1:193
    v_mfma_f32_16x16x32_bf16 v[24:27], v[48:51], v[88:91], v[24:27]
    v_mfma_f32_16x16x32_bf16 v[28:31], v[48:51], v[92:95], v[28:31]
    ds_read_b128 v[144:147], v12 offset:0
    v_mfma_f32_16x16x32_bf16 v[32:35], v[48:51], v[96:99], v[32:35]
    v_mfma_f32_16x16x32_bf16 v[36:39], v[48:51], v[100:103], v[36:39]
    ds_read_b128 v[148:151], v12 offset:512
    v_mfma_f32_16x16x32_bf16 v[40:43], v[48:51], v[104:107], v[40:43]
    v_mfma_f32_16x16x32_bf16 v[44:47], v[48:51], v[108:111], v[44:47]
    ds_read_b128 v[152:155], v12 offset:1024
    v_mfma_f32_16x16x32_bf16 v[20:23], v[52:55], v[80:83], v[20:23]
    v_mfma_f32_16x16x32_bf16 v[24:27], v[52:55], v[84:87], v[24:27]
    ds_read_b128 v[156:159], v12 offset:1536
    v_mfma_f32_16x16x32_bf16 v[28:31], v[52:55], v[88:91], v[28:31]
    v_mfma_f32_16x16x32_bf16 v[32:35], v[52:55], v[92:95], v[32:35]
    ds_read_b128 v[160:163], v12 offset:2048
    v_mfma_f32_16x16x32_bf16 v[36:39], v[52:55], v[96:99], v[36:39]
    v_mfma_f32_16x16x32_bf16 v[40:43], v[52:55], v[100:103], v[40:43]
    ds_read_b128 v[164:167], v12 offset:2560
    v_mfma_f32_16x16x32_bf16 v[44:47], v[52:55], v[104:107], v[44:47]
    v_mfma_f32_16x16x32_bf16 v[24:27], v[56:59], v[80:83], v[24:27]
    ds_read_b128 v[168:171], v12 offset:3072
    v_mfma_f32_16x16x32_bf16 v[28:31], v[56:59], v[84:87], v[28:31]
    v_mfma_f32_16x16x32_bf16 v[32:35], v[56:59], v[88:91], v[32:35]
    ds_read_b128 v[172:175], v12 offset:3584
    v_mfma_f32_16x16x32_bf16 v[36:39], v[56:59], v[92:95], v[36:39]
    v_mfma_f32_16x16x32_bf16 v[40:43], v[56:59], v[96:99], v[40:43]
    ds_read2_b64 v[116:119], v10 offset0:128 offset1:129
    v_mfma_f32_16x16x32_bf16 v[44:47], v[56:59], v[100:103], v[44:47]
    v_mfma_f32_16x16x32_bf16 v[28:31], v[60:63], v[80:83], v[28:31]
    ds_read2_b64 v[120:123], v10 offset0:64 offset1:65
    v_mfma_f32_16x16x32_bf16 v[32:35], v[60:63], v[84:87], v[32:35]
    v_mfma_f32_16x16x32_bf16 v[36:39], v[60:63], v[88:91], v[36:39]
    ds_read2_b64 v[124:127], v10 offset0:0 offset1:1
    v_mfma_f32_16x16x32_bf16 v[40:43], v[60:63], v[92:95], v[40:43]
    v_mfma_f32_16x16x32_bf16 v[44:47], v[60:63], v[96:99], v[44:47]
    ds_read2_b64 v[128:131], v11 offset0:192 offset1:193
    v_mfma_f32_16x16x32_bf16 v[32:35], v[64:67], v[80:83], v[32:35]
    v_mfma_f32_16x16x32_bf16 v[36:39], v[64:67], v[84:87], v[36:39]
    ds_read2_b64 v[132:135], v11 offset0:128 offset1:129
    v_mfma_f32_16x16x32_bf16 v[40:43], v[64:67], v[88:91], v[40:43]
    v_mfma_f32_16x16x32_bf16 v[44:47], v[64:67], v[92:95], v[44:47]
    ds_read2_b64 v[136:139], v11 offset0:64 offset1:65
    v_mfma_f32_16x16x32_bf16 v[36:39], v[68:71], v[80:83], v[36:39]
    v_mfma_f32_16x16x32_bf16 v[40:43], v[68:71], v[84:87], v[40:43]
    ds_read2_b64 v[140:143], v11 offset0:0 offset1:1
    v_mfma_f32_16x16x32_bf16 v[44:47], v[68:71], v[88:91], v[44:47]
    v_mfma_f32_16x16x32_bf16 v[40:43], v[72:75], v[80:83], v[40:43]
    v_mfma_f32_16x16x32_bf16 v[44:47], v[72:75], v[84:87], v[44:47]
    v_mfma_f32_16x16x32_bf16 v[44:47], v[76:79], v[80:83], v[44:47]
    s_waitcnt lgkmcnt(0)
    v_mfma_f32_16x16x32_bf16 v[16:19], v[112:115], v[144:147], v[16:19]
    v_mfma_f32_16x16x32_bf16 v[20:23], v[112:115], v[148:151], v[20:23]
    v_mfma_f32_16x16x32_bf16 v[24:27], v[112:115], v[152:155], v[24:27]
    v_mfma_f32_16x16x32_bf16 v[28:31], v[112:115], v[156:159], v[28:31]
    v_mfma_f32_16x16x32_bf16 v[32:35], v[112:115], v[160:163], v[32:35]
    v_mfma_f32_16x16x32_bf16 v[36:39], v[112:115], v[164:167], v[36:39]
    v_mfma_f32_16x16x32_bf16 v[40:43], v[112:115], v[168:171], v[40:43]
    v_mfma_f32_16x16x32_bf16 v[44:47], v[112:115], v[172:175], v[44:47]
    v_mfma_f32_16x16x32_bf16 v[20:23], v[116:119], v[144:147], v[20:23]
    v_mfma_f32_16x16x32_bf16 v[24:27], v[116:119], v[148:151], v[24:27]
    v_mfma_f32_16x16x32_bf16 v[28:31], v[116:119], v[152:155], v[28:31]
    v_mfma_f32_16x16x32_bf16 v[32:35], v[116:119], v[156:159], v[32:35]
    v_mfma_f32_16x16x32_bf16 v[36:39], v[116:119], v[160:163], v[36:39]
    v_mfma_f32_16x16x32_bf16 v[40:43], v[116:119], v[164:167], v[40:43]
    v_mfma_f32_16x16x32_bf16 v[44:47], v[116:119], v[168:171], v[44:47]
    v_mfma_f32_16x16x32_bf16 v[24:27], v[120:123], v[144:147], v[24:27]
    v_mfma_f32_16x16x32_bf16 v[28:31], v[120:123], v[148:151], v[28:31]
    v_mfma_f32_16x16x32_bf16 v[32:35], v[120:123], v[152:155], v[32:35]
    v_mfma_f32_16x16x32_bf16 v[36:39], v[120:123], v[156:159], v[36:39]
    v_mfma_f32_16x16x32_bf16 v[40:43], v[120:123], v[160:163], v[40:43]
    v_mfma_f32_16x16x32_bf16 v[44:47], v[120:123], v[164:167], v[44:47]
    v_mfma_f32_16x16x32_bf16 v[28:31], v[124:127], v[144:147], v[28:31]
    v_mfma_f32_16x16x32_bf16 v[32:35], v[124:127], v[148:151], v[32:35]
    v_mfma_f32_16x16x32_bf16 v[36:39], v[124:127], v[152:155], v[36:39]
    v_mfma_f32_16x16x32_bf16 v[40:43], v[124:127], v[156:159], v[40:43]
    v_mfma_f32_16x16x32_bf16 v[44:47], v[124:127], v[160:163], v[44:47]
    v_mfma_f32_16x16x32_bf16 v[32:35], v[128:131], v[144:147], v[32:35]
    v_mfma_f32_16x16x32_bf16 v[36:39], v[128:131], v[148:151], v[36:39]
    v_mfma_f32_16x16x32_bf16 v[40:43], v[128:131], v[152:155], v[40:43]
    v_mfma_f32_16x16x32_bf16 v[44:47], v[128:131], v[156:159], v[44:47]
    v_mfma_f32_16x16x32_bf16 v[36:39], v[132:135], v[144:147], v[36:39]
    v_mfma_f32_16x16x32_bf16 v[40:43], v[132:135], v[148:151], v[40:43]
    v_mfma_f32_16x16x32_bf16 v[44:47], v[132:135], v[152:155], v[44:47]
    v_mfma_f32_16x16x32_bf16 v[40:43], v[136:139], v[144:147], v[40:43]
    v_mfma_f32_16x16x32_bf16 v[44:47], v[136:139], v[148:151], v[44:47]
    v_mfma_f32_16x16x32_bf16 v[44:47], v[140:143], v[144:147], v[44:47]
    s_lshl_b32 s45, s6, 12
    s_add_u32 s45, s45, s16
    v_add_u32 v13, s45, v2
    s_cmp_eq_u32 s6, 0
    s_cbranch_scc0 P2_HF1
    ds_write_b128 v13, v[32:35] offset:25344
    ds_write_b128 v13, v[36:39] offset:26368
    ds_write_b128 v13, v[40:43] offset:27392
    ds_write_b128 v13, v[44:47] offset:28416
    s_branch P2_HFJ
P2_HF1:
    ds_write_b128 v13, v[16:19] offset:25344
    ds_write_b128 v13, v[20:23] offset:26368
    ds_write_b128 v13, v[24:27] offset:27392
    ds_write_b128 v13, v[28:31] offset:28416
    s_nop 1
    v_mov_b32 v16, v32
    v_mov_b32 v17, v33
    v_mov_b32 v18, v34
    v_mov_b32 v19, v35
    v_mov_b32 v20, v36
    v_mov_b32 v21, v37
    v_mov_b32 v22, v38
    v_mov_b32 v23, v39
    v_mov_b32 v24, v40
    v_mov_b32 v25, v41
    v_mov_b32 v26, v42
    v_mov_b32 v27, v43
    v_mov_b32 v28, v44
    v_mov_b32 v29, v45
    v_mov_b32 v30, v46
    v_mov_b32 v31, v47
P2_HFJ:
    s_xor_b32 s45, s6, 1
    s_lshl_b32 s45, s45, 12
    s_add_u32 s45, s45, s16
    v_add_u32 v13, s45, v2
    v_lshlrev_b32 v14, 5, v8
    v_lshlrev_b32 v15, 3, v9
    v_add_u32 v14, v14, v15
    s_lshl_b32 s45, s6, 11
    v_add_u32 v14, s45, v14
    v_add_u32 v15, s16, v14
    ds_read_b64 v[48:49], v15 offset:17120
    ds_read_b64 v[56:57], v15 offset:21248
    ds_read_b64 v[50:51], v15 offset:17632
    ds_read_b64 v[58:59], v15 offset:21760
    ds_read_b64 v[52:53], v15 offset:18144
    ds_read_b64 v[60:61], v15 offset:22272
    ds_read_b64 v[54:55], v15 offset:18656
    ds_read_b64 v[62:63], v15 offset:22784
    s_waitcnt lgkmcnt(0)
    s_barrier
    ds_read_b128 v[64:67], v13 offset:25344
    ds_read_b128 v[68:71], v13 offset:26368
    ds_read_b128 v[72:75], v13 offset:27392
    ds_read_b128 v[76:79], v13 offset:28416
    v_lshlrev_b32 v5, 16, v5
    s_lshl_b32 s44, s7, 12
    s_waitcnt lgkmcnt(3)
    v_add_f32 v16, v16, v64
    v_add_f32 v17, v17, v65
    v_add_f32 v18, v18, v66
    v_add_f32 v19, v19, v67
    v_lshlrev_b32 v80, 16, v48
    v_and_b32 v81, 0xffff0000, v48
    v_lshlrev_b32 v82, 16, v56
    v_and_b32 v83, 0xffff0000, v56
    v_fmac_f32 v16, v80, v5
    v_fmac_f32 v17, v81, v5
    v_fma_f32 v82, v16, s42, v82
    v_fma_f32 v83, v17, s42, v83
    v_cvt_pk_bf16_f32 v84, v82, v83
    v_mul_f32 v82, s43, v82
    v_mul_f32 v83, s43, v83
    v_cvt_pk_bf16_f32 v86, v82, v83
    v_lshlrev_b32 v80, 16, v49
    v_and_b32 v81, 0xffff0000, v49
    v_lshlrev_b32 v82, 16, v57
    v_and_b32 v83, 0xffff0000, v57
    v_fmac_f32 v18, v80, v5
    v_fmac_f32 v19, v81, v5
    v_fma_f32 v82, v18, s42, v82
    v_fma_f32 v83, v19, s42, v83
    v_cvt_pk_bf16_f32 v85, v82, v83
    v_mul_f32 v82, s43, v82
    v_mul_f32 v83, s43, v83
    v_cvt_pk_bf16_f32 v87, v82, v83
    buffer_store_dwordx2 v[84:85], v14, s[32:35], s44 offen offset:0
    buffer_store_dwordx2 v[86:87], v14, s[36:39], s44 offen offset:0
    s_waitcnt lgkmcnt(2)
    v_add_f32 v20, v20, v68
    v_add_f32 v21, v21, v69
    v_add_f32 v22, v22, v70
    v_add_f32 v23, v23, v71
    v_lshlrev_b32 v80, 16, v50
    v_and_b32 v81, 0xffff0000, v50
    v_lshlrev_b32 v82, 16, v58
    v_and_b32 v83, 0xffff0000, v58
    v_fmac_f32 v20, v80, v5
    v_fmac_f32 v21, v81, v5
    v_fma_f32 v82, v20, s42, v82
    v_fma_f32 v83, v21, s42, v83
    v_cvt_pk_bf16_f32 v88, v82, v83
    v_mul_f32 v82, s43, v82
    v_mul_f32 v83, s43, v83
    v_cvt_pk_bf16_f32 v90, v82, v83
    v_lshlrev_b32 v80, 16, v51
    v_and_b32 v81, 0xffff0000, v51
    v_lshlrev_b32 v82, 16, v59
    v_and_b32 v83, 0xffff0000, v59
    v_fmac_f32 v22, v80, v5
    v_fmac_f32 v23, v81, v5
    v_fma_f32 v82, v22, s42, v82
    v_fma_f32 v83, v23, s42, v83
    v_cvt_pk_bf16_f32 v89, v82, v83
    v_mul_f32 v82, s43, v82
    v_mul_f32 v83, s43, v83
    v_cvt_pk_bf16_f32 v91, v82, v83
    buffer_store_dwordx2 v[88:89], v14, s[32:35], s44 offen offset:512
    buffer_store_dwordx2 v[90:91], v14, s[36:39], s44 offen offset:512
    s_waitcnt lgkmcnt(1)
    v_add_f32 v24, v24, v72
    v_add_f32 v25, v25, v73
    v_add_f32 v26, v26, v74
    v_add_f32 v27, v27, v75
    v_lshlrev_b32 v80, 16, v52
    v_and_b32 v81, 0xffff0000, v52
    v_lshlrev_b32 v82, 16, v60
    v_and_b32 v83, 0xffff0000, v60
    v_fmac_f32 v24, v80, v5
    v_fmac_f32 v25, v81, v5
    v_fma_f32 v82, v24, s42, v82
    v_fma_f32 v83, v25, s42, v83
    v_cvt_pk_bf16_f32 v92, v82, v83
    v_mul_f32 v82, s43, v82
    v_mul_f32 v83, s43, v83
    v_cvt_pk_bf16_f32 v94, v82, v83
    v_lshlrev_b32 v80, 16, v53
    v_and_b32 v81, 0xffff0000, v53
    v_lshlrev_b32 v82, 16, v61
    v_and_b32 v83, 0xffff0000, v61
    v_fmac_f32 v26, v80, v5
    v_fmac_f32 v27, v81, v5
    v_fma_f32 v82, v26, s42, v82
    v_fma_f32 v83, v27, s42, v83
    v_cvt_pk_bf16_f32 v93, v82, v83
    v_mul_f32 v82, s43, v82
    v_mul_f32 v83, s43, v83
    v_cvt_pk_bf16_f32 v95, v82, v83
    buffer_store_dwordx2 v[92:93], v14, s[32:35], s44 offen offset:1024
    buffer_store_dwordx2 v[94:95], v14, s[36:39], s44 offen offset:1024
    s_waitcnt lgkmcnt(0)
    v_add_f32 v28, v28, v76
    v_add_f32 v29, v29, v77
    v_add_f32 v30, v30, v78
    v_add_f32 v31, v31, v79
    v_lshlrev_b32 v80, 16, v54
    v_and_b32 v81, 0xffff0000, v54
    v_lshlrev_b32 v82, 16, v62
    v_and_b32 v83, 0xffff0000, v62
    v_fmac_f32 v28, v80, v5
    v_fmac_f32 v29, v81, v5
    v_fma_f32 v82, v28, s42, v82
    v_fma_f32 v83, v29, s42, v83
    v_cvt_pk_bf16_f32 v96, v82, v83
    v_mul_f32 v82, s43, v82
    v_mul_f32 v83, s43, v83
    v_cvt_pk_bf16_f32 v98, v82, v83
    v_lshlrev_b32 v80, 16, v55
    v_and_b32 v81, 0xffff0000, v55
    v_lshlrev_b32 v82, 16, v63
    v_and_b32 v83, 0xffff0000, v63
    v_fmac_f32 v30, v80, v5
    v_fmac_f32 v31, v81, v5
    v_fma_f32 v82, v30, s42, v82
    v_fma_f32 v83, v31, s42, v83
    v_cvt_pk_bf16_f32 v97, v82, v83
    v_mul_f32 v82, s43, v82
    v_mul_f32 v83, s43, v83
    v_cvt_pk_bf16_f32 v99, v82, v83
    buffer_store_dwordx2 v[96:97], v14, s[32:35], s44 offen offset:1536
    buffer_store_dwordx2 v[98:99], v14, s[36:39], s44 offen offset:1536
    s_branch P2_END
P2_CS:
    s_sub_u32 s2, s2, 192
    s_load_dwordx2 s[8:9], s[0:1], 136
    s_load_dwordx2 s[12:13], s[0:1], 80
    s_load_dwordx2 s[16:17], s[0:1], 88
    s_lshr_b32 s4, s2, 5
    s_and_b32 s5, s2, 7
    s_lshl_b32 s5, s5, 2
    s_bfe_u32 s6, s2, 0x20003
    s_or_b32 s5, s5, s6
    v_mul_u32_u24 v1, 3641, v0
    v_lshrrev_b32 v1, 16, v1
    v_mul_u32_u24 v2, 18, v1
    v_sub_u32 v2, v0, v2
    v_lshrrev_b32 v3, 6, v0
    s_nop 0
    v_readfirstlane_b32 s93, v3
    s_add_u32 s92, s2, 192
    s_waitcnt lgkmcnt(0)
    s_cmp_eq_u32 s4, 0
    s_cselect_b32 s12, s12, s16
    s_cselect_b32 s13, s13, s17
    s_mov_b32 s14, 0x510000
    s_mov_b32 s15, 0x00020000
    s_add_u32 s20, s8, 0x310000
    s_addc_u32 s21, s9, 0
    s_mov_b32 s22, 0x3600
    s_mov_b32 s23, 0x00020000
    s_add_u32 s24, s8, 0x330000
    s_addc_u32 s25, s9, 0
    s_mov_b32 s26, 0x12000
    s_mov_b32 s27, 0x00020000
    v_lshlrev_b32 v3, 2, v0
    s_movk_i32 s6, 9216
    s_movk_i32 s7, 6912
    buffer_load_dword v10, v3, s[20:23], s6 offen
    buffer_load_dword v11, v3, s[20:23], s7 offen
    buffer_load_dword v12, v3, s[20:23], s6 offen offset:1536
    buffer_load_dword v13, v3, s[20:23], s7 offen offset:1536
    v_mul_u32_u24 v4, 9216, v1
    v_lshlrev_b32 v5, 4, v2
    v_add_u32 v4, v4, v5
    s_mul_i32 s6, s5, 288
    v_add_u32 v4, s6, v4
    v_cmp_gt_u32 vcc, 18, v1
    s_nop 1
    v_cndmask_b32 v4, -1, v4, vcc
    s_mov_b32 s6, 0
    buffer_load_dwordx4 v[40:43], v4, s[12:15], s6 offen
    s_add_u32 s6, s6, 165888
    buffer_load_dwordx4 v[44:47], v4, s[12:15], s6 offen
    s_add_u32 s6, s6, 165888
    buffer_load_dwordx4 v[48:51], v4, s[12:15], s6 offen
    s_add_u32 s6, s6, 165888
    buffer_load_dwordx4 v[52:55], v4, s[12:15], s6 offen
    s_add_u32 s6, s6, 165888
    buffer_load_dwordx4 v[56:59], v4, s[12:15], s6 offen
    s_add_u32 s6, s6, 165888
    buffer_load_dwordx4 v[60:63], v4, s[12:15], s6 offen
    s_add_u32 s6, s6, 165888
    buffer_load_dwordx4 v[64:67], v4, s[12:15], s6 offen
    s_add_u32 s6, s6, 165888
    buffer_load_dwordx4 v[68:71], v4, s[12:15], s6 offen
    s_add_u32 s6, s6, 165888
    buffer_load_dwordx4 v[72:75], v4, s[12:15], s6 offen
    s_add_u32 s6, s6, 165888
    buffer_load_dwordx4 v[76:79], v4, s[12:15], s6 offen
    s_add_u32 s6, s6, 165888
    buffer_load_dwordx4 v[80:83], v4, s[12:15], s6 offen
    s_add_u32 s6, s6, 165888
    buffer_load_dwordx4 v[84:87], v4, s[12:15], s6 offen
    s_add_u32 s6, s6, 165888
    buffer_load_dwordx4 v[88:91], v4, s[12:15], s6 offen
    s_add_u32 s6, s6, 165888
    buffer_load_dwordx4 v[92:95], v4, s[12:15], s6 offen
    s_add_u32 s6, s6, 165888
    buffer_load_dwordx4 v[96:99], v4, s[12:15], s6 offen
    s_add_u32 s6, s6, 165888
    buffer_load_dwordx4 v[100:103], v4, s[12:15], s6 offen
    s_add_u32 s6, s6, 165888
    buffer_load_dwordx4 v[104:107], v4, s[12:15], s6 offen
    s_add_u32 s6, s6, 165888
    buffer_load_dwordx4 v[108:111], v4, s[12:15], s6 offen
    s_add_u32 s6, s6, 165888
    buffer_load_dwordx4 v[112:115], v4, s[12:15], s6 offen
    s_add_u32 s6, s6, 165888
    buffer_load_dwordx4 v[116:119], v4, s[12:15], s6 offen
    s_add_u32 s6, s6, 165888
    buffer_load_dwordx4 v[120:123], v4, s[12:15], s6 offen
    s_add_u32 s6, s6, 165888
    buffer_load_dwordx4 v[124:127], v4, s[12:15], s6 offen
    s_add_u32 s6, s6, 165888
    buffer_load_dwordx4 v[128:131], v4, s[12:15], s6 offen
    s_add_u32 s6, s6, 165888
    buffer_load_dwordx4 v[132:135], v4, s[12:15], s6 offen
    s_add_u32 s6, s6, 165888
    buffer_load_dwordx4 v[136:139], v4, s[12:15], s6 offen
    s_add_u32 s6, s6, 165888
    buffer_load_dwordx4 v[140:143], v4, s[12:15], s6 offen
    s_add_u32 s6, s6, 165888
    buffer_load_dwordx4 v[144:147], v4, s[12:15], s6 offen
    s_add_u32 s6, s6, 165888
    buffer_load_dwordx4 v[148:151], v4, s[12:15], s6 offen
    s_add_u32 s6, s6, 165888
    buffer_load_dwordx4 v[152:155], v4, s[12:15], s6 offen
    s_add_u32 s6, s6, 165888
    buffer_load_dwordx4 v[156:159], v4, s[12:15], s6 offen
    s_add_u32 s6, s6, 165888
    buffer_load_dwordx4 v[160:163], v4, s[12:15], s6 offen
    s_add_u32 s6, s6, 165888
    buffer_load_dwordx4 v[164:167], v4, s[12:15], s6 offen
    s_add_u32 s6, s6, 165888
    v_lshlrev_b32 v5, 3, v0
    s_waitcnt vmcnt(32)
    ds_write_b64 v5, v[10:11]
    v_cmp_gt_u32 vcc, 192, v0
    s_nop 0
    s_and_saveexec_b64 s[28:29], vcc
    ds_write_b64 v5, v[12:13] offset:3072
    s_mov_b64 exec, s[28:29]
    s_waitcnt lgkmcnt(0)
    s_barrier
    v_min_u32 v6, 17, v1
    v_lshlrev_b32 v6, 3, v6
    v_mov_b32 v16, 0
    v_mov_b32 v17, 0
    v_mov_b32 v18, 0
    v_mov_b32 v19, 0
    v_mov_b32 v20, 0
    v_mov_b32 v21, 0
    v_mov_b32 v22, 0
    v_mov_b32 v23, 0
    v_mov_b32 v24, 0
    v_mov_b32 v25, 0
    v_mov_b32 v26, 0
    v_mov_b32 v27, 0
    v_mov_b32 v28, 0
    v_mov_b32 v29, 0
    v_mov_b32 v30, 0
    v_mov_b32 v31, 0
    ds_read_b64 v[170:171], v6 offset:0
    ds_read_b64 v[172:173], v6 offset:144
    ds_read_b64 v[174:175], v6 offset:288
    ds_read_b64 v[176:177], v6 offset:432
    ds_read_b64 v[178:179], v6 offset:576
    ds_read_b64 v[180:181], v6 offset:720
    ds_read_b64 v[182:183], v6 offset:864
    ds_read_b64 v[184:185], v6 offset:1008
    s_waitcnt lgkmcnt(0)
    s_waitcnt vmcnt(31)
    v_lshlrev_b32 v14, 16, v40
    v_and_b32 v15, 0xffff0000, v40
    v_fmac_f32 v16, v170, v14
    v_fmac_f32 v17, v170, v15
    v_fmac_f32 v24, v171, v14
    v_fmac_f32 v25, v171, v15
    v_lshlrev_b32 v14, 16, v41
    v_and_b32 v15, 0xffff0000, v41
    v_fmac_f32 v18, v170, v14
    v_fmac_f32 v19, v170, v15
    v_fmac_f32 v26, v171, v14
    v_fmac_f32 v27, v171, v15
    v_lshlrev_b32 v14, 16, v42
    v_and_b32 v15, 0xffff0000, v42
    v_fmac_f32 v20, v170, v14
    v_fmac_f32 v21, v170, v15
    v_fmac_f32 v28, v171, v14
    v_fmac_f32 v29, v171, v15
    v_lshlrev_b32 v14, 16, v43
    v_and_b32 v15, 0xffff0000, v43
    v_fmac_f32 v22, v170, v14
    v_fmac_f32 v23, v170, v15
    v_fmac_f32 v30, v171, v14
    v_fmac_f32 v31, v171, v15
    s_waitcnt vmcnt(30)
    v_lshlrev_b32 v14, 16, v44
    v_and_b32 v15, 0xffff0000, v44
    v_fmac_f32 v16, v172, v14
    v_fmac_f32 v17, v172, v15
    v_fmac_f32 v24, v173, v14
    v_fmac_f32 v25, v173, v15
    v_lshlrev_b32 v14, 16, v45
    v_and_b32 v15, 0xffff0000, v45
    v_fmac_f32 v18, v172, v14
    v_fmac_f32 v19, v172, v15
    v_fmac_f32 v26, v173, v14
    v_fmac_f32 v27, v173, v15
    v_lshlrev_b32 v14, 16, v46
    v_and_b32 v15, 0xffff0000, v46
    v_fmac_f32 v20, v172, v14
    v_fmac_f32 v21, v172, v15
    v_fmac_f32 v28, v173, v14
    v_fmac_f32 v29, v173, v15
    v_lshlrev_b32 v14, 16, v47
    v_and_b32 v15, 0xffff0000, v47
    v_fmac_f32 v22, v172, v14
    v_fmac_f32 v23, v172, v15
    v_fmac_f32 v30, v173, v14
    v_fmac_f32 v31, v173, v15
    s_waitcnt vmcnt(29)
    v_lshlrev_b32 v14, 16, v48
    v_and_b32 v15, 0xffff0000, v48
    v_fmac_f32 v16, v174, v14
    v_fmac_f32 v17, v174, v15
    v_fmac_f32 v24, v175, v14
    v_fmac_f32 v25, v175, v15
    v_lshlrev_b32 v14, 16, v49
    v_and_b32 v15, 0xffff0000, v49
    v_fmac_f32 v18, v174, v14
    v_fmac_f32 v19, v174, v15
    v_fmac_f32 v26, v175, v14
    v_fmac_f32 v27, v175, v15
    v_lshlrev_b32 v14, 16, v50
    v_and_b32 v15, 0xffff0000, v50
    v_fmac_f32 v20, v174, v14
    v_fmac_f32 v21, v174, v15
    v_fmac_f32 v28, v175, v14
    v_fmac_f32 v29, v175, v15
    v_lshlrev_b32 v14, 16, v51
    v_and_b32 v15, 0xffff0000, v51
    v_fmac_f32 v22, v174, v14
    v_fmac_f32 v23, v174, v15
    v_fmac_f32 v30, v175, v14
    v_fmac_f32 v31, v175, v15
    s_waitcnt vmcnt(28)
    v_lshlrev_b32 v14, 16, v52
    v_and_b32 v15, 0xffff0000, v52
    v_fmac_f32 v16, v176, v14
    v_fmac_f32 v17, v176, v15
    v_fmac_f32 v24, v177, v14
    v_fmac_f32 v25, v177, v15
    v_lshlrev_b32 v14, 16, v53
    v_and_b32 v15, 0xffff0000, v53
    v_fmac_f32 v18, v176, v14
    v_fmac_f32 v19, v176, v15
    v_fmac_f32 v26, v177, v14
    v_fmac_f32 v27, v177, v15
    v_lshlrev_b32 v14, 16, v54
    v_and_b32 v15, 0xffff0000, v54
    v_fmac_f32 v20, v176, v14
    v_fmac_f32 v21, v176, v15
    v_fmac_f32 v28, v177, v14
    v_fmac_f32 v29, v177, v15
    v_lshlrev_b32 v14, 16, v55
    v_and_b32 v15, 0xffff0000, v55
    v_fmac_f32 v22, v176, v14
    v_fmac_f32 v23, v176, v15
    v_fmac_f32 v30, v177, v14
    v_fmac_f32 v31, v177, v15
    s_waitcnt vmcnt(27)
    v_lshlrev_b32 v14, 16, v56
    v_and_b32 v15, 0xffff0000, v56
    v_fmac_f32 v16, v178, v14
    v_fmac_f32 v17, v178, v15
    v_fmac_f32 v24, v179, v14
    v_fmac_f32 v25, v179, v15
    v_lshlrev_b32 v14, 16, v57
    v_and_b32 v15, 0xffff0000, v57
    v_fmac_f32 v18, v178, v14
    v_fmac_f32 v19, v178, v15
    v_fmac_f32 v26, v179, v14
    v_fmac_f32 v27, v179, v15
    v_lshlrev_b32 v14, 16, v58
    v_and_b32 v15, 0xffff0000, v58
    v_fmac_f32 v20, v178, v14
    v_fmac_f32 v21, v178, v15
    v_fmac_f32 v28, v179, v14
    v_fmac_f32 v29, v179, v15
    v_lshlrev_b32 v14, 16, v59
    v_and_b32 v15, 0xffff0000, v59
    v_fmac_f32 v22, v178, v14
    v_fmac_f32 v23, v178, v15
    v_fmac_f32 v30, v179, v14
    v_fmac_f32 v31, v179, v15
    s_waitcnt vmcnt(26)
    v_lshlrev_b32 v14, 16, v60
    v_and_b32 v15, 0xffff0000, v60
    v_fmac_f32 v16, v180, v14
    v_fmac_f32 v17, v180, v15
    v_fmac_f32 v24, v181, v14
    v_fmac_f32 v25, v181, v15
    v_lshlrev_b32 v14, 16, v61
    v_and_b32 v15, 0xffff0000, v61
    v_fmac_f32 v18, v180, v14
    v_fmac_f32 v19, v180, v15
    v_fmac_f32 v26, v181, v14
    v_fmac_f32 v27, v181, v15
    v_lshlrev_b32 v14, 16, v62
    v_and_b32 v15, 0xffff0000, v62
    v_fmac_f32 v20, v180, v14
    v_fmac_f32 v21, v180, v15
    v_fmac_f32 v28, v181, v14
    v_fmac_f32 v29, v181, v15
    v_lshlrev_b32 v14, 16, v63
    v_and_b32 v15, 0xffff0000, v63
    v_fmac_f32 v22, v180, v14
    v_fmac_f32 v23, v180, v15
    v_fmac_f32 v30, v181, v14
    v_fmac_f32 v31, v181, v15
    s_waitcnt vmcnt(25)
    v_lshlrev_b32 v14, 16, v64
    v_and_b32 v15, 0xffff0000, v64
    v_fmac_f32 v16, v182, v14
    v_fmac_f32 v17, v182, v15
    v_fmac_f32 v24, v183, v14
    v_fmac_f32 v25, v183, v15
    v_lshlrev_b32 v14, 16, v65
    v_and_b32 v15, 0xffff0000, v65
    v_fmac_f32 v18, v182, v14
    v_fmac_f32 v19, v182, v15
    v_fmac_f32 v26, v183, v14
    v_fmac_f32 v27, v183, v15
    v_lshlrev_b32 v14, 16, v66
    v_and_b32 v15, 0xffff0000, v66
    v_fmac_f32 v20, v182, v14
    v_fmac_f32 v21, v182, v15
    v_fmac_f32 v28, v183, v14
    v_fmac_f32 v29, v183, v15
    v_lshlrev_b32 v14, 16, v67
    v_and_b32 v15, 0xffff0000, v67
    v_fmac_f32 v22, v182, v14
    v_fmac_f32 v23, v182, v15
    v_fmac_f32 v30, v183, v14
    v_fmac_f32 v31, v183, v15
    s_waitcnt vmcnt(24)
    v_lshlrev_b32 v14, 16, v68
    v_and_b32 v15, 0xffff0000, v68
    v_fmac_f32 v16, v184, v14
    v_fmac_f32 v17, v184, v15
    v_fmac_f32 v24, v185, v14
    v_fmac_f32 v25, v185, v15
    v_lshlrev_b32 v14, 16, v69
    v_and_b32 v15, 0xffff0000, v69
    v_fmac_f32 v18, v184, v14
    v_fmac_f32 v19, v184, v15
    v_fmac_f32 v26, v185, v14
    v_fmac_f32 v27, v185, v15
    v_lshlrev_b32 v14, 16, v70
    v_and_b32 v15, 0xffff0000, v70
    v_fmac_f32 v20, v184, v14
    v_fmac_f32 v21, v184, v15
    v_fmac_f32 v28, v185, v14
    v_fmac_f32 v29, v185, v15
    v_lshlrev_b32 v14, 16, v71
    v_and_b32 v15, 0xffff0000, v71
    v_fmac_f32 v22, v184, v14
    v_fmac_f32 v23, v184, v15
    v_fmac_f32 v30, v185, v14
    v_fmac_f32 v31, v185, v15
    ds_read_b64 v[170:171], v6 offset:1152
    ds_read_b64 v[172:173], v6 offset:1296
    ds_read_b64 v[174:175], v6 offset:1440
    ds_read_b64 v[176:177], v6 offset:1584
    ds_read_b64 v[178:179], v6 offset:1728
    ds_read_b64 v[180:181], v6 offset:1872
    ds_read_b64 v[182:183], v6 offset:2016
    ds_read_b64 v[184:185], v6 offset:2160
    s_waitcnt lgkmcnt(0)
    s_waitcnt vmcnt(23)
    v_lshlrev_b32 v14, 16, v72
    v_and_b32 v15, 0xffff0000, v72
    v_fmac_f32 v16, v170, v14
    v_fmac_f32 v17, v170, v15
    v_fmac_f32 v24, v171, v14
    v_fmac_f32 v25, v171, v15
    v_lshlrev_b32 v14, 16, v73
    v_and_b32 v15, 0xffff0000, v73
    v_fmac_f32 v18, v170, v14
    v_fmac_f32 v19, v170, v15
    v_fmac_f32 v26, v171, v14
    v_fmac_f32 v27, v171, v15
    v_lshlrev_b32 v14, 16, v74
    v_and_b32 v15, 0xffff0000, v74
    v_fmac_f32 v20, v170, v14
    v_fmac_f32 v21, v170, v15
    v_fmac_f32 v28, v171, v14
    v_fmac_f32 v29, v171, v15
    v_lshlrev_b32 v14, 16, v75
    v_and_b32 v15, 0xffff0000, v75
    v_fmac_f32 v22, v170, v14
    v_fmac_f32 v23, v170, v15
    v_fmac_f32 v30, v171, v14
    v_fmac_f32 v31, v171, v15
    s_waitcnt vmcnt(22)
    v_lshlrev_b32 v14, 16, v76
    v_and_b32 v15, 0xffff0000, v76
    v_fmac_f32 v16, v172, v14
    v_fmac_f32 v17, v172, v15
    v_fmac_f32 v24, v173, v14
    v_fmac_f32 v25, v173, v15
    v_lshlrev_b32 v14, 16, v77
    v_and_b32 v15, 0xffff0000, v77
    v_fmac_f32 v18, v172, v14
    v_fmac_f32 v19, v172, v15
    v_fmac_f32 v26, v173, v14
    v_fmac_f32 v27, v173, v15
    v_lshlrev_b32 v14, 16, v78
    v_and_b32 v15, 0xffff0000, v78
    v_fmac_f32 v20, v172, v14
    v_fmac_f32 v21, v172, v15
    v_fmac_f32 v28, v173, v14
    v_fmac_f32 v29, v173, v15
    v_lshlrev_b32 v14, 16, v79
    v_and_b32 v15, 0xffff0000, v79
    v_fmac_f32 v22, v172, v14
    v_fmac_f32 v23, v172, v15
    v_fmac_f32 v30, v173, v14
    v_fmac_f32 v31, v173, v15
    s_waitcnt vmcnt(21)
    v_lshlrev_b32 v14, 16, v80
    v_and_b32 v15, 0xffff0000, v80
    v_fmac_f32 v16, v174, v14
    v_fmac_f32 v17, v174, v15
    v_fmac_f32 v24, v175, v14
    v_fmac_f32 v25, v175, v15
    v_lshlrev_b32 v14, 16, v81
    v_and_b32 v15, 0xffff0000, v81
    v_fmac_f32 v18, v174, v14
    v_fmac_f32 v19, v174, v15
    v_fmac_f32 v26, v175, v14
    v_fmac_f32 v27, v175, v15
    v_lshlrev_b32 v14, 16, v82
    v_and_b32 v15, 0xffff0000, v82
    v_fmac_f32 v20, v174, v14
    v_fmac_f32 v21, v174, v15
    v_fmac_f32 v28, v175, v14
    v_fmac_f32 v29, v175, v15
    v_lshlrev_b32 v14, 16, v83
    v_and_b32 v15, 0xffff0000, v83
    v_fmac_f32 v22, v174, v14
    v_fmac_f32 v23, v174, v15
    v_fmac_f32 v30, v175, v14
    v_fmac_f32 v31, v175, v15
    s_waitcnt vmcnt(20)
    v_lshlrev_b32 v14, 16, v84
    v_and_b32 v15, 0xffff0000, v84
    v_fmac_f32 v16, v176, v14
    v_fmac_f32 v17, v176, v15
    v_fmac_f32 v24, v177, v14
    v_fmac_f32 v25, v177, v15
    v_lshlrev_b32 v14, 16, v85
    v_and_b32 v15, 0xffff0000, v85
    v_fmac_f32 v18, v176, v14
    v_fmac_f32 v19, v176, v15
    v_fmac_f32 v26, v177, v14
    v_fmac_f32 v27, v177, v15
    v_lshlrev_b32 v14, 16, v86
    v_and_b32 v15, 0xffff0000, v86
    v_fmac_f32 v20, v176, v14
    v_fmac_f32 v21, v176, v15
    v_fmac_f32 v28, v177, v14
    v_fmac_f32 v29, v177, v15
    v_lshlrev_b32 v14, 16, v87
    v_and_b32 v15, 0xffff0000, v87
    v_fmac_f32 v22, v176, v14
    v_fmac_f32 v23, v176, v15
    v_fmac_f32 v30, v177, v14
    v_fmac_f32 v31, v177, v15
    s_waitcnt vmcnt(19)
    v_lshlrev_b32 v14, 16, v88
    v_and_b32 v15, 0xffff0000, v88
    v_fmac_f32 v16, v178, v14
    v_fmac_f32 v17, v178, v15
    v_fmac_f32 v24, v179, v14
    v_fmac_f32 v25, v179, v15
    v_lshlrev_b32 v14, 16, v89
    v_and_b32 v15, 0xffff0000, v89
    v_fmac_f32 v18, v178, v14
    v_fmac_f32 v19, v178, v15
    v_fmac_f32 v26, v179, v14
    v_fmac_f32 v27, v179, v15
    v_lshlrev_b32 v14, 16, v90
    v_and_b32 v15, 0xffff0000, v90
    v_fmac_f32 v20, v178, v14
    v_fmac_f32 v21, v178, v15
    v_fmac_f32 v28, v179, v14
    v_fmac_f32 v29, v179, v15
    v_lshlrev_b32 v14, 16, v91
    v_and_b32 v15, 0xffff0000, v91
    v_fmac_f32 v22, v178, v14
    v_fmac_f32 v23, v178, v15
    v_fmac_f32 v30, v179, v14
    v_fmac_f32 v31, v179, v15
    s_waitcnt vmcnt(18)
    v_lshlrev_b32 v14, 16, v92
    v_and_b32 v15, 0xffff0000, v92
    v_fmac_f32 v16, v180, v14
    v_fmac_f32 v17, v180, v15
    v_fmac_f32 v24, v181, v14
    v_fmac_f32 v25, v181, v15
    v_lshlrev_b32 v14, 16, v93
    v_and_b32 v15, 0xffff0000, v93
    v_fmac_f32 v18, v180, v14
    v_fmac_f32 v19, v180, v15
    v_fmac_f32 v26, v181, v14
    v_fmac_f32 v27, v181, v15
    v_lshlrev_b32 v14, 16, v94
    v_and_b32 v15, 0xffff0000, v94
    v_fmac_f32 v20, v180, v14
    v_fmac_f32 v21, v180, v15
    v_fmac_f32 v28, v181, v14
    v_fmac_f32 v29, v181, v15
    v_lshlrev_b32 v14, 16, v95
    v_and_b32 v15, 0xffff0000, v95
    v_fmac_f32 v22, v180, v14
    v_fmac_f32 v23, v180, v15
    v_fmac_f32 v30, v181, v14
    v_fmac_f32 v31, v181, v15
    s_waitcnt vmcnt(17)
    v_lshlrev_b32 v14, 16, v96
    v_and_b32 v15, 0xffff0000, v96
    v_fmac_f32 v16, v182, v14
    v_fmac_f32 v17, v182, v15
    v_fmac_f32 v24, v183, v14
    v_fmac_f32 v25, v183, v15
    v_lshlrev_b32 v14, 16, v97
    v_and_b32 v15, 0xffff0000, v97
    v_fmac_f32 v18, v182, v14
    v_fmac_f32 v19, v182, v15
    v_fmac_f32 v26, v183, v14
    v_fmac_f32 v27, v183, v15
    v_lshlrev_b32 v14, 16, v98
    v_and_b32 v15, 0xffff0000, v98
    v_fmac_f32 v20, v182, v14
    v_fmac_f32 v21, v182, v15
    v_fmac_f32 v28, v183, v14
    v_fmac_f32 v29, v183, v15
    v_lshlrev_b32 v14, 16, v99
    v_and_b32 v15, 0xffff0000, v99
    v_fmac_f32 v22, v182, v14
    v_fmac_f32 v23, v182, v15
    v_fmac_f32 v30, v183, v14
    v_fmac_f32 v31, v183, v15
    s_waitcnt vmcnt(16)
    v_lshlrev_b32 v14, 16, v100
    v_and_b32 v15, 0xffff0000, v100
    v_fmac_f32 v16, v184, v14
    v_fmac_f32 v17, v184, v15
    v_fmac_f32 v24, v185, v14
    v_fmac_f32 v25, v185, v15
    v_lshlrev_b32 v14, 16, v101
    v_and_b32 v15, 0xffff0000, v101
    v_fmac_f32 v18, v184, v14
    v_fmac_f32 v19, v184, v15
    v_fmac_f32 v26, v185, v14
    v_fmac_f32 v27, v185, v15
    v_lshlrev_b32 v14, 16, v102
    v_and_b32 v15, 0xffff0000, v102
    v_fmac_f32 v20, v184, v14
    v_fmac_f32 v21, v184, v15
    v_fmac_f32 v28, v185, v14
    v_fmac_f32 v29, v185, v15
    v_lshlrev_b32 v14, 16, v103
    v_and_b32 v15, 0xffff0000, v103
    v_fmac_f32 v22, v184, v14
    v_fmac_f32 v23, v184, v15
    v_fmac_f32 v30, v185, v14
    v_fmac_f32 v31, v185, v15
    ds_read_b64 v[170:171], v6 offset:2304
    ds_read_b64 v[172:173], v6 offset:2448
    ds_read_b64 v[174:175], v6 offset:2592
    ds_read_b64 v[176:177], v6 offset:2736
    ds_read_b64 v[178:179], v6 offset:2880
    ds_read_b64 v[180:181], v6 offset:3024
    ds_read_b64 v[182:183], v6 offset:3168
    ds_read_b64 v[184:185], v6 offset:3312
    s_waitcnt lgkmcnt(0)
    s_waitcnt vmcnt(15)
    v_lshlrev_b32 v14, 16, v104
    v_and_b32 v15, 0xffff0000, v104
    v_fmac_f32 v16, v170, v14
    v_fmac_f32 v17, v170, v15
    v_fmac_f32 v24, v171, v14
    v_fmac_f32 v25, v171, v15
    v_lshlrev_b32 v14, 16, v105
    v_and_b32 v15, 0xffff0000, v105
    v_fmac_f32 v18, v170, v14
    v_fmac_f32 v19, v170, v15
    v_fmac_f32 v26, v171, v14
    v_fmac_f32 v27, v171, v15
    v_lshlrev_b32 v14, 16, v106
    v_and_b32 v15, 0xffff0000, v106
    v_fmac_f32 v20, v170, v14
    v_fmac_f32 v21, v170, v15
    v_fmac_f32 v28, v171, v14
    v_fmac_f32 v29, v171, v15
    v_lshlrev_b32 v14, 16, v107
    v_and_b32 v15, 0xffff0000, v107
    v_fmac_f32 v22, v170, v14
    v_fmac_f32 v23, v170, v15
    v_fmac_f32 v30, v171, v14
    v_fmac_f32 v31, v171, v15
    s_waitcnt vmcnt(14)
    v_lshlrev_b32 v14, 16, v108
    v_and_b32 v15, 0xffff0000, v108
    v_fmac_f32 v16, v172, v14
    v_fmac_f32 v17, v172, v15
    v_fmac_f32 v24, v173, v14
    v_fmac_f32 v25, v173, v15
    v_lshlrev_b32 v14, 16, v109
    v_and_b32 v15, 0xffff0000, v109
    v_fmac_f32 v18, v172, v14
    v_fmac_f32 v19, v172, v15
    v_fmac_f32 v26, v173, v14
    v_fmac_f32 v27, v173, v15
    v_lshlrev_b32 v14, 16, v110
    v_and_b32 v15, 0xffff0000, v110
    v_fmac_f32 v20, v172, v14
    v_fmac_f32 v21, v172, v15
    v_fmac_f32 v28, v173, v14
    v_fmac_f32 v29, v173, v15
    v_lshlrev_b32 v14, 16, v111
    v_and_b32 v15, 0xffff0000, v111
    v_fmac_f32 v22, v172, v14
    v_fmac_f32 v23, v172, v15
    v_fmac_f32 v30, v173, v14
    v_fmac_f32 v31, v173, v15
    s_waitcnt vmcnt(13)
    v_lshlrev_b32 v14, 16, v112
    v_and_b32 v15, 0xffff0000, v112
    v_fmac_f32 v16, v174, v14
    v_fmac_f32 v17, v174, v15
    v_fmac_f32 v24, v175, v14
    v_fmac_f32 v25, v175, v15
    v_lshlrev_b32 v14, 16, v113
    v_and_b32 v15, 0xffff0000, v113
    v_fmac_f32 v18, v174, v14
    v_fmac_f32 v19, v174, v15
    v_fmac_f32 v26, v175, v14
    v_fmac_f32 v27, v175, v15
    v_lshlrev_b32 v14, 16, v114
    v_and_b32 v15, 0xffff0000, v114
    v_fmac_f32 v20, v174, v14
    v_fmac_f32 v21, v174, v15
    v_fmac_f32 v28, v175, v14
    v_fmac_f32 v29, v175, v15
    v_lshlrev_b32 v14, 16, v115
    v_and_b32 v15, 0xffff0000, v115
    v_fmac_f32 v22, v174, v14
    v_fmac_f32 v23, v174, v15
    v_fmac_f32 v30, v175, v14
    v_fmac_f32 v31, v175, v15
    s_waitcnt vmcnt(12)
    v_lshlrev_b32 v14, 16, v116
    v_and_b32 v15, 0xffff0000, v116
    v_fmac_f32 v16, v176, v14
    v_fmac_f32 v17, v176, v15
    v_fmac_f32 v24, v177, v14
    v_fmac_f32 v25, v177, v15
    v_lshlrev_b32 v14, 16, v117
    v_and_b32 v15, 0xffff0000, v117
    v_fmac_f32 v18, v176, v14
    v_fmac_f32 v19, v176, v15
    v_fmac_f32 v26, v177, v14
    v_fmac_f32 v27, v177, v15
    v_lshlrev_b32 v14, 16, v118
    v_and_b32 v15, 0xffff0000, v118
    v_fmac_f32 v20, v176, v14
    v_fmac_f32 v21, v176, v15
    v_fmac_f32 v28, v177, v14
    v_fmac_f32 v29, v177, v15
    v_lshlrev_b32 v14, 16, v119
    v_and_b32 v15, 0xffff0000, v119
    v_fmac_f32 v22, v176, v14
    v_fmac_f32 v23, v176, v15
    v_fmac_f32 v30, v177, v14
    v_fmac_f32 v31, v177, v15
    s_waitcnt vmcnt(11)
    v_lshlrev_b32 v14, 16, v120
    v_and_b32 v15, 0xffff0000, v120
    v_fmac_f32 v16, v178, v14
    v_fmac_f32 v17, v178, v15
    v_fmac_f32 v24, v179, v14
    v_fmac_f32 v25, v179, v15
    v_lshlrev_b32 v14, 16, v121
    v_and_b32 v15, 0xffff0000, v121
    v_fmac_f32 v18, v178, v14
    v_fmac_f32 v19, v178, v15
    v_fmac_f32 v26, v179, v14
    v_fmac_f32 v27, v179, v15
    v_lshlrev_b32 v14, 16, v122
    v_and_b32 v15, 0xffff0000, v122
    v_fmac_f32 v20, v178, v14
    v_fmac_f32 v21, v178, v15
    v_fmac_f32 v28, v179, v14
    v_fmac_f32 v29, v179, v15
    v_lshlrev_b32 v14, 16, v123
    v_and_b32 v15, 0xffff0000, v123
    v_fmac_f32 v22, v178, v14
    v_fmac_f32 v23, v178, v15
    v_fmac_f32 v30, v179, v14
    v_fmac_f32 v31, v179, v15
    s_waitcnt vmcnt(10)
    v_lshlrev_b32 v14, 16, v124
    v_and_b32 v15, 0xffff0000, v124
    v_fmac_f32 v16, v180, v14
    v_fmac_f32 v17, v180, v15
    v_fmac_f32 v24, v181, v14
    v_fmac_f32 v25, v181, v15
    v_lshlrev_b32 v14, 16, v125
    v_and_b32 v15, 0xffff0000, v125
    v_fmac_f32 v18, v180, v14
    v_fmac_f32 v19, v180, v15
    v_fmac_f32 v26, v181, v14
    v_fmac_f32 v27, v181, v15
    v_lshlrev_b32 v14, 16, v126
    v_and_b32 v15, 0xffff0000, v126
    v_fmac_f32 v20, v180, v14
    v_fmac_f32 v21, v180, v15
    v_fmac_f32 v28, v181, v14
    v_fmac_f32 v29, v181, v15
    v_lshlrev_b32 v14, 16, v127
    v_and_b32 v15, 0xffff0000, v127
    v_fmac_f32 v22, v180, v14
    v_fmac_f32 v23, v180, v15
    v_fmac_f32 v30, v181, v14
    v_fmac_f32 v31, v181, v15
    s_waitcnt vmcnt(9)
    v_lshlrev_b32 v14, 16, v128
    v_and_b32 v15, 0xffff0000, v128
    v_fmac_f32 v16, v182, v14
    v_fmac_f32 v17, v182, v15
    v_fmac_f32 v24, v183, v14
    v_fmac_f32 v25, v183, v15
    v_lshlrev_b32 v14, 16, v129
    v_and_b32 v15, 0xffff0000, v129
    v_fmac_f32 v18, v182, v14
    v_fmac_f32 v19, v182, v15
    v_fmac_f32 v26, v183, v14
    v_fmac_f32 v27, v183, v15
    v_lshlrev_b32 v14, 16, v130
    v_and_b32 v15, 0xffff0000, v130
    v_fmac_f32 v20, v182, v14
    v_fmac_f32 v21, v182, v15
    v_fmac_f32 v28, v183, v14
    v_fmac_f32 v29, v183, v15
    v_lshlrev_b32 v14, 16, v131
    v_and_b32 v15, 0xffff0000, v131
    v_fmac_f32 v22, v182, v14
    v_fmac_f32 v23, v182, v15
    v_fmac_f32 v30, v183, v14
    v_fmac_f32 v31, v183, v15
    s_waitcnt vmcnt(8)
    v_lshlrev_b32 v14, 16, v132
    v_and_b32 v15, 0xffff0000, v132
    v_fmac_f32 v16, v184, v14
    v_fmac_f32 v17, v184, v15
    v_fmac_f32 v24, v185, v14
    v_fmac_f32 v25, v185, v15
    v_lshlrev_b32 v14, 16, v133
    v_and_b32 v15, 0xffff0000, v133
    v_fmac_f32 v18, v184, v14
    v_fmac_f32 v19, v184, v15
    v_fmac_f32 v26, v185, v14
    v_fmac_f32 v27, v185, v15
    v_lshlrev_b32 v14, 16, v134
    v_and_b32 v15, 0xffff0000, v134
    v_fmac_f32 v20, v184, v14
    v_fmac_f32 v21, v184, v15
    v_fmac_f32 v28, v185, v14
    v_fmac_f32 v29, v185, v15
    v_lshlrev_b32 v14, 16, v135
    v_and_b32 v15, 0xffff0000, v135
    v_fmac_f32 v22, v184, v14
    v_fmac_f32 v23, v184, v15
    v_fmac_f32 v30, v185, v14
    v_fmac_f32 v31, v185, v15
    ds_read_b64 v[170:171], v6 offset:3456
    ds_read_b64 v[172:173], v6 offset:3600
    ds_read_b64 v[174:175], v6 offset:3744
    ds_read_b64 v[176:177], v6 offset:3888
    ds_read_b64 v[178:179], v6 offset:4032
    ds_read_b64 v[180:181], v6 offset:4176
    ds_read_b64 v[182:183], v6 offset:4320
    ds_read_b64 v[184:185], v6 offset:4464
    s_waitcnt lgkmcnt(0)
    s_waitcnt vmcnt(7)
    v_lshlrev_b32 v14, 16, v136
    v_and_b32 v15, 0xffff0000, v136
    v_fmac_f32 v16, v170, v14
    v_fmac_f32 v17, v170, v15
    v_fmac_f32 v24, v171, v14
    v_fmac_f32 v25, v171, v15
    v_lshlrev_b32 v14, 16, v137
    v_and_b32 v15, 0xffff0000, v137
    v_fmac_f32 v18, v170, v14
    v_fmac_f32 v19, v170, v15
    v_fmac_f32 v26, v171, v14
    v_fmac_f32 v27, v171, v15
    v_lshlrev_b32 v14, 16, v138
    v_and_b32 v15, 0xffff0000, v138
    v_fmac_f32 v20, v170, v14
    v_fmac_f32 v21, v170, v15
    v_fmac_f32 v28, v171, v14
    v_fmac_f32 v29, v171, v15
    v_lshlrev_b32 v14, 16, v139
    v_and_b32 v15, 0xffff0000, v139
    v_fmac_f32 v22, v170, v14
    v_fmac_f32 v23, v170, v15
    v_fmac_f32 v30, v171, v14
    v_fmac_f32 v31, v171, v15
    s_waitcnt vmcnt(6)
    v_lshlrev_b32 v14, 16, v140
    v_and_b32 v15, 0xffff0000, v140
    v_fmac_f32 v16, v172, v14
    v_fmac_f32 v17, v172, v15
    v_fmac_f32 v24, v173, v14
    v_fmac_f32 v25, v173, v15
    v_lshlrev_b32 v14, 16, v141
    v_and_b32 v15, 0xffff0000, v141
    v_fmac_f32 v18, v172, v14
    v_fmac_f32 v19, v172, v15
    v_fmac_f32 v26, v173, v14
    v_fmac_f32 v27, v173, v15
    v_lshlrev_b32 v14, 16, v142
    v_and_b32 v15, 0xffff0000, v142
    v_fmac_f32 v20, v172, v14
    v_fmac_f32 v21, v172, v15
    v_fmac_f32 v28, v173, v14
    v_fmac_f32 v29, v173, v15
    v_lshlrev_b32 v14, 16, v143
    v_and_b32 v15, 0xffff0000, v143
    v_fmac_f32 v22, v172, v14
    v_fmac_f32 v23, v172, v15
    v_fmac_f32 v30, v173, v14
    v_fmac_f32 v31, v173, v15
    s_waitcnt vmcnt(5)
    v_lshlrev_b32 v14, 16, v144
    v_and_b32 v15, 0xffff0000, v144
    v_fmac_f32 v16, v174, v14
    v_fmac_f32 v17, v174, v15
    v_fmac_f32 v24, v175, v14
    v_fmac_f32 v25, v175, v15
    v_lshlrev_b32 v14, 16, v145
    v_and_b32 v15, 0xffff0000, v145
    v_fmac_f32 v18, v174, v14
    v_fmac_f32 v19, v174, v15
    v_fmac_f32 v26, v175, v14
    v_fmac_f32 v27, v175, v15
    v_lshlrev_b32 v14, 16, v146
    v_and_b32 v15, 0xffff0000, v146
    v_fmac_f32 v20, v174, v14
    v_fmac_f32 v21, v174, v15
    v_fmac_f32 v28, v175, v14
    v_fmac_f32 v29, v175, v15
    v_lshlrev_b32 v14, 16, v147
    v_and_b32 v15, 0xffff0000, v147
    v_fmac_f32 v22, v174, v14
    v_fmac_f32 v23, v174, v15
    v_fmac_f32 v30, v175, v14
    v_fmac_f32 v31, v175, v15
    s_waitcnt vmcnt(4)
    v_lshlrev_b32 v14, 16, v148
    v_and_b32 v15, 0xffff0000, v148
    v_fmac_f32 v16, v176, v14
    v_fmac_f32 v17, v176, v15
    v_fmac_f32 v24, v177, v14
    v_fmac_f32 v25, v177, v15
    v_lshlrev_b32 v14, 16, v149
    v_and_b32 v15, 0xffff0000, v149
    v_fmac_f32 v18, v176, v14
    v_fmac_f32 v19, v176, v15
    v_fmac_f32 v26, v177, v14
    v_fmac_f32 v27, v177, v15
    v_lshlrev_b32 v14, 16, v150
    v_and_b32 v15, 0xffff0000, v150
    v_fmac_f32 v20, v176, v14
    v_fmac_f32 v21, v176, v15
    v_fmac_f32 v28, v177, v14
    v_fmac_f32 v29, v177, v15
    v_lshlrev_b32 v14, 16, v151
    v_and_b32 v15, 0xffff0000, v151
    v_fmac_f32 v22, v176, v14
    v_fmac_f32 v23, v176, v15
    v_fmac_f32 v30, v177, v14
    v_fmac_f32 v31, v177, v15
    s_waitcnt vmcnt(3)
    v_lshlrev_b32 v14, 16, v152
    v_and_b32 v15, 0xffff0000, v152
    v_fmac_f32 v16, v178, v14
    v_fmac_f32 v17, v178, v15
    v_fmac_f32 v24, v179, v14
    v_fmac_f32 v25, v179, v15
    v_lshlrev_b32 v14, 16, v153
    v_and_b32 v15, 0xffff0000, v153
    v_fmac_f32 v18, v178, v14
    v_fmac_f32 v19, v178, v15
    v_fmac_f32 v26, v179, v14
    v_fmac_f32 v27, v179, v15
    v_lshlrev_b32 v14, 16, v154
    v_and_b32 v15, 0xffff0000, v154
    v_fmac_f32 v20, v178, v14
    v_fmac_f32 v21, v178, v15
    v_fmac_f32 v28, v179, v14
    v_fmac_f32 v29, v179, v15
    v_lshlrev_b32 v14, 16, v155
    v_and_b32 v15, 0xffff0000, v155
    v_fmac_f32 v22, v178, v14
    v_fmac_f32 v23, v178, v15
    v_fmac_f32 v30, v179, v14
    v_fmac_f32 v31, v179, v15
    s_waitcnt vmcnt(2)
    v_lshlrev_b32 v14, 16, v156
    v_and_b32 v15, 0xffff0000, v156
    v_fmac_f32 v16, v180, v14
    v_fmac_f32 v17, v180, v15
    v_fmac_f32 v24, v181, v14
    v_fmac_f32 v25, v181, v15
    v_lshlrev_b32 v14, 16, v157
    v_and_b32 v15, 0xffff0000, v157
    v_fmac_f32 v18, v180, v14
    v_fmac_f32 v19, v180, v15
    v_fmac_f32 v26, v181, v14
    v_fmac_f32 v27, v181, v15
    v_lshlrev_b32 v14, 16, v158
    v_and_b32 v15, 0xffff0000, v158
    v_fmac_f32 v20, v180, v14
    v_fmac_f32 v21, v180, v15
    v_fmac_f32 v28, v181, v14
    v_fmac_f32 v29, v181, v15
    v_lshlrev_b32 v14, 16, v159
    v_and_b32 v15, 0xffff0000, v159
    v_fmac_f32 v22, v180, v14
    v_fmac_f32 v23, v180, v15
    v_fmac_f32 v30, v181, v14
    v_fmac_f32 v31, v181, v15
    s_waitcnt vmcnt(1)
    v_lshlrev_b32 v14, 16, v160
    v_and_b32 v15, 0xffff0000, v160
    v_fmac_f32 v16, v182, v14
    v_fmac_f32 v17, v182, v15
    v_fmac_f32 v24, v183, v14
    v_fmac_f32 v25, v183, v15
    v_lshlrev_b32 v14, 16, v161
    v_and_b32 v15, 0xffff0000, v161
    v_fmac_f32 v18, v182, v14
    v_fmac_f32 v19, v182, v15
    v_fmac_f32 v26, v183, v14
    v_fmac_f32 v27, v183, v15
    v_lshlrev_b32 v14, 16, v162
    v_and_b32 v15, 0xffff0000, v162
    v_fmac_f32 v20, v182, v14
    v_fmac_f32 v21, v182, v15
    v_fmac_f32 v28, v183, v14
    v_fmac_f32 v29, v183, v15
    v_lshlrev_b32 v14, 16, v163
    v_and_b32 v15, 0xffff0000, v163
    v_fmac_f32 v22, v182, v14
    v_fmac_f32 v23, v182, v15
    v_fmac_f32 v30, v183, v14
    v_fmac_f32 v31, v183, v15
    s_waitcnt vmcnt(0)
    v_lshlrev_b32 v14, 16, v164
    v_and_b32 v15, 0xffff0000, v164
    v_fmac_f32 v16, v184, v14
    v_fmac_f32 v17, v184, v15
    v_fmac_f32 v24, v185, v14
    v_fmac_f32 v25, v185, v15
    v_lshlrev_b32 v14, 16, v165
    v_and_b32 v15, 0xffff0000, v165
    v_fmac_f32 v18, v184, v14
    v_fmac_f32 v19, v184, v15
    v_fmac_f32 v26, v185, v14
    v_fmac_f32 v27, v185, v15
    v_lshlrev_b32 v14, 16, v166
    v_and_b32 v15, 0xffff0000, v166
    v_fmac_f32 v20, v184, v14
    v_fmac_f32 v21, v184, v15
    v_fmac_f32 v28, v185, v14
    v_fmac_f32 v29, v185, v15
    v_lshlrev_b32 v14, 16, v167
    v_and_b32 v15, 0xffff0000, v167
    v_fmac_f32 v22, v184, v14
    v_fmac_f32 v23, v184, v15
    v_fmac_f32 v30, v185, v14
    v_fmac_f32 v31, v185, v15
    v_mul_u32_u24 v6, 1152, v1
    v_lshlrev_b32 v7, 5, v2
    v_add_u32 v6, v6, v7
    ds_write_b128 v6, v[16:19] offset:8192
    ds_write_b128 v6, v[20:23] offset:8208
    ds_write_b128 v6, v[24:27] offset:8768
    ds_write_b128 v6, v[28:31] offset:8784
    s_waitcnt lgkmcnt(0)
    s_barrier
    v_lshlrev_b32 v6, 2, v0
    ds_read_b32 v40, v6 offset:8192
    ds_read_b32 v41, v6 offset:9344
    ds_read_b32 v42, v6 offset:10496
    ds_read_b32 v43, v6 offset:11648
    ds_read_b32 v44, v6 offset:12800
    ds_read_b32 v45, v6 offset:13952
    ds_read_b32 v46, v6 offset:15104
    ds_read_b32 v47, v6 offset:16256
    ds_read_b32 v48, v6 offset:17408
    ds_read_b32 v49, v6 offset:18560
    ds_read_b32 v50, v6 offset:19712
    ds_read_b32 v51, v6 offset:20864
    ds_read_b32 v52, v6 offset:22016
    ds_read_b32 v53, v6 offset:23168
    ds_read_b32 v54, v6 offset:24320
    ds_read_b32 v55, v6 offset:25472
    ds_read_b32 v56, v6 offset:26624
    ds_read_b32 v57, v6 offset:27776
    s_waitcnt lgkmcnt(0)
    v_add_f32 v40, v40, v41
    v_add_f32 v40, v40, v42
    v_add_f32 v40, v40, v43
    v_add_f32 v40, v40, v44
    v_add_f32 v40, v40, v45
    v_add_f32 v40, v40, v46
    v_add_f32 v40, v40, v47
    v_add_f32 v40, v40, v48
    v_add_f32 v40, v40, v49
    v_add_f32 v40, v40, v50
    v_add_f32 v40, v40, v51
    v_add_f32 v40, v40, v52
    v_add_f32 v40, v40, v53
    v_add_f32 v40, v40, v54
    v_add_f32 v40, v40, v55
    v_add_f32 v40, v40, v56
    v_add_f32 v40, v40, v57
    s_mov_b32 s6, 0xbfb8aa3b
    v_mul_f32 v40, s6, v40
    v_cmp_le_u32 vcc, 144, v0
    v_mov_b32 v7, 0
    v_mov_b32 v8, 17856
    v_cndmask_b32 v7, v7, v8, vcc
    v_add_u32 v6, v6, v7
    s_mul_i32 s6, s4, 36864
    s_mul_i32 s7, s5, 576
    s_add_u32 s6, s6, s7
    v_cmp_gt_u32 vcc, 288, v0
    s_nop 0
    s_and_saveexec_b64 s[28:29], vcc
    s_cbranch_execz P2_Z_1
    buffer_store_dword v40, v6, s[24:27], s6 offen
P2_Z_1:
    s_mov_b64 exec, -1
    s_branch P2_END
P2_END:
    s_endpgm
.globl gg_kernel
.p2align 8
.type gg_kernel,@function
gg_kernel:
    s_cmp_ge_u32 s2, 256
    s_cbranch_scc1 G1_END
    s_load_dwordx2 s[8:9], s[0:1], 136
    s_load_dwordx2 s[12:13], s[0:1], 80
    s_load_dwordx2 s[16:17], s[0:1], 88
    s_and_b32 s3, s2, 7
    s_lshr_b32 s4, s2, 3
    s_and_b32 s5, s4, 7
    s_lshr_b32 s4, s4, 3
    s_lshl_b32 s3, s3, 2
    s_add_u32 s6, s3, s4
    v_lshrrev_b32 v1, 6, v0
    s_nop 0
    v_readfirstlane_b32 s7, v1
    v_and_b32 v1, 63, v0
    s_mov_b32 s92, s2
    s_mov_b32 s93, s7
    s_lshr_b32 s20, s7, 1
    s_and_b32 s21, s7, 1
    v_lshrrev_b32 v12, 5, v1
    v_and_b32 v13, 31, v1
    s_lshl_b32 s22, s7, 2
    v_add_u32 v14, s22, v12
    v_and_b32 v15, 7, v14
    v_lshlrev_b32 v15, 1, v15
    v_xor_b32 v15, v15, v13
    v_lshlrev_b32 v15, 4, v15
    v_lshlrev_b32 v14, 12, v14
    v_add_u32 v14, v14, v15
    s_lshl_b32 s23, s5, 9
    v_add_u32 v8, s23, v14
    v_add_u32 v14, s22, v12
    v_add_u32 v14, 2, v14
    v_and_b32 v15, 7, v14
    v_lshlrev_b32 v15, 1, v15
    v_xor_b32 v15, v15, v13
    v_lshlrev_b32 v15, 4, v15
    v_lshlrev_b32 v14, 12, v14
    v_add_u32 v14, v14, v15
    s_lshl_b32 s23, s5, 9
    s_sub_u32 s23, s23, 1024
    v_add_u32 v9, s23, v14
    s_mul_i32 s24, s6, 288
    s_lshl_b32 s23, s7, 6
    v_add_u32 v14, s23, v1
    v_mul_u32_u24 v15, 3641, v14
    v_lshrrev_b32 v15, 16, v15
    v_mul_u32_u24 v16, 18, v15
    v_sub_u32 v16, v14, v16
    v_mul_u32_u24 v15, 9216, v15
    v_lshlrev_b32 v16, 4, v16
    v_add_u32 v15, v15, v16
    v_add_u32 v10, s24, v15
    s_and_b32 s23, s7, 3
    s_lshl_b32 s23, s23, 4
    s_add_u32 s23, s23, 512
    v_lshrrev_b32 v14, 2, v1
    v_add_u32 v14, s23, v14
    v_mul_u32_u24 v15, 3641, v14
    v_lshrrev_b32 v15, 16, v15
    v_mul_u32_u24 v16, 18, v15
    v_sub_u32 v16, v14, v16
    v_mul_u32_u24 v15, 9216, v15
    v_lshlrev_b32 v16, 4, v16
    v_add_u32 v15, v15, v16
    v_and_b32 v16, 3, v1
    v_lshlrev_b32 v16, 2, v16
    v_add_u32 v15, v15, v16
    v_add_u32 v11, s24, v15
    s_lshl_b32 s49, s7, 11
    s_lshl_b32 s50, s7, 10
    s_add_u32 s50, s50, 16384
    s_mov_b32 s51, 0
    s_mov_b32 s52, 0
    v_and_b32 v12, 3, v0
    v_lshrrev_b32 v13, 2, v0
    v_lshlrev_b32 v14, 12, v13
    v_lshlrev_b32 v15, 2, v12
    v_add_u32 v14, v14, v15
    s_lshl_b32 s22, s5, 9
    s_lshl_b32 s23, s6, 4
    s_add_u32 s22, s22, s23
    v_add_u32 v14, s22, v14
    s_cmp_lt_u32 s7, 4
    s_cselect_b32 s48, 0, 9216
    s_cselect_b64 s[70:71], -1, 0
    s_and_b32 s23, s7, 3
    s_lshl_b32 s23, s23, 8
    s_add_u32 s48, s48, s23
    s_add_u32 s48, s48, 16384+8192
    s_waitcnt lgkmcnt(0)
    s_add_u32 s24, s8, 0xb00000
    s_addc_u32 s25, s9, 0
    s_mov_b32 s26, 0x240000
    s_mov_b32 s27, 0x00020000
    s_mov_b32 s14, 0x510000
    s_mov_b32 s15, 0x00020000
    s_mov_b32 s18, 0x510000
    s_mov_b32 s19, 0x00020000
    s_cmp_lt_u32 s7, 4
    s_cselect_b32 s44, s12, s16
    s_cselect_b32 s45, s13, s17
    s_mov_b32 s46, s14
    s_mov_b32 s47, 0x00020000
    s_add_u32 s28, s8, 0x800000
    s_addc_u32 s29, s9, 0
    s_mov_b32 s30, 0x240000
    s_mov_b32 s31, 0x00020000
    s_add_u32 m0, s49, 0
    s_nop 0
    buffer_load_dwordx4 v8, s[24:27], s51 offen lds
    buffer_load_dwordx4 v9, s[24:27], s51 offen offset:1024 lds
    s_add_u32 s51, s51, 0x20000
    s_add_u32 m0, s50, 0
    s_nop 0
    buffer_load_dwordx4 v10, s[12:15], s52 offen lds
    s_add_u32 m0, s50, 9216
    s_nop 0
    buffer_load_dwordx4 v10, s[16:19], s52 offen lds
    s_add_u32 m0, s48, 0
    s_nop 0
    buffer_load_dword v11, s[44:47], s52 offen lds
    s_add_u32 s52, s52, 294912
    s_add_u32 m0, s49, 34816
    s_nop 0
    buffer_load_dwordx4 v8, s[24:27], s51 offen lds
    buffer_load_dwordx4 v9, s[24:27], s51 offen offset:1024 lds
    s_add_u32 s51, s51, 0x20000
    s_add_u32 m0, s50, 34816
    s_nop 0
    buffer_load_dwordx4 v10, s[12:15], s52 offen lds
    s_add_u32 m0, s50, 44032
    s_nop 0
    buffer_load_dwordx4 v10, s[16:19], s52 offen lds
    s_add_u32 m0, s48, 34816
    s_nop 0
    buffer_load_dword v11, s[44:47], s52 offen lds
    s_add_u32 s52, s52, 294912
    v_lshrrev_b32 v12, 4, v1
    v_and_b32 v13, 15, v1
    v_lshrrev_b32 v13, 2, v13
    v_and_b32 v15, 3, v1
    v_lshlrev_b32 v16, 2, v12
    v_add_u32 v16, v16, v13
    v_mul_u32_u24 v17, 288, v16
    v_lshlrev_b32 v18, 3, v15
    v_add_u32 v6, v17, v18
    s_mul_i32 s22, s21, 160
    s_add_u32 s22, s22, 16384
    v_add_u32 v6, s22, v6
    v_and_b32 v18, 1, v15
    v_lshlrev_b32 v18, 3, v18
    v_add_u32 v7, v17, v18
    v_lshrrev_b32 v18, 1, v15
    v_mul_u32_u24 v18, 9216, v18
    v_add_u32 v7, v7, v18
    s_lshl_b32 s22, s21, 4
    s_add_u32 s22, s22, 16384+128
    v_add_u32 v7, s22, v7
    v_lshrrev_b32 v17, 1, v15
    s_lshl_b32 s22, s20, 3
    v_add_u32 v17, s22, v17
    v_and_b32 v18, 7, v16
    v_lshlrev_b32 v18, 1, v18
    v_xor_b32 v17, v17, v18
    v_lshlrev_b32 v17, 4, v17
    v_lshlrev_b32 v18, 9, v16
    v_add_u32 v17, v17, v18
    v_and_b32 v18, 1, v15
    v_lshlrev_b32 v18, 3, v18
    v_add_u32 v2, v17, v18
    v_xor_b32 v3, 32, v2
    v_xor_b32 v4, 64, v2
    v_xor_b32 v5, 96, v2
    v_add_u32 v32, 69632, v2
    v_add_u32 v33, 69632, v3
    v_add_u32 v34, 69632, v4
    v_add_u32 v35, 69632, v5
    v_add_u32 v36, 69632, v6
    v_add_u32 v37, 69632, v7
    s_add_u32 s32, s8, 0x320000
    s_addc_u32 s33, s9, 0
    s_mov_b32 s34, 0x4000
    s_mov_b32 s35, 0x00020000
    s_add_u32 s36, s8, 0x330000
    s_addc_u32 s37, s9, 0
    s_mov_b32 s38, 0x12000
    s_mov_b32 s39, 0x00020000
    s_add_u32 s40, s8, 0x1000000
    s_addc_u32 s41, s9, 0
    s_mov_b32 s42, 0x1200000
    s_mov_b32 s43, 0x00020000
    s_add_u32 s72, s8, 0x2400000
    s_addc_u32 s73, s9, 0
    s_mov_b32 s74, 0x6c2000
    s_mov_b32 s75, 0x00020000
    v_and_b32 v13, 15, v1
    s_lshl_b32 s22, s5, 8
    s_lshl_b32 s23, s20, 6
    s_add_u32 s22, s22, s23
    v_add_u32 v38, s22, v13
    v_lshlrev_b32 v38, 3, v38
    v_lshrrev_b32 v39, 5, v1
    v_lshlrev_b32 v39, 7, v39
    v_add_u32 v39, v39, v38
    v_lshrrev_b32 v12, 4, v1
    s_mul_i32 s22, s6, 144
    s_mul_i32 s23, s21, 80
    s_add_u32 s22, s22, s23
    v_lshlrev_b32 v40, 2, v12
    v_add_u32 v40, s22, v40
    v_lshlrev_b32 v40, 2, v40
    s_mul_i32 s22, s6, 144
    s_lshl_b32 s23, s21, 3
    s_add_u32 s22, s22, s23
    s_add_u32 s22, s22, 64
    v_and_b32 v41, 1, v12
    v_lshlrev_b32 v41, 2, v41
    v_add_u32 v41, s22, v41
    v_lshlrev_b32 v41, 2, v41
    s_mov_b32 s60, 0
    s_mov_b32 s61, 18432
    s_mov_b32 s62, 36864
    s_mov_b32 s63, 55296
    s_waitcnt vmcnt(5)
    s_barrier
    ds_read_b64_tr_b16 v[76:77], v6 offset:0
    ds_read_b64_tr_b16 v[78:79], v6 offset:4608
    ds_read_b64_tr_b16 v[80:81], v6 offset:32
    ds_read_b64_tr_b16 v[82:83], v6 offset:4640
    ds_read_b64_tr_b16 v[44:45], v2 offset:0
    ds_read_b64_tr_b16 v[46:47], v2 offset:8192
    ds_read_b64_tr_b16 v[48:49], v3 offset:0
    ds_read_b64_tr_b16 v[50:51], v3 offset:8192
    ds_read_b64_tr_b16 v[52:53], v4 offset:0
    ds_read_b64_tr_b16 v[54:55], v4 offset:8192
    ds_read_b64_tr_b16 v[56:57], v5 offset:0
    ds_read_b64_tr_b16 v[58:59], v5 offset:8192
    s_add_u32 m0, s49, 69632
    s_nop 0
    buffer_load_dwordx4 v8, s[24:27], s51 offen lds
    buffer_load_dwordx4 v9, s[24:27], s51 offen offset:1024 lds
    s_add_u32 s51, s51, 0x20000
    s_add_u32 m0, s50, 69632
    s_nop 0
    buffer_load_dwordx4 v10, s[12:15], s52 offen lds
    s_add_u32 m0, s50, 78848
    s_nop 0
    buffer_load_dwordx4 v10, s[16:19], s52 offen lds
    s_add_u32 m0, s48, 69632
    s_nop 0
    buffer_load_dword v11, s[44:47], s52 offen lds
    s_add_u32 s52, s52, 294912
    ds_read_b64_tr_b16 v[84:85], v6 offset:64
    ds_read_b64_tr_b16 v[86:87], v6 offset:4672
    ds_read_b64_tr_b16 v[88:89], v6 offset:96
    ds_read_b64_tr_b16 v[90:91], v6 offset:4704
    ds_read_b64_tr_b16 v[92:93], v6 offset:9216
    ds_read_b64_tr_b16 v[94:95], v6 offset:13824
    ds_read_b64_tr_b16 v[96:97], v6 offset:9248
    ds_read_b64_tr_b16 v[98:99], v6 offset:13856
    ds_read_b64_tr_b16 v[100:101], v6 offset:9280
    ds_read_b64_tr_b16 v[102:103], v6 offset:13888
    ds_read_b64_tr_b16 v[104:105], v6 offset:9312
    ds_read_b64_tr_b16 v[106:107], v6 offset:13920
    ds_read_b64_tr_b16 v[108:109], v7 offset:0
    ds_read_b64_tr_b16 v[110:111], v7 offset:4608
    s_waitcnt lgkmcnt(14)
    v_mfma_f32_16x16x32_bf16 v[112:115], v[76:79], v[44:47], 0
    v_mfma_f32_16x16x32_bf16 v[116:119], v[76:79], v[48:51], 0
    v_mfma_f32_16x16x32_bf16 v[120:123], v[76:79], v[52:55], 0
    v_mfma_f32_16x16x32_bf16 v[124:127], v[76:79], v[56:59], 0
    v_mfma_f32_16x16x32_bf16 v[128:131], v[80:83], v[44:47], 0
    v_mfma_f32_16x16x32_bf16 v[132:135], v[80:83], v[48:51], 0
    v_mfma_f32_16x16x32_bf16 v[136:139], v[80:83], v[52:55], 0
    v_mfma_f32_16x16x32_bf16 v[140:143], v[80:83], v[56:59], 0
    s_waitcnt vmcnt(5) lgkmcnt(0)
    s_barrier
    v_mfma_f32_16x16x32_bf16 v[144:147], v[84:87], v[44:47], 0
    ds_read_b64_tr_b16 v[76:77], v6 offset:34816
    ds_read_b64_tr_b16 v[78:79], v6 offset:39424
    v_mfma_f32_16x16x32_bf16 v[148:151], v[84:87], v[48:51], 0
    s_add_u32 m0, s49, 104448
    s_nop 0
    buffer_load_dwordx4 v8, s[24:27], s51 offen lds
    v_mfma_f32_16x16x32_bf16 v[152:155], v[84:87], v[52:55], 0
    ds_read_b64_tr_b16 v[80:81], v6 offset:34848
    ds_read_b64_tr_b16 v[82:83], v6 offset:39456
    v_mfma_f32_16x16x32_bf16 v[156:159], v[84:87], v[56:59], 0
    v_mfma_f32_16x16x32_bf16 v[160:163], v[88:91], v[44:47], 0
    ds_read_b64_tr_b16 v[60:61], v2 offset:34816
    ds_read_b64_tr_b16 v[62:63], v2 offset:43008
    v_mfma_f32_16x16x32_bf16 v[164:167], v[88:91], v[48:51], 0
    buffer_load_dwordx4 v9, s[24:27], s51 offen offset:1024 lds
    s_add_u32 s51, s51, 0x20000
    v_mfma_f32_16x16x32_bf16 v[168:171], v[88:91], v[52:55], 0
    ds_read_b64_tr_b16 v[64:65], v3 offset:34816
    ds_read_b64_tr_b16 v[66:67], v3 offset:43008
    v_mfma_f32_16x16x32_bf16 v[172:175], v[88:91], v[56:59], 0
    v_mfma_f32_16x16x32_bf16 v[176:179], v[92:95], v[44:47], 0
    ds_read_b64_tr_b16 v[68:69], v4 offset:34816
    ds_read_b64_tr_b16 v[70:71], v4 offset:43008
    v_mfma_f32_16x16x32_bf16 v[180:183], v[92:95], v[48:51], 0
    s_add_u32 m0, s50, 104448
    s_nop 0
    buffer_load_dwordx4 v10, s[12:15], s52 offen lds
    v_mfma_f32_16x16x32_bf16 v[184:187], v[92:95], v[52:55], 0
    ds_read_b64_tr_b16 v[72:73], v5 offset:34816
    ds_read_b64_tr_b16 v[74:75], v5 offset:43008
    v_mfma_f32_16x16x32_bf16 v[188:191], v[92:95], v[56:59], 0
    v_mfma_f32_16x16x32_bf16 v[192:195], v[96:99], v[44:47], 0
    ds_read_b64_tr_b16 v[84:85], v6 offset:34880
    ds_read_b64_tr_b16 v[86:87], v6 offset:39488
    v_mfma_f32_16x16x32_bf16 v[196:199], v[96:99], v[48:51], 0
    ds_read_b64_tr_b16 v[88:89], v6 offset:34912
    ds_read_b64_tr_b16 v[90:91], v6 offset:39520
    s_add_u32 m0, s50, 113664
    s_nop 0
    buffer_load_dwordx4 v10, s[16:19], s52 offen lds
    v_mfma_f32_16x16x32_bf16 v[200:203], v[96:99], v[52:55], 0
    ds_read_b64_tr_b16 v[92:93], v6 offset:44032
    ds_read_b64_tr_b16 v[94:95], v6 offset:48640
    v_mfma_f32_16x16x32_bf16 v[204:207], v[96:99], v[56:59], 0
    v_mfma_f32_16x16x32_bf16 v[208:211], v[100:103], v[44:47], 0
    ds_read_b64_tr_b16 v[96:97], v6 offset:44064
    ds_read_b64_tr_b16 v[98:99], v6 offset:48672
    v_mfma_f32_16x16x32_bf16 v[212:215], v[100:103], v[48:51], 0
    s_add_u32 m0, s48, 104448
    s_nop 0
    buffer_load_dword v11, s[44:47], s52 offen lds
    s_add_u32 s52, s52, 294912
    v_mfma_f32_16x16x32_bf16 v[216:219], v[100:103], v[52:55], 0
    v_mfma_f32_16x16x32_bf16 v[220:223], v[100:103], v[56:59], 0
    v_mfma_f32_16x16x32_bf16 v[224:227], v[104:107], v[44:47], 0
    ds_read_b64_tr_b16 v[100:101], v6 offset:44096
    ds_read_b64_tr_b16 v[102:103], v6 offset:48704
    v_mfma_f32_16x16x32_bf16 v[228:231], v[104:107], v[48:51], 0
    s_add_u32 m0, s49, 0
    s_nop 0
    buffer_load_dwordx4 v8, s[24:27], s51 offen lds
    v_mfma_f32_16x16x32_bf16 v[232:235], v[104:107], v[52:55], 0
    v_mfma_f32_16x16x32_bf16 v[236:239], v[104:107], v[56:59], 0
    v_mfma_f32_16x16x32_bf16 v[240:243], v[108:111], v[44:47], 0
    ds_read_b64_tr_b16 v[104:105], v6 offset:44128
    ds_read_b64_tr_b16 v[106:107], v6 offset:48736
    v_mfma_f32_16x16x32_bf16 v[244:247], v[108:111], v[48:51], 0
    v_mfma_f32_16x16x32_bf16 v[248:251], v[108:111], v[52:55], 0
    v_mfma_f32_16x16x32_bf16 v[252:255], v[108:111], v[56:59], 0
    ds_read_b64_tr_b16 v[108:109], v7 offset:34816
    ds_read_b64_tr_b16 v[110:111], v7 offset:39424
    s_waitcnt lgkmcnt(14)
    v_mfma_f32_16x16x32_bf16 v[112:115], v[76:79], v[60:63], v[112:115]
    v_mfma_f32_16x16x32_bf16 v[116:119], v[76:79], v[64:67], v[116:119]
    v_mfma_f32_16x16x32_bf16 v[120:123], v[76:79], v[68:71], v[120:123]
    v_mfma_f32_16x16x32_bf16 v[124:127], v[76:79], v[72:75], v[124:127]
    v_mfma_f32_16x16x32_bf16 v[128:131], v[80:83], v[60:63], v[128:131]
    v_mfma_f32_16x16x32_bf16 v[132:135], v[80:83], v[64:67], v[132:135]
    v_mfma_f32_16x16x32_bf16 v[136:139], v[80:83], v[68:71], v[136:139]
    v_mfma_f32_16x16x32_bf16 v[140:143], v[80:83], v[72:75], v[140:143]
    s_waitcnt vmcnt(6) lgkmcnt(0)
    s_barrier
    v_mfma_f32_16x16x32_bf16 v[144:147], v[84:87], v[60:63], v[144:147]
    ds_read_b64_tr_b16 v[76:77], v36 offset:0
    ds_read_b64_tr_b16 v[78:79], v36 offset:4608
    v_mfma_f32_16x16x32_bf16 v[148:151], v[84:87], v[64:67], v[148:151]
    buffer_load_dwordx4 v9, s[24:27], s51 offen offset:1024 lds
    s_add_u32 s51, s51, 0x20000
    v_mfma_f32_16x16x32_bf16 v[152:155], v[84:87], v[68:71], v[152:155]
    ds_read_b64_tr_b16 v[80:81], v36 offset:32
    ds_read_b64_tr_b16 v[82:83], v36 offset:4640
    v_mfma_f32_16x16x32_bf16 v[156:159], v[84:87], v[72:75], v[156:159]
    v_mfma_f32_16x16x32_bf16 v[160:163], v[88:91], v[60:63], v[160:163]
    ds_read_b64_tr_b16 v[44:45], v32 offset:0
    ds_read_b64_tr_b16 v[46:47], v32 offset:8192
    v_mfma_f32_16x16x32_bf16 v[164:167], v[88:91], v[64:67], v[164:167]
    s_add_u32 m0, s50, 0
    s_nop 0
    buffer_load_dwordx4 v10, s[12:15], s52 offen lds
    v_mfma_f32_16x16x32_bf16 v[168:171], v[88:91], v[68:71], v[168:171]
    ds_read_b64_tr_b16 v[48:49], v33 offset:0
    ds_read_b64_tr_b16 v[50:51], v33 offset:8192
    v_mfma_f32_16x16x32_bf16 v[172:175], v[88:91], v[72:75], v[172:175]
    v_mfma_f32_16x16x32_bf16 v[176:179], v[92:95], v[60:63], v[176:179]
    ds_read_b64_tr_b16 v[52:53], v34 offset:0
    ds_read_b64_tr_b16 v[54:55], v34 offset:8192
    v_mfma_f32_16x16x32_bf16 v[180:183], v[92:95], v[64:67], v[180:183]
    s_add_u32 m0, s50, 9216
    s_nop 0
    buffer_load_dwordx4 v10, s[16:19], s52 offen lds
    v_mfma_f32_16x16x32_bf16 v[184:187], v[92:95], v[68:71], v[184:187]
    ds_read_b64_tr_b16 v[56:57], v35 offset:0
    ds_read_b64_tr_b16 v[58:59], v35 offset:8192
    v_mfma_f32_16x16x32_bf16 v[188:191], v[92:95], v[72:75], v[188:191]
    v_mfma_f32_16x16x32_bf16 v[192:195], v[96:99], v[60:63], v[192:195]
    ds_read_b64_tr_b16 v[84:85], v36 offset:64
    ds_read_b64_tr_b16 v[86:87], v36 offset:4672
    v_mfma_f32_16x16x32_bf16 v[196:199], v[96:99], v[64:67], v[196:199]
    ds_read_b64_tr_b16 v[88:89], v36 offset:96
    ds_read_b64_tr_b16 v[90:91], v36 offset:4704
    s_add_u32 m0, s48, 0
    s_nop 0
    buffer_load_dword v11, s[44:47], s52 offen lds
    s_add_u32 s52, s52, 294912
    v_mfma_f32_16x16x32_bf16 v[200:203], v[96:99], v[68:71], v[200:203]
    ds_read_b64_tr_b16 v[92:93], v36 offset:9216
    ds_read_b64_tr_b16 v[94:95], v36 offset:13824
    v_mfma_f32_16x16x32_bf16 v[204:207], v[96:99], v[72:75], v[204:207]
    v_mfma_f32_16x16x32_bf16 v[208:211], v[100:103], v[60:63], v[208:211]
    ds_read_b64_tr_b16 v[96:97], v36 offset:9248
    ds_read_b64_tr_b16 v[98:99], v36 offset:13856
    v_mfma_f32_16x16x32_bf16 v[212:215], v[100:103], v[64:67], v[212:215]
    s_add_u32 m0, s49, 34816
    s_nop 0
    buffer_load_dwordx4 v8, s[24:27], s51 offen lds
    v_mfma_f32_16x16x32_bf16 v[216:219], v[100:103], v[68:71], v[216:219]
    v_mfma_f32_16x16x32_bf16 v[220:223], v[100:103], v[72:75], v[220:223]
    v_mfma_f32_16x16x32_bf16 v[224:227], v[104:107], v[60:63], v[224:227]
    ds_read_b64_tr_b16 v[100:101], v36 offset:9280
    ds_read_b64_tr_b16 v[102:103], v36 offset:13888
    v_mfma_f32_16x16x32_bf16 v[228:231], v[104:107], v[64:67], v[228:231]
    buffer_load_dwordx4 v9, s[24:27], s51 offen offset:1024 lds
    s_add_u32 s51, s51, 0x20000
    v_mfma_f32_16x16x32_bf16 v[232:235], v[104:107], v[68:71], v[232:235]
    v_mfma_f32_16x16x32_bf16 v[236:239], v[104:107], v[72:75], v[236:239]
    v_mfma_f32_16x16x32_bf16 v[240:243], v[108:111], v[60:63], v[240:243]
    ds_read_b64_tr_b16 v[104:105], v36 offset:9312
    ds_read_b64_tr_b16 v[106:107], v36 offset:13920
    v_mfma_f32_16x16x32_bf16 v[244:247], v[108:111], v[64:67], v[244:247]
    v_mfma_f32_16x16x32_bf16 v[248:251], v[108:111], v[68:71], v[248:251]
    v_mfma_f32_16x16x32_bf16 v[252:255], v[108:111], v[72:75], v[252:255]
    ds_read_b64_tr_b16 v[108:109], v37 offset:0
    ds_read_b64_tr_b16 v[110:111], v37 offset:4608
    s_waitcnt lgkmcnt(14)
    v_mfma_f32_16x16x32_bf16 v[112:115], v[76:79], v[44:47], v[112:115]
    v_mfma_f32_16x16x32_bf16 v[116:119], v[76:79], v[48:51], v[116:119]
    v_mfma_f32_16x16x32_bf16 v[120:123], v[76:79], v[52:55], v[120:123]
    v_mfma_f32_16x16x32_bf16 v[124:127], v[76:79], v[56:59], v[124:127]
    v_mfma_f32_16x16x32_bf16 v[128:131], v[80:83], v[44:47], v[128:131]
    v_mfma_f32_16x16x32_bf16 v[132:135], v[80:83], v[48:51], v[132:135]
    v_mfma_f32_16x16x32_bf16 v[136:139], v[80:83], v[52:55], v[136:139]
    v_mfma_f32_16x16x32_bf16 v[140:143], v[80:83], v[56:59], v[140:143]
    s_waitcnt vmcnt(7) lgkmcnt(0)
    s_barrier
    v_mfma_f32_16x16x32_bf16 v[144:147], v[84:87], v[44:47], v[144:147]
    ds_read_b64_tr_b16 v[76:77], v36 offset:34816
    ds_read_b64_tr_b16 v[78:79], v36 offset:39424
    v_mfma_f32_16x16x32_bf16 v[148:151], v[84:87], v[48:51], v[148:151]
    s_add_u32 m0, s50, 34816
    s_nop 0
    buffer_load_dwordx4 v10, s[12:15], s52 offen lds
    v_mfma_f32_16x16x32_bf16 v[152:155], v[84:87], v[52:55], v[152:155]
    ds_read_b64_tr_b16 v[80:81], v36 offset:34848
    ds_read_b64_tr_b16 v[82:83], v36 offset:39456
    v_mfma_f32_16x16x32_bf16 v[156:159], v[84:87], v[56:59], v[156:159]
    v_mfma_f32_16x16x32_bf16 v[160:163], v[88:91], v[44:47], v[160:163]
    ds_read_b64_tr_b16 v[60:61], v32 offset:34816
    ds_read_b64_tr_b16 v[62:63], v32 offset:43008
    v_mfma_f32_16x16x32_bf16 v[164:167], v[88:91], v[48:51], v[164:167]
    s_add_u32 m0, s50, 44032
    s_nop 0
    buffer_load_dwordx4 v10, s[16:19], s52 offen lds
    v_mfma_f32_16x16x32_bf16 v[168:171], v[88:91], v[52:55], v[168:171]
    ds_read_b64_tr_b16 v[64:65], v33 offset:34816
    ds_read_b64_tr_b16 v[66:67], v33 offset:43008
    v_mfma_f32_16x16x32_bf16 v[172:175], v[88:91], v[56:59], v[172:175]
    v_mfma_f32_16x16x32_bf16 v[176:179], v[92:95], v[44:47], v[176:179]
    ds_read_b64_tr_b16 v[68:69], v34 offset:34816
    ds_read_b64_tr_b16 v[70:71], v34 offset:43008
    v_mfma_f32_16x16x32_bf16 v[180:183], v[92:95], v[48:51], v[180:183]
    s_add_u32 m0, s48, 34816
    s_nop 0
    buffer_load_dword v11, s[44:47], s52 offen lds
    s_add_u32 s52, s52, 294912
    v_mfma_f32_16x16x32_bf16 v[184:187], v[92:95], v[52:55], v[184:187]
    ds_read_b64_tr_b16 v[72:73], v35 offset:34816
    ds_read_b64_tr_b16 v[74:75], v35 offset:43008
    v_mfma_f32_16x16x32_bf16 v[188:191], v[92:95], v[56:59], v[188:191]
    v_mfma_f32_16x16x32_bf16 v[192:195], v[96:99], v[44:47], v[192:195]
    ds_read_b64_tr_b16 v[84:85], v36 offset:34880
    ds_read_b64_tr_b16 v[86:87], v36 offset:39488
    v_mfma_f32_16x16x32_bf16 v[196:199], v[96:99], v[48:51], v[196:199]
    ds_read_b64_tr_b16 v[88:89], v36 offset:34912
    ds_read_b64_tr_b16 v[90:91], v36 offset:39520
    s_add_u32 m0, s49, 69632
    s_nop 0
    buffer_load_dwordx4 v8, s[24:27], s51 offen lds
    v_mfma_f32_16x16x32_bf16 v[200:203], v[96:99], v[52:55], v[200:203]
    ds_read_b64_tr_b16 v[92:93], v36 offset:44032
    ds_read_b64_tr_b16 v[94:95], v36 offset:48640
    v_mfma_f32_16x16x32_bf16 v[204:207], v[96:99], v[56:59], v[204:207]
    v_mfma_f32_16x16x32_bf16 v[208:211], v[100:103], v[44:47], v[208:211]
    ds_read_b64_tr_b16 v[96:97], v36 offset:44064
    ds_read_b64_tr_b16 v[98:99], v36 offset:48672
    v_mfma_f32_16x16x32_bf16 v[212:215], v[100:103], v[48:51], v[212:215]
    buffer_load_dwordx4 v9, s[24:27], s51 offen offset:1024 lds
    s_add_u32 s51, s51, 0x20000
    v_mfma_f32_16x16x32_bf16 v[216:219], v[100:103], v[52:55], v[216:219]
    v_mfma_f32_16x16x32_bf16 v[220:223], v[100:103], v[56:59], v[220:223]
    v_mfma_f32_16x16x32_bf16 v[224:227], v[104:107], v[44:47], v[224:227]
    ds_read_b64_tr_b16 v[100:101], v36 offset:44096
    ds_read_b64_tr_b16 v[102:103], v36 offset:48704
    v_mfma_f32_16x16x32_bf16 v[228:231], v[104:107], v[48:51], v[228:231]
    s_add_u32 m0, s50, 69632
    s_nop 0
    buffer_load_dwordx4 v10, s[12:15], s52 offen lds
    v_mfma_f32_16x16x32_bf16 v[232:235], v[104:107], v[52:55], v[232:235]
    v_mfma_f32_16x16x32_bf16 v[236:239], v[104:107], v[56:59], v[236:239]
    v_mfma_f32_16x16x32_bf16 v[240:243], v[108:111], v[44:47], v[240:243]
    ds_read_b64_tr_b16 v[104:105], v36 offset:44128
    ds_read_b64_tr_b16 v[106:107], v36 offset:48736
    v_mfma_f32_16x16x32_bf16 v[244:247], v[108:111], v[48:51], v[244:247]
    v_mfma_f32_16x16x32_bf16 v[248:251], v[108:111], v[52:55], v[248:251]
    v_mfma_f32_16x16x32_bf16 v[252:255], v[108:111], v[56:59], v[252:255]
    ds_read_b64_tr_b16 v[108:109], v37 offset:34816
    ds_read_b64_tr_b16 v[110:111], v37 offset:39424
    s_waitcnt lgkmcnt(14)
    v_mfma_f32_16x16x32_bf16 v[112:115], v[76:79], v[60:63], v[112:115]
    v_mfma_f32_16x16x32_bf16 v[116:119], v[76:79], v[64:67], v[116:119]
    v_mfma_f32_16x16x32_bf16 v[120:123], v[76:79], v[68:71], v[120:123]
    v_mfma_f32_16x16x32_bf16 v[124:127], v[76:79], v[72:75], v[124:127]
    v_mfma_f32_16x16x32_bf16 v[128:131], v[80:83], v[60:63], v[128:131]
    v_mfma_f32_16x16x32_bf16 v[132:135], v[80:83], v[64:67], v[132:135]
    v_mfma_f32_16x16x32_bf16 v[136:139], v[80:83], v[68:71], v[136:139]
    v_mfma_f32_16x16x32_bf16 v[140:143], v[80:83], v[72:75], v[140:143]
    s_waitcnt vmcnt(8) lgkmcnt(0)
    s_barrier
    v_mfma_f32_16x16x32_bf16 v[144:147], v[84:87], v[60:63], v[144:147]
    ds_read_b64_tr_b16 v[76:77], v6 offset:0
    ds_read_b64_tr_b16 v[78:79], v6 offset:4608
    v_mfma_f32_16x16x32_bf16 v[148:151], v[84:87], v[64:67], v[148:151]
    s_add_u32 m0, s50, 78848
    s_nop 0
    buffer_load_dwordx4 v10, s[16:19], s52 offen lds
    v_mfma_f32_16x16x32_bf16 v[152:155], v[84:87], v[68:71], v[152:155]
    ds_read_b64_tr_b16 v[80:81], v6 offset:32
    ds_read_b64_tr_b16 v[82:83], v6 offset:4640
    v_mfma_f32_16x16x32_bf16 v[156:159], v[84:87], v[72:75], v[156:159]
    v_mfma_f32_16x16x32_bf16 v[160:163], v[88:91], v[60:63], v[160:163]
    ds_read_b64_tr_b16 v[44:45], v2 offset:0
    ds_read_b64_tr_b16 v[46:47], v2 offset:8192
    v_mfma_f32_16x16x32_bf16 v[164:167], v[88:91], v[64:67], v[164:167]
    s_add_u32 m0, s48, 69632
    s_nop 0
    buffer_load_dword v11, s[44:47], s52 offen lds
    s_add_u32 s52, s52, 294912
    v_mfma_f32_16x16x32_bf16 v[168:171], v[88:91], v[68:71], v[168:171]
    ds_read_b64_tr_b16 v[48:49], v3 offset:0
    ds_read_b64_tr_b16 v[50:51], v3 offset:8192
    v_mfma_f32_16x16x32_bf16 v[172:175], v[88:91], v[72:75], v[172:175]
    v_mfma_f32_16x16x32_bf16 v[176:179], v[92:95], v[60:63], v[176:179]
    ds_read_b64_tr_b16 v[52:53], v4 offset:0
    ds_read_b64_tr_b16 v[54:55], v4 offset:8192
    v_mfma_f32_16x16x32_bf16 v[180:183], v[92:95], v[64:67], v[180:183]
    s_add_u32 m0, s49, 104448
    s_nop 0
    buffer_load_dwordx4 v8, s[24:27], s51 offen lds
    v_mfma_f32_16x16x32_bf16 v[184:187], v[92:95], v[68:71], v[184:187]
    ds_read_b64_tr_b16 v[56:57], v5 offset:0
    ds_read_b64_tr_b16 v[58:59], v5 offset:8192
    v_mfma_f32_16x16x32_bf16 v[188:191], v[92:95], v[72:75], v[188:191]
    v_mfma_f32_16x16x32_bf16 v[192:195], v[96:99], v[60:63], v[192:195]
    ds_read_b64_tr_b16 v[84:85], v6 offset:64
    ds_read_b64_tr_b16 v[86:87], v6 offset:4672
    v_mfma_f32_16x16x32_bf16 v[196:199], v[96:99], v[64:67], v[196:199]
    ds_read_b64_tr_b16 v[88:89], v6 offset:96
    ds_read_b64_tr_b16 v[90:91], v6 offset:4704
    buffer_load_dwordx4 v9, s[24:27], s51 offen offset:1024 lds
    s_add_u32 s51, s51, 0x20000
    v_mfma_f32_16x16x32_bf16 v[200:203], v[96:99], v[68:71], v[200:203]
    ds_read_b64_tr_b16 v[92:93], v6 offset:9216
    ds_read_b64_tr_b16 v[94:95], v6 offset:13824
    v_mfma_f32_16x16x32_bf16 v[204:207], v[96:99], v[72:75], v[204:207]
    v_mfma_f32_16x16x32_bf16 v[208:211], v[100:103], v[60:63], v[208:211]
    ds_read_b64_tr_b16 v[96:97], v6 offset:9248
    ds_read_b64_tr_b16 v[98:99], v6 offset:13856
    v_mfma_f32_16x16x32_bf16 v[212:215], v[100:103], v[64:67], v[212:215]
    s_add_u32 m0, s50, 104448
    s_nop 0
    buffer_load_dwordx4 v10, s[12:15], s52 offen lds
    v_mfma_f32_16x16x32_bf16 v[216:219], v[100:103], v[68:71], v[216:219]
    v_mfma_f32_16x16x32_bf16 v[220:223], v[100:103], v[72:75], v[220:223]
    v_mfma_f32_16x16x32_bf16 v[224:227], v[104:107], v[60:63], v[224:227]
    ds_read_b64_tr_b16 v[100:101], v6 offset:9280
    ds_read_b64_tr_b16 v[102:103], v6 offset:13888
    v_mfma_f32_16x16x32_bf16 v[228:231], v[104:107], v[64:67], v[228:231]
    s_add_u32 m0, s50, 113664
    s_nop 0
    buffer_load_dwordx4 v10, s[16:19], s52 offen lds
    v_mfma_f32_16x16x32_bf16 v[232:235], v[104:107], v[68:71], v[232:235]
    v_mfma_f32_16x16x32_bf16 v[236:239], v[104:107], v[72:75], v[236:239]
    v_mfma_f32_16x16x32_bf16 v[240:243], v[108:111], v[60:63], v[240:243]
    ds_read_b64_tr_b16 v[104:105], v6 offset:9312
    ds_read_b64_tr_b16 v[106:107], v6 offset:13920
    v_mfma_f32_16x16x32_bf16 v[244:247], v[108:111], v[64:67], v[244:247]
    v_mfma_f32_16x16x32_bf16 v[248:251], v[108:111], v[68:71], v[248:251]
    v_mfma_f32_16x16x32_bf16 v[252:255], v[108:111], v[72:75], v[252:255]
    ds_read_b64_tr_b16 v[108:109], v7 offset:0
    ds_read_b64_tr_b16 v[110:111], v7 offset:4608
    s_waitcnt lgkmcnt(14)
    v_mfma_f32_16x16x32_bf16 v[112:115], v[76:79], v[44:47], v[112:115]
    v_mfma_f32_16x16x32_bf16 v[116:119], v[76:79], v[48:51], v[116:119]
    v_mfma_f32_16x16x32_bf16 v[120:123], v[76:79], v[52:55], v[120:123]
    v_mfma_f32_16x16x32_bf16 v[124:127], v[76:79], v[56:59], v[124:127]
    v_mfma_f32_16x16x32_bf16 v[128:131], v[80:83], v[44:47], v[128:131]
    v_mfma_f32_16x16x32_bf16 v[132:135], v[80:83], v[48:51], v[132:135]
    v_mfma_f32_16x16x32_bf16 v[136:139], v[80:83], v[52:55], v[136:139]
    v_mfma_f32_16x16x32_bf16 v[140:143], v[80:83], v[56:59], v[140:143]
    s_waitcnt vmcnt(9) lgkmcnt(0)
    s_barrier
    v_mfma_f32_16x16x32_bf16 v[144:147], v[84:87], v[44:47], v[144:147]
    ds_read_b64_tr_b16 v[76:77], v6 offset:34816
    ds_read_b64_tr_b16 v[78:79], v6 offset:39424
    v_mov_b32 v26, -1
    v_mfma_f32_16x16x32_bf16 v[148:151], v[84:87], v[48:51], v[148:151]
    s_add_u32 m0, s48, 104448
    s_nop 0
    buffer_load_dword v11, s[44:47], s52 offen lds
    s_add_u32 s52, s52, 294912
    v_mov_b32 v27, -1
    v_mfma_f32_16x16x32_bf16 v[152:155], v[84:87], v[52:55], v[152:155]
    ds_read_b64_tr_b16 v[80:81], v6 offset:34848
    ds_read_b64_tr_b16 v[82:83], v6 offset:39456
    v_mov_b32 v28, -1
    v_mfma_f32_16x16x32_bf16 v[156:159], v[84:87], v[56:59], v[156:159]
    v_mov_b32 v29, -1
    v_mfma_f32_16x16x32_bf16 v[160:163], v[88:91], v[44:47], v[160:163]
    ds_read_b64_tr_b16 v[60:61], v2 offset:34816
    ds_read_b64_tr_b16 v[62:63], v2 offset:43008
    v_lshlrev_b32 v30, 4, v0
    v_mfma_f32_16x16x32_bf16 v[164:167], v[88:91], v[48:51], v[164:167]
    s_add_u32 m0, s49, 0
    s_nop 0
    buffer_load_dwordx4 v8, s[24:27], s51 offen lds
    s_lshl_b32 s23, s5, 5
    v_mfma_f32_16x16x32_bf16 v[168:171], v[88:91], v[52:55], v[168:171]
    ds_read_b64_tr_b16 v[64:65], v3 offset:34816
    ds_read_b64_tr_b16 v[66:67], v3 offset:43008
    s_add_u32 s23, s23, s6
    v_mfma_f32_16x16x32_bf16 v[172:175], v[88:91], v[56:59], v[172:175]
    s_mul_i32 s23, s23, 27648
    v_mfma_f32_16x16x32_bf16 v[176:179], v[92:95], v[44:47], v[176:179]
    ds_read_b64_tr_b16 v[68:69], v4 offset:34816
    ds_read_b64_tr_b16 v[70:71], v4 offset:43008
    buffer_store_dwordx4 v[26:29], v30, s[72:75], s23 offen sc0 sc1
    v_mfma_f32_16x16x32_bf16 v[180:183], v[92:95], v[48:51], v[180:183]
    buffer_load_dwordx4 v9, s[24:27], s51 offen offset:1024 lds
    s_add_u32 s51, s51, 0x20000
    s_add_u32 s23, s23, 8192
    v_mfma_f32_16x16x32_bf16 v[184:187], v[92:95], v[52:55], v[184:187]
    ds_read_b64_tr_b16 v[72:73], v5 offset:34816
    ds_read_b64_tr_b16 v[74:75], v5 offset:43008
    buffer_store_dwordx4 v[26:29], v30, s[72:75], s23 offen sc0 sc1
    v_mfma_f32_16x16x32_bf16 v[188:191], v[92:95], v[56:59], v[188:191]
    s_add_u32 s23, s23, 8192
    v_mfma_f32_16x16x32_bf16 v[192:195], v[96:99], v[44:47], v[192:195]
    ds_read_b64_tr_b16 v[84:85], v6 offset:34880
    ds_read_b64_tr_b16 v[86:87], v6 offset:39488
    buffer_store_dwordx4 v[26:29], v30, s[72:75], s23 offen sc0 sc1
    v_mfma_f32_16x16x32_bf16 v[196:199], v[96:99], v[48:51], v[196:199]
    ds_read_b64_tr_b16 v[88:89], v6 offset:34912
    ds_read_b64_tr_b16 v[90:91], v6 offset:39520
    s_add_u32 m0, s50, 0
    s_nop 0
    buffer_load_dwordx4 v10, s[12:15], s52 offen lds
    s_add_u32 s23, s23, 8192
    v_mfma_f32_16x16x32_bf16 v[200:203], v[96:99], v[52:55], v[200:203]
    ds_read_b64_tr_b16 v[92:93], v6 offset:44032
    ds_read_b64_tr_b16 v[94:95], v6 offset:48640
    v_mul_u32_u24 v31, 8, v1
    v_mfma_f32_16x16x32_bf16 v[204:207], v[96:99], v[56:59], v[204:207]
    s_mul_i32 s22, s7, 384
    v_mfma_f32_16x16x32_bf16 v[208:211], v[100:103], v[44:47], v[208:211]
    ds_read_b64_tr_b16 v[96:97], v6 offset:44064
    ds_read_b64_tr_b16 v[98:99], v6 offset:48672
    s_add_u32 s23, s23, s22
    v_mfma_f32_16x16x32_bf16 v[212:215], v[100:103], v[48:51], v[212:215]
    s_add_u32 m0, s50, 9216
    s_nop 0
    buffer_load_dwordx4 v10, s[16:19], s52 offen lds
    s_mov_b32 s22, s23
    s_mov_b32 exec_hi, 0xffff
    buffer_store_dwordx2 v[26:27], v31, s[72:75], s22 offen sc0 sc1
    s_mov_b64 exec, -1
    v_mfma_f32_16x16x32_bf16 v[216:219], v[100:103], v[52:55], v[216:219]
    v_mfma_f32_16x16x32_bf16 v[220:223], v[100:103], v[56:59], v[220:223]
    v_mfma_f32_16x16x32_bf16 v[224:227], v[104:107], v[44:47], v[224:227]
    ds_read_b64_tr_b16 v[100:101], v6 offset:44096
    ds_read_b64_tr_b16 v[102:103], v6 offset:48704
    v_mfma_f32_16x16x32_bf16 v[228:231], v[104:107], v[48:51], v[228:231]
    s_add_u32 m0, s48, 0
    s_nop 0
    buffer_load_dword v11, s[44:47], s52 offen lds
    s_add_u32 s52, s52, 294912
    v_mfma_f32_16x16x32_bf16 v[232:235], v[104:107], v[52:55], v[232:235]
    v_mfma_f32_16x16x32_bf16 v[236:239], v[104:107], v[56:59], v[236:239]
    v_mfma_f32_16x16x32_bf16 v[240:243], v[108:111], v[44:47], v[240:243]
    ds_read_b64_tr_b16 v[104:105], v6 offset:44128
    ds_read_b64_tr_b16 v[106:107], v6 offset:48736
    v_mfma_f32_16x16x32_bf16 v[244:247], v[108:111], v[48:51], v[244:247]
    v_mfma_f32_16x16x32_bf16 v[248:251], v[108:111], v[52:55], v[248:251]
    v_mfma_f32_16x16x32_bf16 v[252:255], v[108:111], v[56:59], v[252:255]
    ds_read_b64_tr_b16 v[108:109], v7 offset:34816
    ds_read_b64_tr_b16 v[110:111], v7 offset:39424
    s_waitcnt lgkmcnt(14)
    v_mfma_f32_16x16x32_bf16 v[112:115], v[76:79], v[60:63], v[112:115]
    v_mfma_f32_16x16x32_bf16 v[116:119], v[76:79], v[64:67], v[116:119]
    v_mfma_f32_16x16x32_bf16 v[120:123], v[76:79], v[68:71], v[120:123]
    v_mfma_f32_16x16x32_bf16 v[124:127], v[76:79], v[72:75], v[124:127]
    v_mfma_f32_16x16x32_bf16 v[128:131], v[80:83], v[60:63], v[128:131]
    v_mfma_f32_16x16x32_bf16 v[132:135], v[80:83], v[64:67], v[132:135]
    v_mfma_f32_16x16x32_bf16 v[136:139], v[80:83], v[68:71], v[136:139]
    v_mfma_f32_16x16x32_bf16 v[140:143], v[80:83], v[72:75], v[140:143]
    s_waitcnt vmcnt(14) lgkmcnt(0)
    s_barrier
    v_mfma_f32_16x16x32_bf16 v[144:147], v[84:87], v[60:63], v[144:147]
    ds_read_b64_tr_b16 v[76:77], v36 offset:0
    ds_read_b64_tr_b16 v[78:79], v36 offset:4608
    v_mfma_f32_16x16x32_bf16 v[148:151], v[84:87], v[64:67], v[148:151]
    s_add_u32 m0, s49, 34816
    s_nop 0
    buffer_load_dwordx4 v8, s[24:27], s51 offen lds
    v_mfma_f32_16x16x32_bf16 v[152:155], v[84:87], v[68:71], v[152:155]
    ds_read_b64_tr_b16 v[80:81], v36 offset:32
    ds_read_b64_tr_b16 v[82:83], v36 offset:4640
    v_mfma_f32_16x16x32_bf16 v[156:159], v[84:87], v[72:75], v[156:159]
    v_mfma_f32_16x16x32_bf16 v[160:163], v[88:91], v[60:63], v[160:163]
    ds_read_b64_tr_b16 v[44:45], v32 offset:0
    ds_read_b64_tr_b16 v[46:47], v32 offset:8192
    v_mfma_f32_16x16x32_bf16 v[164:167], v[88:91], v[64:67], v[164:167]
    buffer_load_dwordx4 v9, s[24:27], s51 offen offset:1024 lds
    s_add_u32 s51, s51, 0x20000
    v_mfma_f32_16x16x32_bf16 v[168:171], v[88:91], v[68:71], v[168:171]
    ds_read_b64_tr_b16 v[48:49], v33 offset:0
    ds_read_b64_tr_b16 v[50:51], v33 offset:8192
    v_mfma_f32_16x16x32_bf16 v[172:175], v[88:91], v[72:75], v[172:175]
    v_mfma_f32_16x16x32_bf16 v[176:179], v[92:95], v[60:63], v[176:179]
    ds_read_b64_tr_b16 v[52:53], v34 offset:0
    ds_read_b64_tr_b16 v[54:55], v34 offset:8192
    v_mfma_f32_16x16x32_bf16 v[180:183], v[92:95], v[64:67], v[180:183]
    s_add_u32 m0, s50, 34816
    s_nop 0
    buffer_load_dwordx4 v10, s[12:15], s52 offen lds
    v_mfma_f32_16x16x32_bf16 v[184:187], v[92:95], v[68:71], v[184:187]
    ds_read_b64_tr_b16 v[56:57], v35 offset:0
    ds_read_b64_tr_b16 v[58:59], v35 offset:8192
    v_mfma_f32_16x16x32_bf16 v[188:191], v[92:95], v[72:75], v[188:191]
    v_mfma_f32_16x16x32_bf16 v[192:195], v[96:99], v[60:63], v[192:195]
    ds_read_b64_tr_b16 v[84:85], v36 offset:64
    ds_read_b64_tr_b16 v[86:87], v36 offset:4672
    v_mfma_f32_16x16x32_bf16 v[196:199], v[96:99], v[64:67], v[196:199]
    ds_read_b64_tr_b16 v[88:89], v36 offset:96
    ds_read_b64_tr_b16 v[90:91], v36 offset:4704
    s_add_u32 m0, s50, 44032
    s_nop 0
    buffer_load_dwordx4 v10, s[16:19], s52 offen lds
    v_mfma_f32_16x16x32_bf16 v[200:203], v[96:99], v[68:71], v[200:203]
    ds_read_b64_tr_b16 v[92:93], v36 offset:9216
    ds_read_b64_tr_b16 v[94:95], v36 offset:13824
    v_mfma_f32_16x16x32_bf16 v[204:207], v[96:99], v[72:75], v[204:207]
    v_mfma_f32_16x16x32_bf16 v[208:211], v[100:103], v[60:63], v[208:211]
    ds_read_b64_tr_b16 v[96:97], v36 offset:9248
    ds_read_b64_tr_b16 v[98:99], v36 offset:13856
    v_mfma_f32_16x16x32_bf16 v[212:215], v[100:103], v[64:67], v[212:215]
    s_add_u32 m0, s48, 34816
    s_nop 0
    buffer_load_dword v11, s[44:47], s52 offen lds
    s_add_u32 s52, s52, 294912
    v_mfma_f32_16x16x32_bf16 v[216:219], v[100:103], v[68:71], v[216:219]
    v_mfma_f32_16x16x32_bf16 v[220:223], v[100:103], v[72:75], v[220:223]
    v_mfma_f32_16x16x32_bf16 v[224:227], v[104:107], v[60:63], v[224:227]
    ds_read_b64_tr_b16 v[100:101], v36 offset:9280
    ds_read_b64_tr_b16 v[102:103], v36 offset:13888
    v_mfma_f32_16x16x32_bf16 v[228:231], v[104:107], v[64:67], v[228:231]
    v_mfma_f32_16x16x32_bf16 v[232:235], v[104:107], v[68:71], v[232:235]
    v_mfma_f32_16x16x32_bf16 v[236:239], v[104:107], v[72:75], v[236:239]
    v_mfma_f32_16x16x32_bf16 v[240:243], v[108:111], v[60:63], v[240:243]
    ds_read_b64_tr_b16 v[104:105], v36 offset:9312
    ds_read_b64_tr_b16 v[106:107], v36 offset:13920
    v_mfma_f32_16x16x32_bf16 v[244:247], v[108:111], v[64:67], v[244:247]
    v_mfma_f32_16x16x32_bf16 v[248:251], v[108:111], v[68:71], v[248:251]
    v_mfma_f32_16x16x32_bf16 v[252:255], v[108:111], v[72:75], v[252:255]
    ds_read_b64_tr_b16 v[108:109], v37 offset:0
    ds_read_b64_tr_b16 v[110:111], v37 offset:4608
    s_waitcnt lgkmcnt(14)
    v_mfma_f32_16x16x32_bf16 v[112:115], v[76:79], v[44:47], v[112:115]
    v_mfma_f32_16x16x32_bf16 v[116:119], v[76:79], v[48:51], v[116:119]
    v_mfma_f32_16x16x32_bf16 v[120:123], v[76:79], v[52:55], v[120:123]
    v_mfma_f32_16x16x32_bf16 v[124:127], v[76:79], v[56:59], v[124:127]
    v_mfma_f32_16x16x32_bf16 v[128:131], v[80:83], v[44:47], v[128:131]
    v_mfma_f32_16x16x32_bf16 v[132:135], v[80:83], v[48:51], v[132:135]
    v_mfma_f32_16x16x32_bf16 v[136:139], v[80:83], v[52:55], v[136:139]
    v_mfma_f32_16x16x32_bf16 v[140:143], v[80:83], v[56:59], v[140:143]
    s_waitcnt vmcnt(14) lgkmcnt(0)
    s_barrier
    v_mfma_f32_16x16x32_bf16 v[144:147], v[84:87], v[44:47], v[144:147]
    ds_read_b64_tr_b16 v[76:77], v36 offset:34816
    ds_read_b64_tr_b16 v[78:79], v36 offset:39424
    s_mov_b32 s23, 0
    v_mfma_f32_16x16x32_bf16 v[148:151], v[84:87], v[48:51], v[148:151]
    s_add_u32 m0, s49, 69632
    s_nop 0
    buffer_load_dwordx4 v8, s[24:27], s51 offen lds
    buffer_load_dword v20, v14, s[28:31], s23 offen
    v_mfma_f32_16x16x32_bf16 v[152:155], v[84:87], v[52:55], v[152:155]
    ds_read_b64_tr_b16 v[80:81], v36 offset:34848
    ds_read_b64_tr_b16 v[82:83], v36 offset:39456
    s_add_u32 s23, s23, 0x80000
    v_mfma_f32_16x16x32_bf16 v[156:159], v[84:87], v[56:59], v[156:159]
    buffer_load_dword v21, v14, s[28:31], s23 offen
    v_mfma_f32_16x16x32_bf16 v[160:163], v[88:91], v[44:47], v[160:163]
    ds_read_b64_tr_b16 v[60:61], v32 offset:34816
    ds_read_b64_tr_b16 v[62:63], v32 offset:43008
    s_add_u32 s23, s23, 0x80000
    v_mfma_f32_16x16x32_bf16 v[164:167], v[88:91], v[48:51], v[164:167]
    buffer_load_dwordx4 v9, s[24:27], s51 offen offset:1024 lds
    s_add_u32 s51, s51, 0x20000
    buffer_load_dword v22, v14, s[28:31], s23 offen
    v_mfma_f32_16x16x32_bf16 v[168:171], v[88:91], v[52:55], v[168:171]
    ds_read_b64_tr_b16 v[64:65], v33 offset:34816
    ds_read_b64_tr_b16 v[66:67], v33 offset:43008
    s_add_u32 s23, s23, 0x80000
    v_mfma_f32_16x16x32_bf16 v[172:175], v[88:91], v[56:59], v[172:175]
    buffer_load_dword v23, v14, s[28:31], s23 offen
    v_mfma_f32_16x16x32_bf16 v[176:179], v[92:95], v[44:47], v[176:179]
    ds_read_b64_tr_b16 v[68:69], v34 offset:34816
    ds_read_b64_tr_b16 v[70:71], v34 offset:43008
    s_add_u32 s23, s23, 0x80000
    v_mfma_f32_16x16x32_bf16 v[180:183], v[92:95], v[48:51], v[180:183]
    s_add_u32 m0, s50, 69632
    s_nop 0
    buffer_load_dwordx4 v10, s[12:15], s52 offen lds
    buffer_load_dword v24, v14, s[28:31], s23 offen
    v_mfma_f32_16x16x32_bf16 v[184:187], v[92:95], v[52:55], v[184:187]
    ds_read_b64_tr_b16 v[72:73], v35 offset:34816
    ds_read_b64_tr_b16 v[74:75], v35 offset:43008
    v_mfma_f32_16x16x32_bf16 v[188:191], v[92:95], v[56:59], v[188:191]
    v_mfma_f32_16x16x32_bf16 v[192:195], v[96:99], v[44:47], v[192:195]
    ds_read_b64_tr_b16 v[84:85], v36 offset:34880
    ds_read_b64_tr_b16 v[86:87], v36 offset:39488
    v_mfma_f32_16x16x32_bf16 v[196:199], v[96:99], v[48:51], v[196:199]
    ds_read_b64_tr_b16 v[88:89], v36 offset:34912
    ds_read_b64_tr_b16 v[90:91], v36 offset:39520
    s_add_u32 m0, s50, 78848
    s_nop 0
    buffer_load_dwordx4 v10, s[16:19], s52 offen lds
    v_mfma_f32_16x16x32_bf16 v[200:203], v[96:99], v[52:55], v[200:203]
    ds_read_b64_tr_b16 v[92:93], v36 offset:44032
    ds_read_b64_tr_b16 v[94:95], v36 offset:48640
    v_mfma_f32_16x16x32_bf16 v[204:207], v[96:99], v[56:59], v[204:207]
    v_mfma_f32_16x16x32_bf16 v[208:211], v[100:103], v[44:47], v[208:211]
    ds_read_b64_tr_b16 v[96:97], v36 offset:44064
    ds_read_b64_tr_b16 v[98:99], v36 offset:48672
    v_mfma_f32_16x16x32_bf16 v[212:215], v[100:103], v[48:51], v[212:215]
    s_add_u32 m0, s48, 69632
    s_nop 0
    buffer_load_dword v11, s[44:47], s52 offen lds
    s_add_u32 s52, s52, 294912
    v_mfma_f32_16x16x32_bf16 v[216:219], v[100:103], v[52:55], v[216:219]
    v_mfma_f32_16x16x32_bf16 v[220:223], v[100:103], v[56:59], v[220:223]
    v_mfma_f32_16x16x32_bf16 v[224:227], v[104:107], v[44:47], v[224:227]
    ds_read_b64_tr_b16 v[100:101], v36 offset:44096
    ds_read_b64_tr_b16 v[102:103], v36 offset:48704
    v_mfma_f32_16x16x32_bf16 v[228:231], v[104:107], v[48:51], v[228:231]
    v_mfma_f32_16x16x32_bf16 v[232:235], v[104:107], v[52:55], v[232:235]
    v_mfma_f32_16x16x32_bf16 v[236:239], v[104:107], v[56:59], v[236:239]
    v_mfma_f32_16x16x32_bf16 v[240:243], v[108:111], v[44:47], v[240:243]
    ds_read_b64_tr_b16 v[104:105], v36 offset:44128
    ds_read_b64_tr_b16 v[106:107], v36 offset:48736
    v_mfma_f32_16x16x32_bf16 v[244:247], v[108:111], v[48:51], v[244:247]
    v_mfma_f32_16x16x32_bf16 v[248:251], v[108:111], v[52:55], v[248:251]
    v_mfma_f32_16x16x32_bf16 v[252:255], v[108:111], v[56:59], v[252:255]
    ds_read_b64_tr_b16 v[108:109], v37 offset:34816
    ds_read_b64_tr_b16 v[110:111], v37 offset:39424
    s_waitcnt lgkmcnt(14)
    v_mfma_f32_16x16x32_bf16 v[112:115], v[76:79], v[60:63], v[112:115]
    v_mfma_f32_16x16x32_bf16 v[116:119], v[76:79], v[64:67], v[116:119]
    v_mfma_f32_16x16x32_bf16 v[120:123], v[76:79], v[68:71], v[120:123]
    v_mfma_f32_16x16x32_bf16 v[124:127], v[76:79], v[72:75], v[124:127]
    v_mfma_f32_16x16x32_bf16 v[128:131], v[80:83], v[60:63], v[128:131]
    v_mfma_f32_16x16x32_bf16 v[132:135], v[80:83], v[64:67], v[132:135]
    v_mfma_f32_16x16x32_bf16 v[136:139], v[80:83], v[68:71], v[136:139]
    v_mfma_f32_16x16x32_bf16 v[140:143], v[80:83], v[72:75], v[140:143]
    s_waitcnt vmcnt(15) lgkmcnt(0)
    s_barrier
    v_mfma_f32_16x16x32_bf16 v[144:147], v[84:87], v[60:63], v[144:147]
    ds_read_b64_tr_b16 v[76:77], v6 offset:0
    ds_read_b64_tr_b16 v[78:79], v6 offset:4608
    s_waitcnt vmcnt(2)
    v_mov_b32 v26, 0
    v_mfma_f32_16x16x32_bf16 v[148:151], v[84:87], v[64:67], v[148:151]
    s_add_u32 m0, s49, 104448
    s_nop 0
    buffer_load_dwordx4 v8, s[24:27], s51 offen lds
    v_mov_b32 v27, 0
    v_mov_b32 v28, 0
    v_mfma_f32_16x16x32_bf16 v[152:155], v[84:87], v[68:71], v[152:155]
    ds_read_b64_tr_b16 v[80:81], v6 offset:32
    ds_read_b64_tr_b16 v[82:83], v6 offset:4640
    v_mov_b32 v29, 0
    v_lshlrev_b32 v30, 16, v20
    v_mfma_f32_16x16x32_bf16 v[156:159], v[84:87], v[72:75], v[156:159]
    v_and_b32 v31, 0xffff0000, v20
    v_add_f32 v26, v26, v30
    v_mfma_f32_16x16x32_bf16 v[160:163], v[88:91], v[60:63], v[160:163]
    ds_read_b64_tr_b16 v[44:45], v2 offset:0
    ds_read_b64_tr_b16 v[46:47], v2 offset:8192
    v_add_f32 v27, v27, v31
    v_fmac_f32 v28, v30, v30
    v_mfma_f32_16x16x32_bf16 v[164:167], v[88:91], v[64:67], v[164:167]
    buffer_load_dwordx4 v9, s[24:27], s51 offen offset:1024 lds
    s_add_u32 s51, s51, 0x20000
    v_fmac_f32 v29, v31, v31
    v_lshlrev_b32 v30, 16, v21
    v_mfma_f32_16x16x32_bf16 v[168:171], v[88:91], v[68:71], v[168:171]
    ds_read_b64_tr_b16 v[48:49], v3 offset:0
    ds_read_b64_tr_b16 v[50:51], v3 offset:8192
    v_and_b32 v31, 0xffff0000, v21
    v_add_f32 v26, v26, v30
    v_mfma_f32_16x16x32_bf16 v[172:175], v[88:91], v[72:75], v[172:175]
    v_add_f32 v27, v27, v31
    v_fmac_f32 v28, v30, v30
    v_mfma_f32_16x16x32_bf16 v[176:179], v[92:95], v[60:63], v[176:179]
    ds_read_b64_tr_b16 v[52:53], v4 offset:0
    ds_read_b64_tr_b16 v[54:55], v4 offset:8192
    v_fmac_f32 v29, v31, v31
    v_lshlrev_b32 v30, 16, v22
    v_mfma_f32_16x16x32_bf16 v[180:183], v[92:95], v[64:67], v[180:183]
    s_add_u32 m0, s50, 104448
    s_nop 0
    buffer_load_dwordx4 v10, s[12:15], s52 offen lds
    v_and_b32 v31, 0xffff0000, v22
    v_add_f32 v26, v26, v30
    v_mfma_f32_16x16x32_bf16 v[184:187], v[92:95], v[68:71], v[184:187]
    ds_read_b64_tr_b16 v[56:57], v5 offset:0
    ds_read_b64_tr_b16 v[58:59], v5 offset:8192
    v_add_f32 v27, v27, v31
    v_fmac_f32 v28, v30, v30
    v_mfma_f32_16x16x32_bf16 v[188:191], v[92:95], v[72:75], v[188:191]
    v_fmac_f32 v29, v31, v31
    v_lshlrev_b32 v30, 16, v23
    v_mfma_f32_16x16x32_bf16 v[192:195], v[96:99], v[60:63], v[192:195]
    ds_read_b64_tr_b16 v[84:85], v6 offset:64
    ds_read_b64_tr_b16 v[86:87], v6 offset:4672
    v_and_b32 v31, 0xffff0000, v23
    v_add_f32 v26, v26, v30
    v_mfma_f32_16x16x32_bf16 v[196:199], v[96:99], v[64:67], v[196:199]
    ds_read_b64_tr_b16 v[88:89], v6 offset:96
    ds_read_b64_tr_b16 v[90:91], v6 offset:4704
    s_add_u32 m0, s50, 113664
    s_nop 0
    buffer_load_dwordx4 v10, s[16:19], s52 offen lds
    v_add_f32 v27, v27, v31
    v_fmac_f32 v28, v30, v30
    v_mfma_f32_16x16x32_bf16 v[200:203], v[96:99], v[68:71], v[200:203]
    ds_read_b64_tr_b16 v[92:93], v6 offset:9216
    ds_read_b64_tr_b16 v[94:95], v6 offset:13824
    v_fmac_f32 v29, v31, v31
    v_lshlrev_b32 v30, 16, v24
    v_mfma_f32_16x16x32_bf16 v[204:207], v[96:99], v[72:75], v[204:207]
    v_and_b32 v31, 0xffff0000, v24
    v_add_f32 v26, v26, v30
    v_mfma_f32_16x16x32_bf16 v[208:211], v[100:103], v[60:63], v[208:211]
    ds_read_b64_tr_b16 v[96:97], v6 offset:9248
    ds_read_b64_tr_b16 v[98:99], v6 offset:13856
    v_add_f32 v27, v27, v31
    v_fmac_f32 v28, v30, v30
    v_mfma_f32_16x16x32_bf16 v[212:215], v[100:103], v[64:67], v[212:215]
    s_add_u32 m0, s48, 104448
    s_nop 0
    buffer_load_dword v11, s[44:47], s52 offen lds
    s_add_u32 s52, s52, 294912
    v_fmac_f32 v29, v31, v31
    v_add_f32_dpp v26, v26, v26 row_shr:4 row_mask:0xf bank_mask:0xf
    v_mfma_f32_16x16x32_bf16 v[216:219], v[100:103], v[68:71], v[216:219]
    v_add_f32_dpp v27, v27, v27 row_shr:4 row_mask:0xf bank_mask:0xf
    v_add_f32_dpp v28, v28, v28 row_shr:4 row_mask:0xf bank_mask:0xf
    v_mfma_f32_16x16x32_bf16 v[220:223], v[100:103], v[72:75], v[220:223]
    v_add_f32_dpp v29, v29, v29 row_shr:4 row_mask:0xf bank_mask:0xf
    v_add_f32_dpp v26, v26, v26 row_shr:8 row_mask:0xf bank_mask:0xf
    v_mfma_f32_16x16x32_bf16 v[224:227], v[104:107], v[60:63], v[224:227]
    ds_read_b64_tr_b16 v[100:101], v6 offset:9280
    ds_read_b64_tr_b16 v[102:103], v6 offset:13888
    v_add_f32_dpp v27, v27, v27 row_shr:8 row_mask:0xf bank_mask:0xf
    v_add_f32_dpp v28, v28, v28 row_shr:8 row_mask:0xf bank_mask:0xf
    v_mfma_f32_16x16x32_bf16 v[228:231], v[104:107], v[64:67], v[228:231]
    v_add_f32_dpp v29, v29, v29 row_shr:8 row_mask:0xf bank_mask:0xf
    v_lshrrev_b32 v30, 4, v0
    v_mfma_f32_16x16x32_bf16 v[232:235], v[104:107], v[68:71], v[232:235]
    v_lshlrev_b32 v30, 6, v30
    v_and_b32 v31, 3, v0
    v_mfma_f32_16x16x32_bf16 v[236:239], v[104:107], v[72:75], v[236:239]
    v_lshlrev_b32 v31, 4, v31
    v_add_u32 v30, v30, v31
    v_mfma_f32_16x16x32_bf16 v[240:243], v[108:111], v[60:63], v[240:243]
    ds_read_b64_tr_b16 v[104:105], v6 offset:9312
    ds_read_b64_tr_b16 v[106:107], v6 offset:13920
    v_add_u32 v30, 139264, v30
    s_mov_b32 s22, 0xf000f000
    v_mfma_f32_16x16x32_bf16 v[244:247], v[108:111], v[64:67], v[244:247]
    s_mov_b32 s23, 0xf000f000
    s_mov_b64 exec, s[22:23]
    ds_write_b128 v30, v[26:29]
    s_mov_b64 exec, -1
    v_mfma_f32_16x16x32_bf16 v[248:251], v[108:111], v[68:71], v[248:251]
    v_mfma_f32_16x16x32_bf16 v[252:255], v[108:111], v[72:75], v[252:255]
    ds_read_b64_tr_b16 v[108:109], v7 offset:0
    ds_read_b64_tr_b16 v[110:111], v7 offset:4608
    s_waitcnt lgkmcnt(14)
    v_mfma_f32_16x16x32_bf16 v[112:115], v[76:79], v[44:47], v[112:115]
    v_mfma_f32_16x16x32_bf16 v[116:119], v[76:79], v[48:51], v[116:119]
    v_mfma_f32_16x16x32_bf16 v[120:123], v[76:79], v[52:55], v[120:123]
    v_mfma_f32_16x16x32_bf16 v[124:127], v[76:79], v[56:59], v[124:127]
    v_mfma_f32_16x16x32_bf16 v[128:131], v[80:83], v[44:47], v[128:131]
    v_mfma_f32_16x16x32_bf16 v[132:135], v[80:83], v[48:51], v[132:135]
    v_mfma_f32_16x16x32_bf16 v[136:139], v[80:83], v[52:55], v[136:139]
    v_mfma_f32_16x16x32_bf16 v[140:143], v[80:83], v[56:59], v[140:143]
    s_waitcnt lgkmcnt(0)
    s_barrier
    s_cmp_lg_u32 s7, 7
    s_nop 0
    s_cbranch_scc1 G1_NOSTAT_1
    v_and_b32 v30, 15, v1
    v_lshlrev_b32 v30, 2, v30
    v_lshrrev_b32 v31, 4, v1
    v_lshlrev_b32 v31, 9, v31
    v_add_u32 v30, v30, v31
    v_add_u32 v30, 139264, v30
    ds_read_b32 v12, v30 offset:0
    ds_read_b32 v13, v30 offset:64
    ds_read_b32 v14, v30 offset:128
    ds_read_b32 v15, v30 offset:192
    ds_read_b32 v16, v30 offset:256
    ds_read_b32 v17, v30 offset:320
    ds_read_b32 v18, v30 offset:384
    ds_read_b32 v19, v30 offset:448
    s_waitcnt lgkmcnt(0)
    v_add_f32 v12, v12, v13
    v_add_f32 v12, v12, v14
    v_add_f32 v12, v12, v15
    v_add_f32 v12, v12, v16
    v_add_f32 v12, v12, v17
    v_add_f32 v12, v12, v18
    v_add_f32 v12, v12, v19
    v_mov_b32 v13, v12
    s_nop 1
    v_permlane32_swap_b32 v12, v13
    v_add_f32 v12, v12, v13
    v_mov_b32 v13, v12
    s_nop 1
    v_permlane16_swap_b32 v12, v13
    v_add_f32 v12, v12, v13
    s_nop 1
    v_mov_b32_dpp v13, v12 quad_perm:[2,3,0,1] row_mask:0xf bank_mask:0xf
    v_mul_f32 v12, 0x3ae38e39, v12
    v_mul_f32 v13, 0x3ae38e39, v13
    v_fma_f32 v13, -v12, v12, v13
    v_max_f32 v13, 0, v13
    v_cvt_pk_bf16_f32 v12, v12, v12
    v_lshlrev_b32 v12, 16, v12
    v_cvt_pk_bf16_f32 v13, v13, v13
    v_lshlrev_b32 v13, 16, v13
    v_add_f32 v13, 0x3727c5ac, v13
    v_cvt_pk_bf16_f32 v13, v13, v13
    v_lshlrev_b32 v13, 16, v13
    v_sqrt_f32 v13, v13
    s_nop 0
    v_cvt_pk_bf16_f32 v13, v13, v13
    v_lshlrev_b32 v13, 16, v13
    v_rcp_f32 v14, v13
    s_nop 0
    v_mul_f32 v15, -v12, v14
    v_lshrrev_b32 v16, 2, v1
    v_lshlrev_b32 v16, 1, v16
    v_and_b32 v17, 1, v1
    v_add_u32 v16, v16, v17
    s_lshl_b32 s22, s5, 8
    s_lshl_b32 s23, s6, 3
    s_add_u32 s22, s22, s23
    v_add_u32 v16, s22, v16
    v_lshlrev_b32 v16, 3, v16
    s_mov_b64 exec, 0x3333
    buffer_store_dwordx2 v[14:15], v16, s[32:35], 0 offen sc0 sc1
    s_mov_b64 exec, -1
G1_NOSTAT_1:
    v_mfma_f32_16x16x32_bf16 v[144:147], v[84:87], v[44:47], v[144:147]
    ds_read_b64_tr_b16 v[76:77], v6 offset:34816
    ds_read_b64_tr_b16 v[78:79], v6 offset:39424
    v_mfma_f32_16x16x32_bf16 v[148:151], v[84:87], v[48:51], v[148:151]
    s_add_u32 m0, s49, 0
    s_nop 0
    buffer_load_dwordx4 v8, s[24:27], s51 offen lds
    v_mfma_f32_16x16x32_bf16 v[152:155], v[84:87], v[52:55], v[152:155]
    ds_read_b64_tr_b16 v[80:81], v6 offset:34848
    ds_read_b64_tr_b16 v[82:83], v6 offset:39456
    v_mfma_f32_16x16x32_bf16 v[156:159], v[84:87], v[56:59], v[156:159]
    v_mfma_f32_16x16x32_bf16 v[160:163], v[88:91], v[44:47], v[160:163]
    ds_read_b64_tr_b16 v[60:61], v2 offset:34816
    ds_read_b64_tr_b16 v[62:63], v2 offset:43008
    v_mfma_f32_16x16x32_bf16 v[164:167], v[88:91], v[48:51], v[164:167]
    buffer_load_dwordx4 v9, s[24:27], s51 offen offset:1024 lds
    s_add_u32 s51, s51, 0x20000
    v_mfma_f32_16x16x32_bf16 v[168:171], v[88:91], v[52:55], v[168:171]
    ds_read_b64_tr_b16 v[64:65], v3 offset:34816
    ds_read_b64_tr_b16 v[66:67], v3 offset:43008
    v_mfma_f32_16x16x32_bf16 v[172:175], v[88:91], v[56:59], v[172:175]
    v_mfma_f32_16x16x32_bf16 v[176:179], v[92:95], v[44:47], v[176:179]
    ds_read_b64_tr_b16 v[68:69], v4 offset:34816
    ds_read_b64_tr_b16 v[70:71], v4 offset:43008
    v_mfma_f32_16x16x32_bf16 v[180:183], v[92:95], v[48:51], v[180:183]
    s_add_u32 m0, s50, 0
    s_nop 0
    buffer_load_dwordx4 v10, s[12:15], s52 offen lds
    v_mfma_f32_16x16x32_bf16 v[184:187], v[92:95], v[52:55], v[184:187]
    ds_read_b64_tr_b16 v[72:73], v5 offset:34816
    ds_read_b64_tr_b16 v[74:75], v5 offset:43008
    v_mfma_f32_16x16x32_bf16 v[188:191], v[92:95], v[56:59], v[188:191]
    v_mfma_f32_16x16x32_bf16 v[192:195], v[96:99], v[44:47], v[192:195]
    ds_read_b64_tr_b16 v[84:85], v6 offset:34880
    ds_read_b64_tr_b16 v[86:87], v6 offset:39488
    v_mfma_f32_16x16x32_bf16 v[196:199], v[96:99], v[48:51], v[196:199]
    ds_read_b64_tr_b16 v[88:89], v6 offset:34912
    ds_read_b64_tr_b16 v[90:91], v6 offset:39520
    s_add_u32 m0, s50, 9216
    s_nop 0
    buffer_load_dwordx4 v10, s[16:19], s52 offen lds
    v_mfma_f32_16x16x32_bf16 v[200:203], v[96:99], v[52:55], v[200:203]
    ds_read_b64_tr_b16 v[92:93], v6 offset:44032
    ds_read_b64_tr_b16 v[94:95], v6 offset:48640
    v_mfma_f32_16x16x32_bf16 v[204:207], v[96:99], v[56:59], v[204:207]
    v_mfma_f32_16x16x32_bf16 v[208:211], v[100:103], v[44:47], v[208:211]
    ds_read_b64_tr_b16 v[96:97], v6 offset:44064
    ds_read_b64_tr_b16 v[98:99], v6 offset:48672
    v_mfma_f32_16x16x32_bf16 v[212:215], v[100:103], v[48:51], v[212:215]
    s_add_u32 m0, s48, 0
    s_nop 0
    buffer_load_dword v11, s[44:47], s52 offen lds
    s_add_u32 s52, s52, 294912
    v_mfma_f32_16x16x32_bf16 v[216:219], v[100:103], v[52:55], v[216:219]
    v_mfma_f32_16x16x32_bf16 v[220:223], v[100:103], v[56:59], v[220:223]
    v_mfma_f32_16x16x32_bf16 v[224:227], v[104:107], v[44:47], v[224:227]
    ds_read_b64_tr_b16 v[100:101], v6 offset:44096
    ds_read_b64_tr_b16 v[102:103], v6 offset:48704
    v_mfma_f32_16x16x32_bf16 v[228:231], v[104:107], v[48:51], v[228:231]
    v_mfma_f32_16x16x32_bf16 v[232:235], v[104:107], v[52:55], v[232:235]
    v_mfma_f32_16x16x32_bf16 v[236:239], v[104:107], v[56:59], v[236:239]
    v_mfma_f32_16x16x32_bf16 v[240:243], v[108:111], v[44:47], v[240:243]
    ds_read_b64_tr_b16 v[104:105], v6 offset:44128
    ds_read_b64_tr_b16 v[106:107], v6 offset:48736
    v_mfma_f32_16x16x32_bf16 v[244:247], v[108:111], v[48:51], v[244:247]
    v_mfma_f32_16x16x32_bf16 v[248:251], v[108:111], v[52:55], v[248:251]
    v_mfma_f32_16x16x32_bf16 v[252:255], v[108:111], v[56:59], v[252:255]
    ds_read_b64_tr_b16 v[108:109], v7 offset:34816
    ds_read_b64_tr_b16 v[110:111], v7 offset:39424
    s_waitcnt lgkmcnt(14)
    v_mfma_f32_16x16x32_bf16 v[112:115], v[76:79], v[60:63], v[112:115]
    v_mfma_f32_16x16x32_bf16 v[116:119], v[76:79], v[64:67], v[116:119]
    v_mfma_f32_16x16x32_bf16 v[120:123], v[76:79], v[68:71], v[120:123]
    v_mfma_f32_16x16x32_bf16 v[124:127], v[76:79], v[72:75], v[124:127]
    v_mfma_f32_16x16x32_bf16 v[128:131], v[80:83], v[60:63], v[128:131]
    v_mfma_f32_16x16x32_bf16 v[132:135], v[80:83], v[64:67], v[132:135]
    v_mfma_f32_16x16x32_bf16 v[136:139], v[80:83], v[68:71], v[136:139]
    v_mfma_f32_16x16x32_bf16 v[140:143], v[80:83], v[72:75], v[140:143]
    s_waitcnt vmcnt(10) lgkmcnt(0)
    s_barrier
    v_mfma_f32_16x16x32_bf16 v[144:147], v[84:87], v[60:63], v[144:147]
    ds_read_b64_tr_b16 v[76:77], v36 offset:0
    ds_read_b64_tr_b16 v[78:79], v36 offset:4608
    v_mfma_f32_16x16x32_bf16 v[148:151], v[84:87], v[64:67], v[148:151]
    s_add_u32 m0, s49, 34816
    s_nop 0
    buffer_load_dwordx4 v8, s[24:27], s51 offen lds
    v_mfma_f32_16x16x32_bf16 v[152:155], v[84:87], v[68:71], v[152:155]
    ds_read_b64_tr_b16 v[80:81], v36 offset:32
    ds_read_b64_tr_b16 v[82:83], v36 offset:4640
    v_mfma_f32_16x16x32_bf16 v[156:159], v[84:87], v[72:75], v[156:159]
    v_mfma_f32_16x16x32_bf16 v[160:163], v[88:91], v[60:63], v[160:163]
    ds_read_b64_tr_b16 v[44:45], v32 offset:0
    ds_read_b64_tr_b16 v[46:47], v32 offset:8192
    v_mfma_f32_16x16x32_bf16 v[164:167], v[88:91], v[64:67], v[164:167]
    buffer_load_dwordx4 v9, s[24:27], s51 offen offset:1024 lds
    s_add_u32 s51, s51, 0x20000
    v_mfma_f32_16x16x32_bf16 v[168:171], v[88:91], v[68:71], v[168:171]
    ds_read_b64_tr_b16 v[48:49], v33 offset:0
    ds_read_b64_tr_b16 v[50:51], v33 offset:8192
    v_mfma_f32_16x16x32_bf16 v[172:175], v[88:91], v[72:75], v[172:175]
    v_mfma_f32_16x16x32_bf16 v[176:179], v[92:95], v[60:63], v[176:179]
    ds_read_b64_tr_b16 v[52:53], v34 offset:0
    ds_read_b64_tr_b16 v[54:55], v34 offset:8192
    v_mfma_f32_16x16x32_bf16 v[180:183], v[92:95], v[64:67], v[180:183]
    s_add_u32 m0, s50, 34816
    s_nop 0
    buffer_load_dwordx4 v10, s[12:15], s52 offen lds
    v_mfma_f32_16x16x32_bf16 v[184:187], v[92:95], v[68:71], v[184:187]
    ds_read_b64_tr_b16 v[56:57], v35 offset:0
    ds_read_b64_tr_b16 v[58:59], v35 offset:8192
    v_mfma_f32_16x16x32_bf16 v[188:191], v[92:95], v[72:75], v[188:191]
    v_mfma_f32_16x16x32_bf16 v[192:195], v[96:99], v[60:63], v[192:195]
    ds_read_b64_tr_b16 v[84:85], v36 offset:64
    ds_read_b64_tr_b16 v[86:87], v36 offset:4672
    v_mfma_f32_16x16x32_bf16 v[196:199], v[96:99], v[64:67], v[196:199]
    ds_read_b64_tr_b16 v[88:89], v36 offset:96
    ds_read_b64_tr_b16 v[90:91], v36 offset:4704
    s_add_u32 m0, s50, 44032
    s_nop 0
    buffer_load_dwordx4 v10, s[16:19], s52 offen lds
    v_mfma_f32_16x16x32_bf16 v[200:203], v[96:99], v[68:71], v[200:203]
    ds_read_b64_tr_b16 v[92:93], v36 offset:9216
    ds_read_b64_tr_b16 v[94:95], v36 offset:13824
    v_mfma_f32_16x16x32_bf16 v[204:207], v[96:99], v[72:75], v[204:207]
    v_mfma_f32_16x16x32_bf16 v[208:211], v[100:103], v[60:63], v[208:211]
    ds_read_b64_tr_b16 v[96:97], v36 offset:9248
    ds_read_b64_tr_b16 v[98:99], v36 offset:13856
    v_mfma_f32_16x16x32_bf16 v[212:215], v[100:103], v[64:67], v[212:215]
    s_add_u32 m0, s48, 34816
    s_nop 0
    buffer_load_dword v11, s[44:47], s52 offen lds
    s_add_u32 s52, s52, 294912
    v_mfma_f32_16x16x32_bf16 v[216:219], v[100:103], v[68:71], v[216:219]
    v_mfma_f32_16x16x32_bf16 v[220:223], v[100:103], v[72:75], v[220:223]
    v_mfma_f32_16x16x32_bf16 v[224:227], v[104:107], v[60:63], v[224:227]
    ds_read_b64_tr_b16 v[100:101], v36 offset:9280
    ds_read_b64_tr_b16 v[102:103], v36 offset:13888
    v_mfma_f32_16x16x32_bf16 v[228:231], v[104:107], v[64:67], v[228:231]
    v_mfma_f32_16x16x32_bf16 v[232:235], v[104:107], v[68:71], v[232:235]
    v_mfma_f32_16x16x32_bf16 v[236:239], v[104:107], v[72:75], v[236:239]
    v_mfma_f32_16x16x32_bf16 v[240:243], v[108:111], v[60:63], v[240:243]
    ds_read_b64_tr_b16 v[104:105], v36 offset:9312
    ds_read_b64_tr_b16 v[106:107], v36 offset:13920
    v_mfma_f32_16x16x32_bf16 v[244:247], v[108:111], v[64:67], v[244:247]
    v_mfma_f32_16x16x32_bf16 v[248:251], v[108:111], v[68:71], v[248:251]
    v_mfma_f32_16x16x32_bf16 v[252:255], v[108:111], v[72:75], v[252:255]
    ds_read_b64_tr_b16 v[108:109], v37 offset:0
    ds_read_b64_tr_b16 v[110:111], v37 offset:4608
    s_waitcnt lgkmcnt(14)
    v_mfma_f32_16x16x32_bf16 v[112:115], v[76:79], v[44:47], v[112:115]
    v_mfma_f32_16x16x32_bf16 v[116:119], v[76:79], v[48:51], v[116:119]
    v_mfma_f32_16x16x32_bf16 v[120:123], v[76:79], v[52:55], v[120:123]
    v_mfma_f32_16x16x32_bf16 v[124:127], v[76:79], v[56:59], v[124:127]
    v_mfma_f32_16x16x32_bf16 v[128:131], v[80:83], v[44:47], v[128:131]
    v_mfma_f32_16x16x32_bf16 v[132:135], v[80:83], v[48:51], v[132:135]
    v_mfma_f32_16x16x32_bf16 v[136:139], v[80:83], v[52:55], v[136:139]
    v_mfma_f32_16x16x32_bf16 v[140:143], v[80:83], v[56:59], v[140:143]
    s_waitcnt vmcnt(10) lgkmcnt(0)
    s_barrier
    v_mfma_f32_16x16x32_bf16 v[144:147], v[84:87], v[44:47], v[144:147]
    ds_read_b64_tr_b16 v[76:77], v36 offset:34816
    ds_read_b64_tr_b16 v[78:79], v36 offset:39424
    v_mfma_f32_16x16x32_bf16 v[148:151], v[84:87], v[48:51], v[148:151]
    s_add_u32 m0, s49, 69632
    s_nop 0
    buffer_load_dwordx4 v8, s[24:27], s51 offen lds
    v_mfma_f32_16x16x32_bf16 v[152:155], v[84:87], v[52:55], v[152:155]
    ds_read_b64_tr_b16 v[80:81], v36 offset:34848
    ds_read_b64_tr_b16 v[82:83], v36 offset:39456
    v_mfma_f32_16x16x32_bf16 v[156:159], v[84:87], v[56:59], v[156:159]
    v_mfma_f32_16x16x32_bf16 v[160:163], v[88:91], v[44:47], v[160:163]
    ds_read_b64_tr_b16 v[60:61], v32 offset:34816
    ds_read_b64_tr_b16 v[62:63], v32 offset:43008
    v_mfma_f32_16x16x32_bf16 v[164:167], v[88:91], v[48:51], v[164:167]
    buffer_load_dwordx4 v9, s[24:27], s51 offen offset:1024 lds
    s_add_u32 s51, s51, 0x20000
    v_mfma_f32_16x16x32_bf16 v[168:171], v[88:91], v[52:55], v[168:171]
    ds_read_b64_tr_b16 v[64:65], v33 offset:34816
    ds_read_b64_tr_b16 v[66:67], v33 offset:43008
    v_mfma_f32_16x16x32_bf16 v[172:175], v[88:91], v[56:59], v[172:175]
    v_mfma_f32_16x16x32_bf16 v[176:179], v[92:95], v[44:47], v[176:179]
    ds_read_b64_tr_b16 v[68:69], v34 offset:34816
    ds_read_b64_tr_b16 v[70:71], v34 offset:43008
    v_mfma_f32_16x16x32_bf16 v[180:183], v[92:95], v[48:51], v[180:183]
    s_add_u32 m0, s50, 69632
    s_nop 0
    buffer_load_dwordx4 v10, s[12:15], s52 offen lds
    v_mfma_f32_16x16x32_bf16 v[184:187], v[92:95], v[52:55], v[184:187]
    ds_read_b64_tr_b16 v[72:73], v35 offset:34816
    ds_read_b64_tr_b16 v[74:75], v35 offset:43008
    v_mfma_f32_16x16x32_bf16 v[188:191], v[92:95], v[56:59], v[188:191]
    v_mfma_f32_16x16x32_bf16 v[192:195], v[96:99], v[44:47], v[192:195]
    ds_read_b64_tr_b16 v[84:85], v36 offset:34880
    ds_read_b64_tr_b16 v[86:87], v36 offset:39488
    v_mfma_f32_16x16x32_bf16 v[196:199], v[96:99], v[48:51], v[196:199]
    ds_read_b64_tr_b16 v[88:89], v36 offset:34912
    ds_read_b64_tr_b16 v[90:91], v36 offset:39520
    s_add_u32 m0, s50, 78848
    s_nop 0
    buffer_load_dwordx4 v10, s[16:19], s52 offen lds
    v_mfma_f32_16x16x32_bf16 v[200:203], v[96:99], v[52:55], v[200:203]
    ds_read_b64_tr_b16 v[92:93], v36 offset:44032
    ds_read_b64_tr_b16 v[94:95], v36 offset:48640
    v_mfma_f32_16x16x32_bf16 v[204:207], v[96:99], v[56:59], v[204:207]
    v_mfma_f32_16x16x32_bf16 v[208:211], v[100:103], v[44:47], v[208:211]
    ds_read_b64_tr_b16 v[96:97], v36 offset:44064
    ds_read_b64_tr_b16 v[98:99], v36 offset:48672
    v_mfma_f32_16x16x32_bf16 v[212:215], v[100:103], v[48:51], v[212:215]
    s_add_u32 m0, s48, 69632
    s_nop 0
    buffer_load_dword v11, s[44:47], s52 offen lds
    s_add_u32 s52, s52, 294912
    v_mfma_f32_16x16x32_bf16 v[216:219], v[100:103], v[52:55], v[216:219]
    v_mfma_f32_16x16x32_bf16 v[220:223], v[100:103], v[56:59], v[220:223]
    v_mfma_f32_16x16x32_bf16 v[224:227], v[104:107], v[44:47], v[224:227]
    ds_read_b64_tr_b16 v[100:101], v36 offset:44096
    ds_read_b64_tr_b16 v[102:103], v36 offset:48704
    v_mfma_f32_16x16x32_bf16 v[228:231], v[104:107], v[48:51], v[228:231]
    v_mfma_f32_16x16x32_bf16 v[232:235], v[104:107], v[52:55], v[232:235]
    v_mfma_f32_16x16x32_bf16 v[236:239], v[104:107], v[56:59], v[236:239]
    v_mfma_f32_16x16x32_bf16 v[240:243], v[108:111], v[44:47], v[240:243]
    ds_read_b64_tr_b16 v[104:105], v36 offset:44128
    ds_read_b64_tr_b16 v[106:107], v36 offset:48736
    v_mfma_f32_16x16x32_bf16 v[244:247], v[108:111], v[48:51], v[244:247]
    v_mfma_f32_16x16x32_bf16 v[248:251], v[108:111], v[52:55], v[248:251]
    v_mfma_f32_16x16x32_bf16 v[252:255], v[108:111], v[56:59], v[252:255]
    ds_read_b64_tr_b16 v[108:109], v37 offset:34816
    ds_read_b64_tr_b16 v[110:111], v37 offset:39424
    s_waitcnt lgkmcnt(14)
    v_mfma_f32_16x16x32_bf16 v[112:115], v[76:79], v[60:63], v[112:115]
    v_mfma_f32_16x16x32_bf16 v[116:119], v[76:79], v[64:67], v[116:119]
    v_mfma_f32_16x16x32_bf16 v[120:123], v[76:79], v[68:71], v[120:123]
    v_mfma_f32_16x16x32_bf16 v[124:127], v[76:79], v[72:75], v[124:127]
    v_mfma_f32_16x16x32_bf16 v[128:131], v[80:83], v[60:63], v[128:131]
    v_mfma_f32_16x16x32_bf16 v[132:135], v[80:83], v[64:67], v[132:135]
    v_mfma_f32_16x16x32_bf16 v[136:139], v[80:83], v[68:71], v[136:139]
    v_mfma_f32_16x16x32_bf16 v[140:143], v[80:83], v[72:75], v[140:143]
    s_waitcnt vmcnt(10) lgkmcnt(0)
    s_barrier
    v_mfma_f32_16x16x32_bf16 v[144:147], v[84:87], v[60:63], v[144:147]
    ds_read_b64_tr_b16 v[76:77], v6 offset:0
    ds_read_b64_tr_b16 v[78:79], v6 offset:4608
    v_mfma_f32_16x16x32_bf16 v[148:151], v[84:87], v[64:67], v[148:151]
    s_add_u32 m0, s49, 104448
    s_nop 0
    buffer_load_dwordx4 v8, s[24:27], s51 offen lds
    v_mfma_f32_16x16x32_bf16 v[152:155], v[84:87], v[68:71], v[152:155]
    ds_read_b64_tr_b16 v[80:81], v6 offset:32
    ds_read_b64_tr_b16 v[82:83], v6 offset:4640
    v_mfma_f32_16x16x32_bf16 v[156:159], v[84:87], v[72:75], v[156:159]
    v_mfma_f32_16x16x32_bf16 v[160:163], v[88:91], v[60:63], v[160:163]
    ds_read_b64_tr_b16 v[44:45], v2 offset:0
    ds_read_b64_tr_b16 v[46:47], v2 offset:8192
    v_mfma_f32_16x16x32_bf16 v[164:167], v[88:91], v[64:67], v[164:167]
    buffer_load_dwordx4 v9, s[24:27], s51 offen offset:1024 lds
    s_add_u32 s51, s51, 0x20000
    v_mfma_f32_16x16x32_bf16 v[168:171], v[88:91], v[68:71], v[168:171]
    ds_read_b64_tr_b16 v[48:49], v3 offset:0
    ds_read_b64_tr_b16 v[50:51], v3 offset:8192
    v_mfma_f32_16x16x32_bf16 v[172:175], v[88:91], v[72:75], v[172:175]
    v_mfma_f32_16x16x32_bf16 v[176:179], v[92:95], v[60:63], v[176:179]
    ds_read_b64_tr_b16 v[52:53], v4 offset:0
    ds_read_b64_tr_b16 v[54:55], v4 offset:8192
    v_mfma_f32_16x16x32_bf16 v[180:183], v[92:95], v[64:67], v[180:183]
    s_add_u32 m0, s50, 104448
    s_nop 0
    buffer_load_dwordx4 v10, s[12:15], s52 offen lds
    v_mfma_f32_16x16x32_bf16 v[184:187], v[92:95], v[68:71], v[184:187]
    ds_read_b64_tr_b16 v[56:57], v5 offset:0
    ds_read_b64_tr_b16 v[58:59], v5 offset:8192
    v_mfma_f32_16x16x32_bf16 v[188:191], v[92:95], v[72:75], v[188:191]
    v_mfma_f32_16x16x32_bf16 v[192:195], v[96:99], v[60:63], v[192:195]
    ds_read_b64_tr_b16 v[84:85], v6 offset:64
    ds_read_b64_tr_b16 v[86:87], v6 offset:4672
    v_mfma_f32_16x16x32_bf16 v[196:199], v[96:99], v[64:67], v[196:199]
    ds_read_b64_tr_b16 v[88:89], v6 offset:96
    ds_read_b64_tr_b16 v[90:91], v6 offset:4704
    s_add_u32 m0, s50, 113664
    s_nop 0
    buffer_load_dwordx4 v10, s[16:19], s52 offen lds
    v_mfma_f32_16x16x32_bf16 v[200:203], v[96:99], v[68:71], v[200:203]
    ds_read_b64_tr_b16 v[92:93], v6 offset:9216
    ds_read_b64_tr_b16 v[94:95], v6 offset:13824
    v_mfma_f32_16x16x32_bf16 v[204:207], v[96:99], v[72:75], v[204:207]
    v_mfma_f32_16x16x32_bf16 v[208:211], v[100:103], v[60:63], v[208:211]
    ds_read_b64_tr_b16 v[96:97], v6 offset:9248
    ds_read_b64_tr_b16 v[98:99], v6 offset:13856
    v_mfma_f32_16x16x32_bf16 v[212:215], v[100:103], v[64:67], v[212:215]
    s_add_u32 m0, s48, 104448
    s_nop 0
    buffer_load_dword v11, s[44:47], s52 offen lds
    s_add_u32 s52, s52, 294912
    v_mfma_f32_16x16x32_bf16 v[216:219], v[100:103], v[68:71], v[216:219]
    v_mfma_f32_16x16x32_bf16 v[220:223], v[100:103], v[72:75], v[220:223]
    v_mfma_f32_16x16x32_bf16 v[224:227], v[104:107], v[60:63], v[224:227]
    ds_read_b64_tr_b16 v[100:101], v6 offset:9280
    ds_read_b64_tr_b16 v[102:103], v6 offset:13888
    v_mfma_f32_16x16x32_bf16 v[228:231], v[104:107], v[64:67], v[228:231]
    v_mfma_f32_16x16x32_bf16 v[232:235], v[104:107], v[68:71], v[232:235]
    v_mfma_f32_16x16x32_bf16 v[236:239], v[104:107], v[72:75], v[236:239]
    v_mfma_f32_16x16x32_bf16 v[240:243], v[108:111], v[60:63], v[240:243]
    ds_read_b64_tr_b16 v[104:105], v6 offset:9312
    ds_read_b64_tr_b16 v[106:107], v6 offset:13920
    v_mfma_f32_16x16x32_bf16 v[244:247], v[108:111], v[64:67], v[244:247]
    v_mfma_f32_16x16x32_bf16 v[248:251], v[108:111], v[68:71], v[248:251]
    v_mfma_f32_16x16x32_bf16 v[252:255], v[108:111], v[72:75], v[252:255]
    ds_read_b64_tr_b16 v[108:109], v7 offset:0
    ds_read_b64_tr_b16 v[110:111], v7 offset:4608
    s_waitcnt lgkmcnt(14)
    v_mfma_f32_16x16x32_bf16 v[112:115], v[76:79], v[44:47], v[112:115]
    v_mfma_f32_16x16x32_bf16 v[116:119], v[76:79], v[48:51], v[116:119]
    v_mfma_f32_16x16x32_bf16 v[120:123], v[76:79], v[52:55], v[120:123]
    v_mfma_f32_16x16x32_bf16 v[124:127], v[76:79], v[56:59], v[124:127]
    v_mfma_f32_16x16x32_bf16 v[128:131], v[80:83], v[44:47], v[128:131]
    v_mfma_f32_16x16x32_bf16 v[132:135], v[80:83], v[48:51], v[132:135]
    v_mfma_f32_16x16x32_bf16 v[136:139], v[80:83], v[52:55], v[136:139]
    v_mfma_f32_16x16x32_bf16 v[140:143], v[80:83], v[56:59], v[140:143]
    s_waitcnt vmcnt(10) lgkmcnt(0)
    s_barrier
    v_mfma_f32_16x16x32_bf16 v[144:147], v[84:87], v[44:47], v[144:147]
    ds_read_b64_tr_b16 v[76:77], v6 offset:34816
    ds_read_b64_tr_b16 v[78:79], v6 offset:39424
    v_mfma_f32_16x16x32_bf16 v[148:151], v[84:87], v[48:51], v[148:151]
    s_add_u32 m0, s49, 0
    s_nop 0
    buffer_load_dwordx4 v8, s[24:27], s51 offen lds
    v_mfma_f32_16x16x32_bf16 v[152:155], v[84:87], v[52:55], v[152:155]
    ds_read_b64_tr_b16 v[80:81], v6 offset:34848
    ds_read_b64_tr_b16 v[82:83], v6 offset:39456
    v_mfma_f32_16x16x32_bf16 v[156:159], v[84:87], v[56:59], v[156:159]
    v_mfma_f32_16x16x32_bf16 v[160:163], v[88:91], v[44:47], v[160:163]
    ds_read_b64_tr_b16 v[60:61], v2 offset:34816
    ds_read_b64_tr_b16 v[62:63], v2 offset:43008
    v_mfma_f32_16x16x32_bf16 v[164:167], v[88:91], v[48:51], v[164:167]
    buffer_load_dwordx4 v9, s[24:27], s51 offen offset:1024 lds
    s_add_u32 s51, s51, 0x20000
    v_mfma_f32_16x16x32_bf16 v[168:171], v[88:91], v[52:55], v[168:171]
    ds_read_b64_tr_b16 v[64:65], v3 offset:34816
    ds_read_b64_tr_b16 v[66:67], v3 offset:43008
    v_mfma_f32_16x16x32_bf16 v[172:175], v[88:91], v[56:59], v[172:175]
    v_mfma_f32_16x16x32_bf16 v[176:179], v[92:95], v[44:47], v[176:179]
    ds_read_b64_tr_b16 v[68:69], v4 offset:34816
    ds_read_b64_tr_b16 v[70:71], v4 offset:43008
    v_mfma_f32_16x16x32_bf16 v[180:183], v[92:95], v[48:51], v[180:183]
    s_add_u32 m0, s50, 0
    s_nop 0
    buffer_load_dwordx4 v10, s[12:15], s52 offen lds
    v_mfma_f32_16x16x32_bf16 v[184:187], v[92:95], v[52:55], v[184:187]
    ds_read_b64_tr_b16 v[72:73], v5 offset:34816
    ds_read_b64_tr_b16 v[74:75], v5 offset:43008
    v_mfma_f32_16x16x32_bf16 v[188:191], v[92:95], v[56:59], v[188:191]
    v_mfma_f32_16x16x32_bf16 v[192:195], v[96:99], v[44:47], v[192:195]
    ds_read_b64_tr_b16 v[84:85], v6 offset:34880
    ds_read_b64_tr_b16 v[86:87], v6 offset:39488
    v_mfma_f32_16x16x32_bf16 v[196:199], v[96:99], v[48:51], v[196:199]
    ds_read_b64_tr_b16 v[88:89], v6 offset:34912
    ds_read_b64_tr_b16 v[90:91], v6 offset:39520
    s_add_u32 m0, s50, 9216
    s_nop 0
    buffer_load_dwordx4 v10, s[16:19], s52 offen lds
    v_mfma_f32_16x16x32_bf16 v[200:203], v[96:99], v[52:55], v[200:203]
    ds_read_b64_tr_b16 v[92:93], v6 offset:44032
    ds_read_b64_tr_b16 v[94:95], v6 offset:48640
    v_mfma_f32_16x16x32_bf16 v[204:207], v[96:99], v[56:59], v[204:207]
    v_mfma_f32_16x16x32_bf16 v[208:211], v[100:103], v[44:47], v[208:211]
    ds_read_b64_tr_b16 v[96:97], v6 offset:44064
    ds_read_b64_tr_b16 v[98:99], v6 offset:48672
    v_mfma_f32_16x16x32_bf16 v[212:215], v[100:103], v[48:51], v[212:215]
    s_add_u32 m0, s48, 0
    s_nop 0
    buffer_load_dword v11, s[44:47], s52 offen lds
    s_add_u32 s52, s52, 294912
    v_mfma_f32_16x16x32_bf16 v[216:219], v[100:103], v[52:55], v[216:219]
    v_mfma_f32_16x16x32_bf16 v[220:223], v[100:103], v[56:59], v[220:223]
    v_mfma_f32_16x16x32_bf16 v[224:227], v[104:107], v[44:47], v[224:227]
    ds_read_b64_tr_b16 v[100:101], v6 offset:44096
    ds_read_b64_tr_b16 v[102:103], v6 offset:48704
    v_mfma_f32_16x16x32_bf16 v[228:231], v[104:107], v[48:51], v[228:231]
    v_mfma_f32_16x16x32_bf16 v[232:235], v[104:107], v[52:55], v[232:235]
    v_mfma_f32_16x16x32_bf16 v[236:239], v[104:107], v[56:59], v[236:239]
    v_mfma_f32_16x16x32_bf16 v[240:243], v[108:111], v[44:47], v[240:243]
    ds_read_b64_tr_b16 v[104:105], v6 offset:44128
    ds_read_b64_tr_b16 v[106:107], v6 offset:48736
    v_mfma_f32_16x16x32_bf16 v[244:247], v[108:111], v[48:51], v[244:247]
    v_mfma_f32_16x16x32_bf16 v[248:251], v[108:111], v[52:55], v[248:251]
    v_mfma_f32_16x16x32_bf16 v[252:255], v[108:111], v[56:59], v[252:255]
    ds_read_b64_tr_b16 v[108:109], v7 offset:34816
    ds_read_b64_tr_b16 v[110:111], v7 offset:39424
    s_waitcnt lgkmcnt(14)
    v_mfma_f32_16x16x32_bf16 v[112:115], v[76:79], v[60:63], v[112:115]
    v_mfma_f32_16x16x32_bf16 v[116:119], v[76:79], v[64:67], v[116:119]
    v_mfma_f32_16x16x32_bf16 v[120:123], v[76:79], v[68:71], v[120:123]
    v_mfma_f32_16x16x32_bf16 v[124:127], v[76:79], v[72:75], v[124:127]
    v_mfma_f32_16x16x32_bf16 v[128:131], v[80:83], v[60:63], v[128:131]
    v_mfma_f32_16x16x32_bf16 v[132:135], v[80:83], v[64:67], v[132:135]
    v_mfma_f32_16x16x32_bf16 v[136:139], v[80:83], v[68:71], v[136:139]
    v_mfma_f32_16x16x32_bf16 v[140:143], v[80:83], v[72:75], v[140:143]
    s_waitcnt vmcnt(10) lgkmcnt(0)
    s_barrier
    v_mfma_f32_16x16x32_bf16 v[144:147], v[84:87], v[60:63], v[144:147]
    ds_read_b64_tr_b16 v[76:77], v36 offset:0
    ds_read_b64_tr_b16 v[78:79], v36 offset:4608
    v_mfma_f32_16x16x32_bf16 v[148:151], v[84:87], v[64:67], v[148:151]
    s_add_u32 m0, s49, 34816
    s_nop 0
    buffer_load_dwordx4 v8, s[24:27], s51 offen lds
    v_mfma_f32_16x16x32_bf16 v[152:155], v[84:87], v[68:71], v[152:155]
    ds_read_b64_tr_b16 v[80:81], v36 offset:32
    ds_read_b64_tr_b16 v[82:83], v36 offset:4640
    v_mfma_f32_16x16x32_bf16 v[156:159], v[84:87], v[72:75], v[156:159]
    v_mfma_f32_16x16x32_bf16 v[160:163], v[88:91], v[60:63], v[160:163]
    ds_read_b64_tr_b16 v[44:45], v32 offset:0
    ds_read_b64_tr_b16 v[46:47], v32 offset:8192
    v_mfma_f32_16x16x32_bf16 v[164:167], v[88:91], v[64:67], v[164:167]
    buffer_load_dwordx4 v9, s[24:27], s51 offen offset:1024 lds
    s_add_u32 s51, s51, 0x20000
    v_mfma_f32_16x16x32_bf16 v[168:171], v[88:91], v[68:71], v[168:171]
    ds_read_b64_tr_b16 v[48:49], v33 offset:0
    ds_read_b64_tr_b16 v[50:51], v33 offset:8192
    v_mfma_f32_16x16x32_bf16 v[172:175], v[88:91], v[72:75], v[172:175]
    v_mfma_f32_16x16x32_bf16 v[176:179], v[92:95], v[60:63], v[176:179]
    ds_read_b64_tr_b16 v[52:53], v34 offset:0
    ds_read_b64_tr_b16 v[54:55], v34 offset:8192
    v_mfma_f32_16x16x32_bf16 v[180:183], v[92:95], v[64:67], v[180:183]
    s_add_u32 m0, s50, 34816
    s_nop 0
    buffer_load_dwordx4 v10, s[12:15], s52 offen lds
    v_mfma_f32_16x16x32_bf16 v[184:187], v[92:95], v[68:71], v[184:187]
    ds_read_b64_tr_b16 v[56:57], v35 offset:0
    ds_read_b64_tr_b16 v[58:59], v35 offset:8192
    v_mfma_f32_16x16x32_bf16 v[188:191], v[92:95], v[72:75], v[188:191]
    v_mfma_f32_16x16x32_bf16 v[192:195], v[96:99], v[60:63], v[192:195]
    ds_read_b64_tr_b16 v[84:85], v36 offset:64
    ds_read_b64_tr_b16 v[86:87], v36 offset:4672
    v_mfma_f32_16x16x32_bf16 v[196:199], v[96:99], v[64:67], v[196:199]
    ds_read_b64_tr_b16 v[88:89], v36 offset:96
    ds_read_b64_tr_b16 v[90:91], v36 offset:4704
    s_add_u32 m0, s50, 44032
    s_nop 0
    buffer_load_dwordx4 v10, s[16:19], s52 offen lds
    v_mfma_f32_16x16x32_bf16 v[200:203], v[96:99], v[68:71], v[200:203]
    ds_read_b64_tr_b16 v[92:93], v36 offset:9216
    ds_read_b64_tr_b16 v[94:95], v36 offset:13824
    v_mfma_f32_16x16x32_bf16 v[204:207], v[96:99], v[72:75], v[204:207]
    v_mfma_f32_16x16x32_bf16 v[208:211], v[100:103], v[60:63], v[208:211]
    ds_read_b64_tr_b16 v[96:97], v36 offset:9248
    ds_read_b64_tr_b16 v[98:99], v36 offset:13856
    v_mfma_f32_16x16x32_bf16 v[212:215], v[100:103], v[64:67], v[212:215]
    s_add_u32 m0, s48, 34816
    s_nop 0
    buffer_load_dword v11, s[44:47], s52 offen lds
    s_add_u32 s52, s52, 294912
    v_mfma_f32_16x16x32_bf16 v[216:219], v[100:103], v[68:71], v[216:219]
    v_mfma_f32_16x16x32_bf16 v[220:223], v[100:103], v[72:75], v[220:223]
    v_mfma_f32_16x16x32_bf16 v[224:227], v[104:107], v[60:63], v[224:227]
    ds_read_b64_tr_b16 v[100:101], v36 offset:9280
    ds_read_b64_tr_b16 v[102:103], v36 offset:13888
    v_mfma_f32_16x16x32_bf16 v[228:231], v[104:107], v[64:67], v[228:231]
    v_mfma_f32_16x16x32_bf16 v[232:235], v[104:107], v[68:71], v[232:235]
    v_mfma_f32_16x16x32_bf16 v[236:239], v[104:107], v[72:75], v[236:239]
    v_mfma_f32_16x16x32_bf16 v[240:243], v[108:111], v[60:63], v[240:243]
    ds_read_b64_tr_b16 v[104:105], v36 offset:9312
    ds_read_b64_tr_b16 v[106:107], v36 offset:13920
    v_mfma_f32_16x16x32_bf16 v[244:247], v[108:111], v[64:67], v[244:247]
    v_mfma_f32_16x16x32_bf16 v[248:251], v[108:111], v[68:71], v[248:251]
    v_mfma_f32_16x16x32_bf16 v[252:255], v[108:111], v[72:75], v[252:255]
    ds_read_b64_tr_b16 v[108:109], v37 offset:0
    ds_read_b64_tr_b16 v[110:111], v37 offset:4608
    s_waitcnt lgkmcnt(14)
    v_mfma_f32_16x16x32_bf16 v[112:115], v[76:79], v[44:47], v[112:115]
    v_mfma_f32_16x16x32_bf16 v[116:119], v[76:79], v[48:51], v[116:119]
    v_mfma_f32_16x16x32_bf16 v[120:123], v[76:79], v[52:55], v[120:123]
    v_mfma_f32_16x16x32_bf16 v[124:127], v[76:79], v[56:59], v[124:127]
    v_mfma_f32_16x16x32_bf16 v[128:131], v[80:83], v[44:47], v[128:131]
    v_mfma_f32_16x16x32_bf16 v[132:135], v[80:83], v[48:51], v[132:135]
    v_mfma_f32_16x16x32_bf16 v[136:139], v[80:83], v[52:55], v[136:139]
    v_mfma_f32_16x16x32_bf16 v[140:143], v[80:83], v[56:59], v[140:143]
    s_waitcnt vmcnt(10) lgkmcnt(0)
    s_barrier
    v_mfma_f32_16x16x32_bf16 v[144:147], v[84:87], v[44:47], v[144:147]
    ds_read_b64_tr_b16 v[76:77], v36 offset:34816
    ds_read_b64_tr_b16 v[78:79], v36 offset:39424
    buffer_load_dwordx2 v[12:13], v38, s[32:35], 0 offen offset:0 sc0 sc1
    v_mfma_f32_16x16x32_bf16 v[148:151], v[84:87], v[48:51], v[148:151]
    buffer_load_dwordx2 v[14:15], v38, s[32:35], 0 offen offset:128 sc0 sc1
    v_mfma_f32_16x16x32_bf16 v[152:155], v[84:87], v[52:55], v[152:155]
    ds_read_b64_tr_b16 v[80:81], v36 offset:34848
    ds_read_b64_tr_b16 v[82:83], v36 offset:39456
    buffer_load_dwordx2 v[16:17], v38, s[32:35], 0 offen offset:256 sc0 sc1
    v_mfma_f32_16x16x32_bf16 v[156:159], v[84:87], v[56:59], v[156:159]
    buffer_load_dwordx2 v[18:19], v38, s[32:35], 0 offen offset:384 sc0 sc1
    v_mfma_f32_16x16x32_bf16 v[160:163], v[88:91], v[44:47], v[160:163]
    ds_read_b64_tr_b16 v[60:61], v32 offset:34816
    ds_read_b64_tr_b16 v[62:63], v32 offset:43008
    buffer_load_dwordx2 v[20:21], v39, s[32:35], 0 offen offset:0 sc0 sc1
    v_mfma_f32_16x16x32_bf16 v[164:167], v[88:91], v[48:51], v[164:167]
    buffer_load_dwordx2 v[22:23], v39, s[32:35], 0 offen offset:256 sc0 sc1
    v_mfma_f32_16x16x32_bf16 v[168:171], v[88:91], v[52:55], v[168:171]
    ds_read_b64_tr_b16 v[64:65], v33 offset:34816
    ds_read_b64_tr_b16 v[66:67], v33 offset:43008
    v_mfma_f32_16x16x32_bf16 v[172:175], v[88:91], v[56:59], v[172:175]
    v_mfma_f32_16x16x32_bf16 v[176:179], v[92:95], v[44:47], v[176:179]
    ds_read_b64_tr_b16 v[68:69], v34 offset:34816
    ds_read_b64_tr_b16 v[70:71], v34 offset:43008
    v_mfma_f32_16x16x32_bf16 v[180:183], v[92:95], v[48:51], v[180:183]
    v_mfma_f32_16x16x32_bf16 v[184:187], v[92:95], v[52:55], v[184:187]
    ds_read_b64_tr_b16 v[72:73], v35 offset:34816
    ds_read_b64_tr_b16 v[74:75], v35 offset:43008
    v_mfma_f32_16x16x32_bf16 v[188:191], v[92:95], v[56:59], v[188:191]
    v_mfma_f32_16x16x32_bf16 v[192:195], v[96:99], v[44:47], v[192:195]
    ds_read_b64_tr_b16 v[84:85], v36 offset:34880
    ds_read_b64_tr_b16 v[86:87], v36 offset:39488
    v_mfma_f32_16x16x32_bf16 v[196:199], v[96:99], v[48:51], v[196:199]
    ds_read_b64_tr_b16 v[88:89], v36 offset:34912
    ds_read_b64_tr_b16 v[90:91], v36 offset:39520
    v_mfma_f32_16x16x32_bf16 v[200:203], v[96:99], v[52:55], v[200:203]
    ds_read_b64_tr_b16 v[92:93], v36 offset:44032
    ds_read_b64_tr_b16 v[94:95], v36 offset:48640
    v_mfma_f32_16x16x32_bf16 v[204:207], v[96:99], v[56:59], v[204:207]
    v_mfma_f32_16x16x32_bf16 v[208:211], v[100:103], v[44:47], v[208:211]
    ds_read_b64_tr_b16 v[96:97], v36 offset:44064
    ds_read_b64_tr_b16 v[98:99], v36 offset:48672
    v_mfma_f32_16x16x32_bf16 v[212:215], v[100:103], v[48:51], v[212:215]
    v_mfma_f32_16x16x32_bf16 v[216:219], v[100:103], v[52:55], v[216:219]
    v_mfma_f32_16x16x32_bf16 v[220:223], v[100:103], v[56:59], v[220:223]
    v_mfma_f32_16x16x32_bf16 v[224:227], v[104:107], v[44:47], v[224:227]
    ds_read_b64_tr_b16 v[100:101], v36 offset:44096
    ds_read_b64_tr_b16 v[102:103], v36 offset:48704
    v_mfma_f32_16x16x32_bf16 v[228:231], v[104:107], v[48:51], v[228:231]
    v_mfma_f32_16x16x32_bf16 v[232:235], v[104:107], v[52:55], v[232:235]
    v_mfma_f32_16x16x32_bf16 v[236:239], v[104:107], v[56:59], v[236:239]
    v_mfma_f32_16x16x32_bf16 v[240:243], v[108:111], v[44:47], v[240:243]
    ds_read_b64_tr_b16 v[104:105], v36 offset:44128
    ds_read_b64_tr_b16 v[106:107], v36 offset:48736
    v_mfma_f32_16x16x32_bf16 v[244:247], v[108:111], v[48:51], v[244:247]
    v_mfma_f32_16x16x32_bf16 v[248:251], v[108:111], v[52:55], v[248:251]
    v_mfma_f32_16x16x32_bf16 v[252:255], v[108:111], v[56:59], v[252:255]
    ds_read_b64_tr_b16 v[108:109], v37 offset:34816
    ds_read_b64_tr_b16 v[110:111], v37 offset:39424
    s_waitcnt lgkmcnt(14)
    v_mfma_f32_16x16x32_bf16 v[112:115], v[76:79], v[60:63], v[112:115]
    v_mfma_f32_16x16x32_bf16 v[116:119], v[76:79], v[64:67], v[116:119]
    v_mfma_f32_16x16x32_bf16 v[120:123], v[76:79], v[68:71], v[120:123]
    v_mfma_f32_16x16x32_bf16 v[124:127], v[76:79], v[72:75], v[124:127]
    v_mfma_f32_16x16x32_bf16 v[128:131], v[80:83], v[60:63], v[128:131]
    v_mfma_f32_16x16x32_bf16 v[132:135], v[80:83], v[64:67], v[132:135]
    v_mfma_f32_16x16x32_bf16 v[136:139], v[80:83], v[68:71], v[136:139]
    v_mfma_f32_16x16x32_bf16 v[140:143], v[80:83], v[72:75], v[140:143]
    s_waitcnt vmcnt(11) lgkmcnt(0)
    s_barrier
    v_mfma_f32_16x16x32_bf16 v[144:147], v[84:87], v[60:63], v[144:147]
    ds_read_b64_tr_b16 v[76:77], v6 offset:0
    ds_read_b64_tr_b16 v[78:79], v6 offset:4608
    v_mfma_f32_16x16x32_bf16 v[148:151], v[84:87], v[64:67], v[148:151]
    v_mfma_f32_16x16x32_bf16 v[152:155], v[84:87], v[68:71], v[152:155]
    ds_read_b64_tr_b16 v[80:81], v6 offset:32
    ds_read_b64_tr_b16 v[82:83], v6 offset:4640
    v_mfma_f32_16x16x32_bf16 v[156:159], v[84:87], v[72:75], v[156:159]
    v_mfma_f32_16x16x32_bf16 v[160:163], v[88:91], v[60:63], v[160:163]
    ds_read_b64_tr_b16 v[44:45], v2 offset:0
    ds_read_b64_tr_b16 v[46:47], v2 offset:8192
    v_mfma_f32_16x16x32_bf16 v[164:167], v[88:91], v[64:67], v[164:167]
    v_mfma_f32_16x16x32_bf16 v[168:171], v[88:91], v[68:71], v[168:171]
    ds_read_b64_tr_b16 v[48:49], v3 offset:0
    ds_read_b64_tr_b16 v[50:51], v3 offset:8192
    v_mfma_f32_16x16x32_bf16 v[172:175], v[88:91], v[72:75], v[172:175]
    v_mfma_f32_16x16x32_bf16 v[176:179], v[92:95], v[60:63], v[176:179]
    ds_read_b64_tr_b16 v[52:53], v4 offset:0
    ds_read_b64_tr_b16 v[54:55], v4 offset:8192
    v_mfma_f32_16x16x32_bf16 v[180:183], v[92:95], v[64:67], v[180:183]
    v_mfma_f32_16x16x32_bf16 v[184:187], v[92:95], v[68:71], v[184:187]
    ds_read_b64_tr_b16 v[56:57], v5 offset:0
    ds_read_b64_tr_b16 v[58:59], v5 offset:8192
    v_mfma_f32_16x16x32_bf16 v[188:191], v[92:95], v[72:75], v[188:191]
    v_mfma_f32_16x16x32_bf16 v[192:195], v[96:99], v[60:63], v[192:195]
    ds_read_b64_tr_b16 v[84:85], v6 offset:64
    ds_read_b64_tr_b16 v[86:87], v6 offset:4672
    v_mfma_f32_16x16x32_bf16 v[196:199], v[96:99], v[64:67], v[196:199]
    ds_read_b64_tr_b16 v[88:89], v6 offset:96
    ds_read_b64_tr_b16 v[90:91], v6 offset:4704
    v_mfma_f32_16x16x32_bf16 v[200:203], v[96:99], v[68:71], v[200:203]
    ds_read_b64_tr_b16 v[92:93], v6 offset:9216
    ds_read_b64_tr_b16 v[94:95], v6 offset:13824
    v_mfma_f32_16x16x32_bf16 v[204:207], v[96:99], v[72:75], v[204:207]
    v_mfma_f32_16x16x32_bf16 v[208:211], v[100:103], v[60:63], v[208:211]
    ds_read_b64_tr_b16 v[96:97], v6 offset:9248
    ds_read_b64_tr_b16 v[98:99], v6 offset:13856
    v_mfma_f32_16x16x32_bf16 v[212:215], v[100:103], v[64:67], v[212:215]
    v_mfma_f32_16x16x32_bf16 v[216:219], v[100:103], v[68:71], v[216:219]
    v_mfma_f32_16x16x32_bf16 v[220:223], v[100:103], v[72:75], v[220:223]
    v_mfma_f32_16x16x32_bf16 v[224:227], v[104:107], v[60:63], v[224:227]
    ds_read_b64_tr_b16 v[100:101], v6 offset:9280
    ds_read_b64_tr_b16 v[102:103], v6 offset:13888
    v_mfma_f32_16x16x32_bf16 v[228:231], v[104:107], v[64:67], v[228:231]
    v_mfma_f32_16x16x32_bf16 v[232:235], v[104:107], v[68:71], v[232:235]
    v_mfma_f32_16x16x32_bf16 v[236:239], v[104:107], v[72:75], v[236:239]
    v_mfma_f32_16x16x32_bf16 v[240:243], v[108:111], v[60:63], v[240:243]
    ds_read_b64_tr_b16 v[104:105], v6 offset:9312
    ds_read_b64_tr_b16 v[106:107], v6 offset:13920
    v_mfma_f32_16x16x32_bf16 v[244:247], v[108:111], v[64:67], v[244:247]
    v_mfma_f32_16x16x32_bf16 v[248:251], v[108:111], v[68:71], v[248:251]
    v_mfma_f32_16x16x32_bf16 v[252:255], v[108:111], v[72:75], v[252:255]
    ds_read_b64_tr_b16 v[108:109], v7 offset:0
    ds_read_b64_tr_b16 v[110:111], v7 offset:4608
    s_waitcnt lgkmcnt(14)
    v_mfma_f32_16x16x32_bf16 v[112:115], v[76:79], v[44:47], v[112:115]
    v_mfma_f32_16x16x32_bf16 v[116:119], v[76:79], v[48:51], v[116:119]
    v_mfma_f32_16x16x32_bf16 v[120:123], v[76:79], v[52:55], v[120:123]
    v_mfma_f32_16x16x32_bf16 v[124:127], v[76:79], v[56:59], v[124:127]
    v_mfma_f32_16x16x32_bf16 v[128:131], v[80:83], v[44:47], v[128:131]
    v_mfma_f32_16x16x32_bf16 v[132:135], v[80:83], v[48:51], v[132:135]
    v_mfma_f32_16x16x32_bf16 v[136:139], v[80:83], v[52:55], v[136:139]
    v_mfma_f32_16x16x32_bf16 v[140:143], v[80:83], v[56:59], v[140:143]
    s_waitcnt vmcnt(6) lgkmcnt(0)
    s_barrier
    v_mfma_f32_16x16x32_bf16 v[144:147], v[84:87], v[44:47], v[144:147]
    ds_read_b64_tr_b16 v[76:77], v6 offset:34816
    ds_read_b64_tr_b16 v[78:79], v6 offset:39424
    s_and_b32 s46, s2, 7
    s_lshr_b32 s47, s2, 3
    s_lshr_b32 s44, s46, 1
    v_mfma_f32_16x16x32_bf16 v[148:151], v[84:87], v[48:51], v[148:151]
    s_lshr_b32 s45, s47, 3
    s_mul_i32 s44, s44, 1327104
    s_mul_i32 s45, s45, 9216
    v_mfma_f32_16x16x32_bf16 v[152:155], v[84:87], v[52:55], v[152:155]
    ds_read_b64_tr_b16 v[80:81], v6 offset:34848
    ds_read_b64_tr_b16 v[82:83], v6 offset:39456
    s_add_u32 s44, s44, s45
    s_add_u32 s45, s7, 0
    s_mul_i32 s46, s45, 57
    v_mfma_f32_16x16x32_bf16 v[156:159], v[84:87], v[56:59], v[156:159]
    s_lshr_b32 s46, s46, 9
    s_mul_i32 s46, s46, 27648
    s_lshl_b32 s45, s45, 10
    v_mfma_f32_16x16x32_bf16 v[160:163], v[88:91], v[44:47], v[160:163]
    ds_read_b64_tr_b16 v[60:61], v2 offset:34816
    ds_read_b64_tr_b16 v[62:63], v2 offset:43008
    s_add_u32 s46, s46, s45
    s_add_u32 s48, s46, s44
    s_add_u32 s45, s7, 8
    v_mfma_f32_16x16x32_bf16 v[164:167], v[88:91], v[48:51], v[164:167]
    s_mul_i32 s46, s45, 57
    s_lshr_b32 s46, s46, 9
    s_mul_i32 s46, s46, 27648
    v_mfma_f32_16x16x32_bf16 v[168:171], v[88:91], v[52:55], v[168:171]
    ds_read_b64_tr_b16 v[64:65], v3 offset:34816
    ds_read_b64_tr_b16 v[66:67], v3 offset:43008
    s_lshl_b32 s45, s45, 10
    s_add_u32 s46, s46, s45
    s_add_u32 s49, s46, s44
    v_mfma_f32_16x16x32_bf16 v[172:175], v[88:91], v[56:59], v[172:175]
    s_add_u32 s45, s7, 16
    s_mul_i32 s46, s45, 57
    s_lshr_b32 s46, s46, 9
    v_mfma_f32_16x16x32_bf16 v[176:179], v[92:95], v[44:47], v[176:179]
    ds_read_b64_tr_b16 v[68:69], v4 offset:34816
    ds_read_b64_tr_b16 v[70:71], v4 offset:43008
    s_mul_i32 s46, s46, 27648
    s_lshl_b32 s45, s45, 10
    s_add_u32 s46, s46, s45
    v_mfma_f32_16x16x32_bf16 v[180:183], v[92:95], v[48:51], v[180:183]
    s_add_u32 s50, s46, s44
    s_add_u32 s45, s7, 24
    s_mul_i32 s46, s45, 57
    v_mfma_f32_16x16x32_bf16 v[184:187], v[92:95], v[52:55], v[184:187]
    ds_read_b64_tr_b16 v[72:73], v5 offset:34816
    ds_read_b64_tr_b16 v[74:75], v5 offset:43008
    s_lshr_b32 s46, s46, 9
    s_mul_i32 s46, s46, 27648
    s_lshl_b32 s45, s45, 10
    v_mfma_f32_16x16x32_bf16 v[188:191], v[92:95], v[56:59], v[188:191]
    s_add_u32 s46, s46, s45
    s_add_u32 s51, s46, s44
    s_lshr_b32 s45, s7, 1
    v_mfma_f32_16x16x32_bf16 v[192:195], v[96:99], v[44:47], v[192:195]
    ds_read_b64_tr_b16 v[84:85], v6 offset:34880
    ds_read_b64_tr_b16 v[86:87], v6 offset:39488
    s_add_u32 s45, s45, 32
    s_mul_i32 s46, s45, 57
    s_lshr_b32 s46, s46, 9
    v_mfma_f32_16x16x32_bf16 v[196:199], v[96:99], v[48:51], v[196:199]
    ds_read_b64_tr_b16 v[88:89], v6 offset:34912
    ds_read_b64_tr_b16 v[90:91], v6 offset:39520
    s_mul_i32 s46, s46, 27648
    s_lshl_b32 s45, s45, 10
    s_add_u32 s46, s46, s45
    v_mfma_f32_16x16x32_bf16 v[200:203], v[96:99], v[52:55], v[200:203]
    ds_read_b64_tr_b16 v[92:93], v6 offset:44032
    ds_read_b64_tr_b16 v[94:95], v6 offset:48640
    s_add_u32 s52, s46, s44
    s_and_b32 s46, s7, 1
    s_lshl_b32 s46, s46, 9
    v_mfma_f32_16x16x32_bf16 v[204:207], v[96:99], v[56:59], v[204:207]
    s_add_u32 s52, s52, s46
    s_lshl_b32 s53, s7, 10
    s_lshl_b32 s54, s7, 9
    v_mfma_f32_16x16x32_bf16 v[208:211], v[100:103], v[44:47], v[208:211]
    ds_read_b64_tr_b16 v[96:97], v6 offset:44064
    ds_read_b64_tr_b16 v[98:99], v6 offset:48672
    s_add_u32 s54, s54, 32768
    s_add_u32 s12, s8, 0x3400000
    s_addc_u32 s13, s9, 0
    v_mfma_f32_16x16x32_bf16 v[212:215], v[100:103], v[48:51], v[212:215]
    s_mov_b32 s14, 0x510000
    s_mov_b32 s15, 0x00020000
    v_lshlrev_b32 v0, 4, v1
    v_mfma_f32_16x16x32_bf16 v[216:219], v[100:103], v[52:55], v[216:219]
    v_mfma_f32_16x16x32_bf16 v[220:223], v[100:103], v[56:59], v[220:223]
    v_mfma_f32_16x16x32_bf16 v[224:227], v[104:107], v[44:47], v[224:227]
    ds_read_b64_tr_b16 v[100:101], v6 offset:44096
    ds_read_b64_tr_b16 v[102:103], v6 offset:48704
    v_mfma_f32_16x16x32_bf16 v[228:231], v[104:107], v[48:51], v[228:231]
    v_mfma_f32_16x16x32_bf16 v[232:235], v[104:107], v[52:55], v[232:235]
    v_mfma_f32_16x16x32_bf16 v[236:239], v[104:107], v[56:59], v[236:239]
    v_mfma_f32_16x16x32_bf16 v[240:243], v[108:111], v[44:47], v[240:243]
    ds_read_b64_tr_b16 v[104:105], v6 offset:44128
    ds_read_b64_tr_b16 v[106:107], v6 offset:48736
    v_mfma_f32_16x16x32_bf16 v[244:247], v[108:111], v[48:51], v[244:247]
    v_mfma_f32_16x16x32_bf16 v[248:251], v[108:111], v[52:55], v[248:251]
    v_mfma_f32_16x16x32_bf16 v[252:255], v[108:111], v[56:59], v[252:255]
    ds_read_b64_tr_b16 v[108:109], v7 offset:34816
    ds_read_b64_tr_b16 v[110:111], v7 offset:39424
    s_waitcnt lgkmcnt(14)
    v_mfma_f32_16x16x32_bf16 v[112:115], v[76:79], v[60:63], v[112:115]
    v_mfma_f32_16x16x32_bf16 v[116:119], v[76:79], v[64:67], v[116:119]
    v_mfma_f32_16x16x32_bf16 v[120:123], v[76:79], v[68:71], v[120:123]
    v_mfma_f32_16x16x32_bf16 v[124:127], v[76:79], v[72:75], v[124:127]
    v_mfma_f32_16x16x32_bf16 v[128:131], v[80:83], v[60:63], v[128:131]
    v_mfma_f32_16x16x32_bf16 v[132:135], v[80:83], v[64:67], v[132:135]
    v_mfma_f32_16x16x32_bf16 v[136:139], v[80:83], v[68:71], v[136:139]
    v_mfma_f32_16x16x32_bf16 v[140:143], v[80:83], v[72:75], v[140:143]
    s_waitcnt lgkmcnt(0)
    s_barrier
    v_mfma_f32_16x16x32_bf16 v[144:147], v[84:87], v[60:63], v[144:147]
    buffer_load_dwordx4 v[44:47], v40, s[36:39], s60 offen offset:0
    v_mfma_f32_16x16x32_bf16 v[148:151], v[84:87], v[64:67], v[148:151]
    buffer_load_dwordx4 v[48:51], v40, s[36:39], s61 offen offset:0
    v_mfma_f32_16x16x32_bf16 v[152:155], v[84:87], v[68:71], v[152:155]
    buffer_load_dwordx4 v[52:55], v40, s[36:39], s62 offen offset:0
    v_mfma_f32_16x16x32_bf16 v[156:159], v[84:87], v[72:75], v[156:159]
    buffer_load_dwordx4 v[56:59], v40, s[36:39], s63 offen offset:0
    v_mfma_f32_16x16x32_bf16 v[160:163], v[88:91], v[60:63], v[160:163]
    v_mfma_f32_16x16x32_bf16 v[164:167], v[88:91], v[64:67], v[164:167]
    v_mfma_f32_16x16x32_bf16 v[168:171], v[88:91], v[68:71], v[168:171]
    v_mfma_f32_16x16x32_bf16 v[172:175], v[88:91], v[72:75], v[172:175]
    v_mfma_f32_16x16x32_bf16 v[176:179], v[92:95], v[60:63], v[176:179]
    buffer_load_dwordx4 v[76:79], v40, s[36:39], s60 offen offset:64
    v_mfma_f32_16x16x32_bf16 v[180:183], v[92:95], v[64:67], v[180:183]
    buffer_load_dwordx4 v[80:83], v40, s[36:39], s61 offen offset:64
    v_mfma_f32_16x16x32_bf16 v[184:187], v[92:95], v[68:71], v[184:187]
    buffer_load_dwordx4 v[84:87], v40, s[36:39], s62 offen offset:64
    v_mfma_f32_16x16x32_bf16 v[188:191], v[92:95], v[72:75], v[188:191]
    buffer_load_dwordx4 v[88:91], v40, s[36:39], s63 offen offset:64
    v_mfma_f32_16x16x32_bf16 v[192:195], v[96:99], v[60:63], v[192:195]
    v_mfma_f32_16x16x32_bf16 v[196:199], v[96:99], v[64:67], v[196:199]
    v_mfma_f32_16x16x32_bf16 v[200:203], v[96:99], v[68:71], v[200:203]
    v_mfma_f32_16x16x32_bf16 v[204:207], v[96:99], v[72:75], v[204:207]
    v_mfma_f32_16x16x32_bf16 v[208:211], v[100:103], v[60:63], v[208:211]
    v_mfma_f32_16x16x32_bf16 v[212:215], v[100:103], v[64:67], v[212:215]
    v_mfma_f32_16x16x32_bf16 v[216:219], v[100:103], v[68:71], v[216:219]
    v_mfma_f32_16x16x32_bf16 v[220:223], v[100:103], v[72:75], v[220:223]
    v_mfma_f32_16x16x32_bf16 v[224:227], v[104:107], v[60:63], v[224:227]
    v_mfma_f32_16x16x32_bf16 v[228:231], v[104:107], v[64:67], v[228:231]
    v_mfma_f32_16x16x32_bf16 v[232:235], v[104:107], v[68:71], v[232:235]
    v_mfma_f32_16x16x32_bf16 v[236:239], v[104:107], v[72:75], v[236:239]
    v_mfma_f32_16x16x32_bf16 v[240:243], v[108:111], v[60:63], v[240:243]
    buffer_load_dwordx4 v[92:95], v40, s[36:39], s60 offen offset:128
    buffer_load_dwordx4 v[96:99], v40, s[36:39], s61 offen offset:128
    v_mfma_f32_16x16x32_bf16 v[244:247], v[108:111], v[64:67], v[244:247]
    buffer_load_dwordx4 v[100:103], v40, s[36:39], s62 offen offset:128
    buffer_load_dwordx4 v[104:107], v40, s[36:39], s63 offen offset:128
    v_mfma_f32_16x16x32_bf16 v[248:251], v[108:111], v[68:71], v[248:251]
    v_mfma_f32_16x16x32_bf16 v[252:255], v[108:111], v[72:75], v[252:255]
    buffer_load_dwordx4 v[60:63], v40, s[36:39], s60 offen offset:192
    buffer_load_dwordx4 v[64:67], v40, s[36:39], s61 offen offset:192
    buffer_load_dwordx4 v[68:71], v40, s[36:39], s62 offen offset:192
    buffer_load_dwordx4 v[72:75], v40, s[36:39], s63 offen offset:192
    s_mov_b32 s57, 0
    s_waitcnt vmcnt(16)
G1_SPIN:
    v_min_f32 v24, v12, v14
    v_min_f32 v25, v16, v18
    v_min_f32 v24, v24, v25
    v_min_f32 v25, v20, v22
    v_min_f32 v24, v24, v25
    v_cmp_lt_f32 vcc, 0, v24
    s_nop 0
    s_cmp_eq_u64 vcc, -1
    s_cbranch_scc1 G1_SOK
    buffer_load_dwordx2 v[12:13], v38, s[32:35], 0 offen offset:0 sc0 sc1
    buffer_load_dwordx2 v[14:15], v38, s[32:35], 0 offen offset:128 sc0 sc1
    buffer_load_dwordx2 v[16:17], v38, s[32:35], 0 offen offset:256 sc0 sc1
    buffer_load_dwordx2 v[18:19], v38, s[32:35], 0 offen offset:384 sc0 sc1
    buffer_load_dwordx2 v[20:21], v39, s[32:35], 0 offen offset:0 sc0 sc1
    buffer_load_dwordx2 v[22:23], v39, s[32:35], 0 offen offset:256 sc0 sc1
    s_waitcnt vmcnt(0)
    s_add_u32 s57, s57, 1
    s_cmp_lt_u32 s57, 20000
    s_nop 0
    s_cbranch_scc1 G1_SPIN
G1_SOK:
    v_mov_b32 v24, v13
    v_mul_f32 v12, 0xbfb8aa3b, v12
    v_mov_b32 v26, v15
    v_mul_f32 v14, 0xbfb8aa3b, v14
    v_mov_b32 v28, v17
    v_mul_f32 v16, 0xbfb8aa3b, v16
    v_mov_b32 v30, v19
    v_mul_f32 v18, 0xbfb8aa3b, v18
    v_mov_b32 v32, v21
    v_mul_f32 v20, 0xbfb8aa3b, v20
    v_mov_b32 v34, v23
    v_mul_f32 v22, 0xbfb8aa3b, v22
    v_mov_b32 v36, 0x40053526
    v_mov_b32 v37, 0x40053526
    s_lshl_b32 s22, s5, 4
    s_lshl_b32 s23, s20, 2
    s_add_u32 s22, s22, s23
    s_mul_i32 s22, s22, 147456
    s_and_b32 s58, s6, 1
    s_lshl_b32 s55, s58, 1
    s_add_u32 s55, s55, s21
    s_lshr_b32 s23, s6, 1
    s_mul_i32 s23, s23, 9
    s_add_u32 s56, s23, 8
    s_lshl_b32 s58, s55, 1
    s_add_u32 s23, s23, s58
    s_lshl_b32 s23, s23, 10
    s_add_u32 s23, s23, s22
    s_lshl_b32 s56, s56, 10
    s_add_u32 s56, s56, s22
    s_lshl_b32 s55, s55, 8
    s_add_u32 s56, s56, s55
    v_lshrrev_b32 v39, 4, v1
    v_and_b32 v38, 1, v39
    v_lshlrev_b32 v38, 1, v38
    v_lshrrev_b32 v39, 1, v39
    v_add_u32 v39, v38, v39
    v_mul_u32_u24 v39, 147456, v39
    v_and_b32 v38, 15, v1
    v_lshlrev_b32 v38, 4, v38
    v_add_u32 v38, v38, v39
    s_waitcnt vmcnt(8)
    s_add_u32 s59, s23, 0
    v_pk_fma_f32 v[2:3], v[24:25], v[44:45], v[48:49] op_sel:[0,0,0] op_sel_hi:[0,1,1]
    v_pk_fma_f32 v[4:5], v[24:25], v[52:53], v[56:57] op_sel:[0,0,0] op_sel_hi:[0,1,1]
    v_pk_fma_f32 v[2:3], v[112:113], v[12:13], v[2:3] op_sel:[0,0,0] op_sel_hi:[1,0,1]
    v_pk_fma_f32 v[4:5], v[176:177], v[12:13], v[4:5] op_sel:[0,0,0] op_sel_hi:[1,0,1]
    v_exp_f32 v10, v2
    v_exp_f32 v11, v3
    v_pk_mul_f32 v[4:5], v[2:3], v[4:5]
    v_pk_fma_f32 v[10:11], v[10:11], v[36:37], v[36:37]
    v_rcp_f32 v10, v10
    v_rcp_f32 v11, v11
    s_nop 0
    v_pk_mul_f32 v[4:5], v[4:5], v[10:11]
    v_cvt_pk_bf16_f32 v108, v4, v5
    v_pk_fma_f32 v[6:7], v[24:25], v[46:47], v[50:51] op_sel:[0,0,0] op_sel_hi:[0,1,1]
    v_pk_fma_f32 v[8:9], v[24:25], v[54:55], v[58:59] op_sel:[0,0,0] op_sel_hi:[0,1,1]
    v_pk_fma_f32 v[6:7], v[114:115], v[12:13], v[6:7] op_sel:[0,0,0] op_sel_hi:[1,0,1]
    v_pk_fma_f32 v[8:9], v[178:179], v[12:13], v[8:9] op_sel:[0,0,0] op_sel_hi:[1,0,1]
    v_exp_f32 v42, v6
    v_exp_f32 v43, v7
    v_pk_mul_f32 v[8:9], v[6:7], v[8:9]
    v_pk_fma_f32 v[42:43], v[42:43], v[36:37], v[36:37]
    v_rcp_f32 v42, v42
    v_rcp_f32 v43, v43
    s_nop 0
    v_pk_mul_f32 v[8:9], v[8:9], v[42:43]
    v_cvt_pk_bf16_f32 v109, v8, v9
    v_pk_fma_f32 v[2:3], v[24:25], v[76:77], v[80:81] op_sel:[0,0,0] op_sel_hi:[0,1,1]
    v_pk_fma_f32 v[4:5], v[24:25], v[84:85], v[88:89] op_sel:[0,0,0] op_sel_hi:[0,1,1]
    v_pk_fma_f32 v[2:3], v[128:129], v[12:13], v[2:3] op_sel:[0,0,0] op_sel_hi:[1,0,1]
    v_pk_fma_f32 v[4:5], v[192:193], v[12:13], v[4:5] op_sel:[0,0,0] op_sel_hi:[1,0,1]
    v_exp_f32 v10, v2
    v_exp_f32 v11, v3
    v_pk_mul_f32 v[4:5], v[2:3], v[4:5]
    v_pk_fma_f32 v[10:11], v[10:11], v[36:37], v[36:37]
    v_rcp_f32 v10, v10
    v_rcp_f32 v11, v11
    s_nop 0
    v_pk_mul_f32 v[4:5], v[4:5], v[10:11]
    v_cvt_pk_bf16_f32 v110, v4, v5
    v_pk_fma_f32 v[6:7], v[24:25], v[78:79], v[82:83] op_sel:[0,0,0] op_sel_hi:[0,1,1]
    v_pk_fma_f32 v[8:9], v[24:25], v[86:87], v[90:91] op_sel:[0,0,0] op_sel_hi:[0,1,1]
    v_pk_fma_f32 v[6:7], v[130:131], v[12:13], v[6:7] op_sel:[0,0,0] op_sel_hi:[1,0,1]
    v_pk_fma_f32 v[8:9], v[194:195], v[12:13], v[8:9] op_sel:[0,0,0] op_sel_hi:[1,0,1]
    v_exp_f32 v42, v6
    v_exp_f32 v43, v7
    v_pk_mul_f32 v[8:9], v[6:7], v[8:9]
    v_pk_fma_f32 v[42:43], v[42:43], v[36:37], v[36:37]
    v_rcp_f32 v42, v42
    v_rcp_f32 v43, v43
    s_nop 0
    v_pk_mul_f32 v[8:9], v[8:9], v[42:43]
    v_cvt_pk_bf16_f32 v111, v8, v9
    buffer_load_dwordx4 v[112:115], v41, s[36:39], s60 offen
    buffer_load_dwordx4 v[128:131], v41, s[36:39], s61 offen
    buffer_load_dwordx4 v[176:179], v41, s[36:39], s62 offen
    buffer_load_dwordx4 v[192:195], v41, s[36:39], s63 offen
    buffer_store_dwordx4 v[108:111], v0, s[40:43], s59 offen sc0 sc1
    s_add_u32 s59, s59, 147456
    v_pk_fma_f32 v[2:3], v[26:27], v[44:45], v[48:49] op_sel:[0,0,0] op_sel_hi:[0,1,1]
    v_pk_fma_f32 v[4:5], v[26:27], v[52:53], v[56:57] op_sel:[0,0,0] op_sel_hi:[0,1,1]
    v_pk_fma_f32 v[2:3], v[116:117], v[14:15], v[2:3] op_sel:[0,0,0] op_sel_hi:[1,0,1]
    v_pk_fma_f32 v[4:5], v[180:181], v[14:15], v[4:5] op_sel:[0,0,0] op_sel_hi:[1,0,1]
    v_exp_f32 v10, v2
    v_exp_f32 v11, v3
    v_pk_mul_f32 v[4:5], v[2:3], v[4:5]
    v_pk_fma_f32 v[10:11], v[10:11], v[36:37], v[36:37]
    v_rcp_f32 v10, v10
    v_rcp_f32 v11, v11
    s_nop 0
    v_pk_mul_f32 v[4:5], v[4:5], v[10:11]
    v_cvt_pk_bf16_f32 v108, v4, v5
    v_pk_fma_f32 v[6:7], v[26:27], v[46:47], v[50:51] op_sel:[0,0,0] op_sel_hi:[0,1,1]
    v_pk_fma_f32 v[8:9], v[26:27], v[54:55], v[58:59] op_sel:[0,0,0] op_sel_hi:[0,1,1]
    v_pk_fma_f32 v[6:7], v[118:119], v[14:15], v[6:7] op_sel:[0,0,0] op_sel_hi:[1,0,1]
    v_pk_fma_f32 v[8:9], v[182:183], v[14:15], v[8:9] op_sel:[0,0,0] op_sel_hi:[1,0,1]
    v_exp_f32 v42, v6
    v_exp_f32 v43, v7
    v_pk_mul_f32 v[8:9], v[6:7], v[8:9]
    v_pk_fma_f32 v[42:43], v[42:43], v[36:37], v[36:37]
    v_rcp_f32 v42, v42
    v_rcp_f32 v43, v43
    s_nop 0
    v_pk_mul_f32 v[8:9], v[8:9], v[42:43]
    v_cvt_pk_bf16_f32 v109, v8, v9
    v_pk_fma_f32 v[2:3], v[26:27], v[76:77], v[80:81] op_sel:[0,0,0] op_sel_hi:[0,1,1]
    v_pk_fma_f32 v[4:5], v[26:27], v[84:85], v[88:89] op_sel:[0,0,0] op_sel_hi:[0,1,1]
    v_pk_fma_f32 v[2:3], v[132:133], v[14:15], v[2:3] op_sel:[0,0,0] op_sel_hi:[1,0,1]
    v_pk_fma_f32 v[4:5], v[196:197], v[14:15], v[4:5] op_sel:[0,0,0] op_sel_hi:[1,0,1]
    v_exp_f32 v10, v2
    v_exp_f32 v11, v3
    v_pk_mul_f32 v[4:5], v[2:3], v[4:5]
    v_pk_fma_f32 v[10:11], v[10:11], v[36:37], v[36:37]
    v_rcp_f32 v10, v10
    v_rcp_f32 v11, v11
    s_nop 0
    v_pk_mul_f32 v[4:5], v[4:5], v[10:11]
    v_cvt_pk_bf16_f32 v110, v4, v5
    v_pk_fma_f32 v[6:7], v[26:27], v[78:79], v[82:83] op_sel:[0,0,0] op_sel_hi:[0,1,1]
    v_pk_fma_f32 v[8:9], v[26:27], v[86:87], v[90:91] op_sel:[0,0,0] op_sel_hi:[0,1,1]
    v_pk_fma_f32 v[6:7], v[134:135], v[14:15], v[6:7] op_sel:[0,0,0] op_sel_hi:[1,0,1]
    v_pk_fma_f32 v[8:9], v[198:199], v[14:15], v[8:9] op_sel:[0,0,0] op_sel_hi:[1,0,1]
    v_exp_f32 v42, v6
    v_exp_f32 v43, v7
    v_pk_mul_f32 v[8:9], v[6:7], v[8:9]
    v_pk_fma_f32 v[42:43], v[42:43], v[36:37], v[36:37]
    v_rcp_f32 v42, v42
    v_rcp_f32 v43, v43
    s_nop 0
    v_pk_mul_f32 v[8:9], v[8:9], v[42:43]
    v_cvt_pk_bf16_f32 v111, v8, v9
    buffer_store_dwordx4 v[108:111], v0, s[40:43], s59 offen sc0 sc1
    s_add_u32 s59, s59, 147456
    v_pk_fma_f32 v[2:3], v[28:29], v[44:45], v[48:49] op_sel:[0,0,0] op_sel_hi:[0,1,1]
    v_pk_fma_f32 v[4:5], v[28:29], v[52:53], v[56:57] op_sel:[0,0,0] op_sel_hi:[0,1,1]
    v_pk_fma_f32 v[2:3], v[120:121], v[16:17], v[2:3] op_sel:[0,0,0] op_sel_hi:[1,0,1]
    v_pk_fma_f32 v[4:5], v[184:185], v[16:17], v[4:5] op_sel:[0,0,0] op_sel_hi:[1,0,1]
    v_exp_f32 v10, v2
    v_exp_f32 v11, v3
    v_pk_mul_f32 v[4:5], v[2:3], v[4:5]
    v_pk_fma_f32 v[10:11], v[10:11], v[36:37], v[36:37]
    v_rcp_f32 v10, v10
    v_rcp_f32 v11, v11
    s_nop 0
    v_pk_mul_f32 v[4:5], v[4:5], v[10:11]
    v_cvt_pk_bf16_f32 v108, v4, v5
    v_pk_fma_f32 v[6:7], v[28:29], v[46:47], v[50:51] op_sel:[0,0,0] op_sel_hi:[0,1,1]
    v_pk_fma_f32 v[8:9], v[28:29], v[54:55], v[58:59] op_sel:[0,0,0] op_sel_hi:[0,1,1]
    v_pk_fma_f32 v[6:7], v[122:123], v[16:17], v[6:7] op_sel:[0,0,0] op_sel_hi:[1,0,1]
    v_pk_fma_f32 v[8:9], v[186:187], v[16:17], v[8:9] op_sel:[0,0,0] op_sel_hi:[1,0,1]
    v_exp_f32 v42, v6
    v_exp_f32 v43, v7
    v_pk_mul_f32 v[8:9], v[6:7], v[8:9]
    v_pk_fma_f32 v[42:43], v[42:43], v[36:37], v[36:37]
    v_rcp_f32 v42, v42
    v_rcp_f32 v43, v43
    s_nop 0
    v_pk_mul_f32 v[8:9], v[8:9], v[42:43]
    v_cvt_pk_bf16_f32 v109, v8, v9
    v_pk_fma_f32 v[2:3], v[28:29], v[76:77], v[80:81] op_sel:[0,0,0] op_sel_hi:[0,1,1]
    v_pk_fma_f32 v[4:5], v[28:29], v[84:85], v[88:89] op_sel:[0,0,0] op_sel_hi:[0,1,1]
    v_pk_fma_f32 v[2:3], v[136:137], v[16:17], v[2:3] op_sel:[0,0,0] op_sel_hi:[1,0,1]
    v_pk_fma_f32 v[4:5], v[200:201], v[16:17], v[4:5] op_sel:[0,0,0] op_sel_hi:[1,0,1]
    v_exp_f32 v10, v2
    v_exp_f32 v11, v3
    v_pk_mul_f32 v[4:5], v[2:3], v[4:5]
    v_pk_fma_f32 v[10:11], v[10:11], v[36:37], v[36:37]
    v_rcp_f32 v10, v10
    v_rcp_f32 v11, v11
    s_nop 0
    v_pk_mul_f32 v[4:5], v[4:5], v[10:11]
    v_cvt_pk_bf16_f32 v110, v4, v5
    v_pk_fma_f32 v[6:7], v[28:29], v[78:79], v[82:83] op_sel:[0,0,0] op_sel_hi:[0,1,1]
    v_pk_fma_f32 v[8:9], v[28:29], v[86:87], v[90:91] op_sel:[0,0,0] op_sel_hi:[0,1,1]
    v_pk_fma_f32 v[6:7], v[138:139], v[16:17], v[6:7] op_sel:[0,0,0] op_sel_hi:[1,0,1]
    v_pk_fma_f32 v[8:9], v[202:203], v[16:17], v[8:9] op_sel:[0,0,0] op_sel_hi:[1,0,1]
    v_exp_f32 v42, v6
    v_exp_f32 v43, v7
    v_pk_mul_f32 v[8:9], v[6:7], v[8:9]
    v_pk_fma_f32 v[42:43], v[42:43], v[36:37], v[36:37]
    v_rcp_f32 v42, v42
    v_rcp_f32 v43, v43
    s_nop 0
    v_pk_mul_f32 v[8:9], v[8:9], v[42:43]
    v_cvt_pk_bf16_f32 v111, v8, v9
    buffer_store_dwordx4 v[108:111], v0, s[40:43], s59 offen sc0 sc1
    s_add_u32 s59, s59, 147456
    v_pk_fma_f32 v[2:3], v[30:31], v[44:45], v[48:49] op_sel:[0,0,0] op_sel_hi:[0,1,1]
    v_pk_fma_f32 v[4:5], v[30:31], v[52:53], v[56:57] op_sel:[0,0,0] op_sel_hi:[0,1,1]
    v_pk_fma_f32 v[2:3], v[124:125], v[18:19], v[2:3] op_sel:[0,0,0] op_sel_hi:[1,0,1]
    v_pk_fma_f32 v[4:5], v[188:189], v[18:19], v[4:5] op_sel:[0,0,0] op_sel_hi:[1,0,1]
    v_exp_f32 v10, v2
    v_exp_f32 v11, v3
    v_pk_mul_f32 v[4:5], v[2:3], v[4:5]
    v_pk_fma_f32 v[10:11], v[10:11], v[36:37], v[36:37]
    v_rcp_f32 v10, v10
    v_rcp_f32 v11, v11
    s_nop 0
    v_pk_mul_f32 v[4:5], v[4:5], v[10:11]
    v_cvt_pk_bf16_f32 v108, v4, v5
    v_pk_fma_f32 v[6:7], v[30:31], v[46:47], v[50:51] op_sel:[0,0,0] op_sel_hi:[0,1,1]
    v_pk_fma_f32 v[8:9], v[30:31], v[54:55], v[58:59] op_sel:[0,0,0] op_sel_hi:[0,1,1]
    v_pk_fma_f32 v[6:7], v[126:127], v[18:19], v[6:7] op_sel:[0,0,0] op_sel_hi:[1,0,1]
    v_pk_fma_f32 v[8:9], v[190:191], v[18:19], v[8:9] op_sel:[0,0,0] op_sel_hi:[1,0,1]
    v_exp_f32 v42, v6
    v_exp_f32 v43, v7
    v_pk_mul_f32 v[8:9], v[6:7], v[8:9]
    v_pk_fma_f32 v[42:43], v[42:43], v[36:37], v[36:37]
    v_rcp_f32 v42, v42
    v_rcp_f32 v43, v43
    s_nop 0
    v_pk_mul_f32 v[8:9], v[8:9], v[42:43]
    v_cvt_pk_bf16_f32 v109, v8, v9
    v_pk_fma_f32 v[2:3], v[30:31], v[76:77], v[80:81] op_sel:[0,0,0] op_sel_hi:[0,1,1]
    v_pk_fma_f32 v[4:5], v[30:31], v[84:85], v[88:89] op_sel:[0,0,0] op_sel_hi:[0,1,1]
    v_pk_fma_f32 v[2:3], v[140:141], v[18:19], v[2:3] op_sel:[0,0,0] op_sel_hi:[1,0,1]
    v_pk_fma_f32 v[4:5], v[204:205], v[18:19], v[4:5] op_sel:[0,0,0] op_sel_hi:[1,0,1]
    v_exp_f32 v10, v2
    v_exp_f32 v11, v3
    v_pk_mul_f32 v[4:5], v[2:3], v[4:5]
    v_pk_fma_f32 v[10:11], v[10:11], v[36:37], v[36:37]
    v_rcp_f32 v10, v10
    v_rcp_f32 v11, v11
    s_nop 0
    v_pk_mul_f32 v[4:5], v[4:5], v[10:11]
    v_cvt_pk_bf16_f32 v110, v4, v5
    v_pk_fma_f32 v[6:7], v[30:31], v[78:79], v[82:83] op_sel:[0,0,0] op_sel_hi:[0,1,1]
    v_pk_fma_f32 v[8:9], v[30:31], v[86:87], v[90:91] op_sel:[0,0,0] op_sel_hi:[0,1,1]
    v_pk_fma_f32 v[6:7], v[142:143], v[18:19], v[6:7] op_sel:[0,0,0] op_sel_hi:[1,0,1]
    v_pk_fma_f32 v[8:9], v[206:207], v[18:19], v[8:9] op_sel:[0,0,0] op_sel_hi:[1,0,1]
    v_exp_f32 v42, v6
    v_exp_f32 v43, v7
    v_pk_mul_f32 v[8:9], v[6:7], v[8:9]
    v_pk_fma_f32 v[42:43], v[42:43], v[36:37], v[36:37]
    v_rcp_f32 v42, v42
    v_rcp_f32 v43, v43
    s_nop 0
    v_pk_mul_f32 v[8:9], v[8:9], v[42:43]
    v_cvt_pk_bf16_f32 v111, v8, v9
    buffer_store_dwordx4 v[108:111], v0, s[40:43], s59 offen sc0 sc1
    s_waitcnt vmcnt(8)
    s_add_u32 s59, s23, 1024
    v_pk_fma_f32 v[2:3], v[24:25], v[92:93], v[96:97] op_sel:[0,0,0] op_sel_hi:[0,1,1]
    v_pk_fma_f32 v[4:5], v[24:25], v[100:101], v[104:105] op_sel:[0,0,0] op_sel_hi:[0,1,1]
    v_pk_fma_f32 v[2:3], v[144:145], v[12:13], v[2:3] op_sel:[0,0,0] op_sel_hi:[1,0,1]
    v_pk_fma_f32 v[4:5], v[208:209], v[12:13], v[4:5] op_sel:[0,0,0] op_sel_hi:[1,0,1]
    v_exp_f32 v10, v2
    v_exp_f32 v11, v3
    v_pk_mul_f32 v[4:5], v[2:3], v[4:5]
    v_pk_fma_f32 v[10:11], v[10:11], v[36:37], v[36:37]
    v_rcp_f32 v10, v10
    v_rcp_f32 v11, v11
    s_nop 0
    v_pk_mul_f32 v[4:5], v[4:5], v[10:11]
    v_cvt_pk_bf16_f32 v108, v4, v5
    v_pk_fma_f32 v[6:7], v[24:25], v[94:95], v[98:99] op_sel:[0,0,0] op_sel_hi:[0,1,1]
    v_pk_fma_f32 v[8:9], v[24:25], v[102:103], v[106:107] op_sel:[0,0,0] op_sel_hi:[0,1,1]
    v_pk_fma_f32 v[6:7], v[146:147], v[12:13], v[6:7] op_sel:[0,0,0] op_sel_hi:[1,0,1]
    v_pk_fma_f32 v[8:9], v[210:211], v[12:13], v[8:9] op_sel:[0,0,0] op_sel_hi:[1,0,1]
    v_exp_f32 v42, v6
    v_exp_f32 v43, v7
    v_pk_mul_f32 v[8:9], v[6:7], v[8:9]
    v_pk_fma_f32 v[42:43], v[42:43], v[36:37], v[36:37]
    v_rcp_f32 v42, v42
    v_rcp_f32 v43, v43
    s_nop 0
    v_pk_mul_f32 v[8:9], v[8:9], v[42:43]
    v_cvt_pk_bf16_f32 v109, v8, v9
    v_pk_fma_f32 v[2:3], v[24:25], v[60:61], v[64:65] op_sel:[0,0,0] op_sel_hi:[0,1,1]
    v_pk_fma_f32 v[4:5], v[24:25], v[68:69], v[72:73] op_sel:[0,0,0] op_sel_hi:[0,1,1]
    v_pk_fma_f32 v[2:3], v[160:161], v[12:13], v[2:3] op_sel:[0,0,0] op_sel_hi:[1,0,1]
    v_pk_fma_f32 v[4:5], v[224:225], v[12:13], v[4:5] op_sel:[0,0,0] op_sel_hi:[1,0,1]
    v_exp_f32 v10, v2
    v_exp_f32 v11, v3
    v_pk_mul_f32 v[4:5], v[2:3], v[4:5]
    v_pk_fma_f32 v[10:11], v[10:11], v[36:37], v[36:37]
    v_rcp_f32 v10, v10
    v_rcp_f32 v11, v11
    s_nop 0
    v_pk_mul_f32 v[4:5], v[4:5], v[10:11]
    v_cvt_pk_bf16_f32 v110, v4, v5
    v_pk_fma_f32 v[6:7], v[24:25], v[62:63], v[66:67] op_sel:[0,0,0] op_sel_hi:[0,1,1]
    v_pk_fma_f32 v[8:9], v[24:25], v[70:71], v[74:75] op_sel:[0,0,0] op_sel_hi:[0,1,1]
    v_pk_fma_f32 v[6:7], v[162:163], v[12:13], v[6:7] op_sel:[0,0,0] op_sel_hi:[1,0,1]
    v_pk_fma_f32 v[8:9], v[226:227], v[12:13], v[8:9] op_sel:[0,0,0] op_sel_hi:[1,0,1]
    v_exp_f32 v42, v6
    v_exp_f32 v43, v7
    v_pk_mul_f32 v[8:9], v[6:7], v[8:9]
    v_pk_fma_f32 v[42:43], v[42:43], v[36:37], v[36:37]
    v_rcp_f32 v42, v42
    v_rcp_f32 v43, v43
    s_nop 0
    v_pk_mul_f32 v[8:9], v[8:9], v[42:43]
    v_cvt_pk_bf16_f32 v111, v8, v9
    buffer_store_dwordx4 v[108:111], v0, s[40:43], s59 offen sc0 sc1
    s_add_u32 s59, s59, 147456
    v_pk_fma_f32 v[2:3], v[26:27], v[92:93], v[96:97] op_sel:[0,0,0] op_sel_hi:[0,1,1]
    v_pk_fma_f32 v[4:5], v[26:27], v[100:101], v[104:105] op_sel:[0,0,0] op_sel_hi:[0,1,1]
    v_pk_fma_f32 v[2:3], v[148:149], v[14:15], v[2:3] op_sel:[0,0,0] op_sel_hi:[1,0,1]
    v_pk_fma_f32 v[4:5], v[212:213], v[14:15], v[4:5] op_sel:[0,0,0] op_sel_hi:[1,0,1]
    v_exp_f32 v10, v2
    v_exp_f32 v11, v3
    v_pk_mul_f32 v[4:5], v[2:3], v[4:5]
    v_pk_fma_f32 v[10:11], v[10:11], v[36:37], v[36:37]
    v_rcp_f32 v10, v10
    v_rcp_f32 v11, v11
    s_nop 0
    v_pk_mul_f32 v[4:5], v[4:5], v[10:11]
    v_cvt_pk_bf16_f32 v108, v4, v5
    v_pk_fma_f32 v[6:7], v[26:27], v[94:95], v[98:99] op_sel:[0,0,0] op_sel_hi:[0,1,1]
    v_pk_fma_f32 v[8:9], v[26:27], v[102:103], v[106:107] op_sel:[0,0,0] op_sel_hi:[0,1,1]
    v_pk_fma_f32 v[6:7], v[150:151], v[14:15], v[6:7] op_sel:[0,0,0] op_sel_hi:[1,0,1]
    v_pk_fma_f32 v[8:9], v[214:215], v[14:15], v[8:9] op_sel:[0,0,0] op_sel_hi:[1,0,1]
    v_exp_f32 v42, v6
    v_exp_f32 v43, v7
    v_pk_mul_f32 v[8:9], v[6:7], v[8:9]
    v_pk_fma_f32 v[42:43], v[42:43], v[36:37], v[36:37]
    v_rcp_f32 v42, v42
    v_rcp_f32 v43, v43
    s_nop 0
    v_pk_mul_f32 v[8:9], v[8:9], v[42:43]
    v_cvt_pk_bf16_f32 v109, v8, v9
    v_pk_fma_f32 v[2:3], v[26:27], v[60:61], v[64:65] op_sel:[0,0,0] op_sel_hi:[0,1,1]
    v_pk_fma_f32 v[4:5], v[26:27], v[68:69], v[72:73] op_sel:[0,0,0] op_sel_hi:[0,1,1]
    v_pk_fma_f32 v[2:3], v[164:165], v[14:15], v[2:3] op_sel:[0,0,0] op_sel_hi:[1,0,1]
    v_pk_fma_f32 v[4:5], v[228:229], v[14:15], v[4:5] op_sel:[0,0,0] op_sel_hi:[1,0,1]
    v_exp_f32 v10, v2
    v_exp_f32 v11, v3
    v_pk_mul_f32 v[4:5], v[2:3], v[4:5]
    v_pk_fma_f32 v[10:11], v[10:11], v[36:37], v[36:37]
    v_rcp_f32 v10, v10
    v_rcp_f32 v11, v11
    s_nop 0
    v_pk_mul_f32 v[4:5], v[4:5], v[10:11]
    v_cvt_pk_bf16_f32 v110, v4, v5
    v_pk_fma_f32 v[6:7], v[26:27], v[62:63], v[66:67] op_sel:[0,0,0] op_sel_hi:[0,1,1]
    v_pk_fma_f32 v[8:9], v[26:27], v[70:71], v[74:75] op_sel:[0,0,0] op_sel_hi:[0,1,1]
    v_pk_fma_f32 v[6:7], v[166:167], v[14:15], v[6:7] op_sel:[0,0,0] op_sel_hi:[1,0,1]
    v_pk_fma_f32 v[8:9], v[230:231], v[14:15], v[8:9] op_sel:[0,0,0] op_sel_hi:[1,0,1]
    v_exp_f32 v42, v6
    v_exp_f32 v43, v7
    v_pk_mul_f32 v[8:9], v[6:7], v[8:9]
    v_pk_fma_f32 v[42:43], v[42:43], v[36:37], v[36:37]
    v_rcp_f32 v42, v42
    v_rcp_f32 v43, v43
    s_nop 0
    v_pk_mul_f32 v[8:9], v[8:9], v[42:43]
    v_cvt_pk_bf16_f32 v111, v8, v9
    buffer_store_dwordx4 v[108:111], v0, s[40:43], s59 offen sc0 sc1
    s_add_u32 s59, s59, 147456
    v_pk_fma_f32 v[2:3], v[28:29], v[92:93], v[96:97] op_sel:[0,0,0] op_sel_hi:[0,1,1]
    v_pk_fma_f32 v[4:5], v[28:29], v[100:101], v[104:105] op_sel:[0,0,0] op_sel_hi:[0,1,1]
    v_pk_fma_f32 v[2:3], v[152:153], v[16:17], v[2:3] op_sel:[0,0,0] op_sel_hi:[1,0,1]
    v_pk_fma_f32 v[4:5], v[216:217], v[16:17], v[4:5] op_sel:[0,0,0] op_sel_hi:[1,0,1]
    v_exp_f32 v10, v2
    v_exp_f32 v11, v3
    v_pk_mul_f32 v[4:5], v[2:3], v[4:5]
    v_pk_fma_f32 v[10:11], v[10:11], v[36:37], v[36:37]
    v_rcp_f32 v10, v10
    v_rcp_f32 v11, v11
    s_nop 0
    v_pk_mul_f32 v[4:5], v[4:5], v[10:11]
    v_cvt_pk_bf16_f32 v108, v4, v5
    v_pk_fma_f32 v[6:7], v[28:29], v[94:95], v[98:99] op_sel:[0,0,0] op_sel_hi:[0,1,1]
    v_pk_fma_f32 v[8:9], v[28:29], v[102:103], v[106:107] op_sel:[0,0,0] op_sel_hi:[0,1,1]
    v_pk_fma_f32 v[6:7], v[154:155], v[16:17], v[6:7] op_sel:[0,0,0] op_sel_hi:[1,0,1]
    v_pk_fma_f32 v[8:9], v[218:219], v[16:17], v[8:9] op_sel:[0,0,0] op_sel_hi:[1,0,1]
    v_exp_f32 v42, v6
    v_exp_f32 v43, v7
    v_pk_mul_f32 v[8:9], v[6:7], v[8:9]
    v_pk_fma_f32 v[42:43], v[42:43], v[36:37], v[36:37]
    v_rcp_f32 v42, v42
    v_rcp_f32 v43, v43
    s_nop 0
    v_pk_mul_f32 v[8:9], v[8:9], v[42:43]
    v_cvt_pk_bf16_f32 v109, v8, v9
    v_pk_fma_f32 v[2:3], v[28:29], v[60:61], v[64:65] op_sel:[0,0,0] op_sel_hi:[0,1,1]
    v_pk_fma_f32 v[4:5], v[28:29], v[68:69], v[72:73] op_sel:[0,0,0] op_sel_hi:[0,1,1]
    v_pk_fma_f32 v[2:3], v[168:169], v[16:17], v[2:3] op_sel:[0,0,0] op_sel_hi:[1,0,1]
    v_pk_fma_f32 v[4:5], v[232:233], v[16:17], v[4:5] op_sel:[0,0,0] op_sel_hi:[1,0,1]
    v_exp_f32 v10, v2
    v_exp_f32 v11, v3
    v_pk_mul_f32 v[4:5], v[2:3], v[4:5]
    v_pk_fma_f32 v[10:11], v[10:11], v[36:37], v[36:37]
    v_rcp_f32 v10, v10
    v_rcp_f32 v11, v11
    s_nop 0
    v_pk_mul_f32 v[4:5], v[4:5], v[10:11]
    v_cvt_pk_bf16_f32 v110, v4, v5
    v_pk_fma_f32 v[6:7], v[28:29], v[62:63], v[66:67] op_sel:[0,0,0] op_sel_hi:[0,1,1]
    v_pk_fma_f32 v[8:9], v[28:29], v[70:71], v[74:75] op_sel:[0,0,0] op_sel_hi:[0,1,1]
    v_pk_fma_f32 v[6:7], v[170:171], v[16:17], v[6:7] op_sel:[0,0,0] op_sel_hi:[1,0,1]
    v_pk_fma_f32 v[8:9], v[234:235], v[16:17], v[8:9] op_sel:[0,0,0] op_sel_hi:[1,0,1]
    v_exp_f32 v42, v6
    v_exp_f32 v43, v7
    v_pk_mul_f32 v[8:9], v[6:7], v[8:9]
    v_pk_fma_f32 v[42:43], v[42:43], v[36:37], v[36:37]
    v_rcp_f32 v42, v42
    v_rcp_f32 v43, v43
    s_nop 0
    v_pk_mul_f32 v[8:9], v[8:9], v[42:43]
    v_cvt_pk_bf16_f32 v111, v8, v9
    buffer_store_dwordx4 v[108:111], v0, s[40:43], s59 offen sc0 sc1
    s_add_u32 s59, s59, 147456
    v_pk_fma_f32 v[2:3], v[30:31], v[92:93], v[96:97] op_sel:[0,0,0] op_sel_hi:[0,1,1]
    v_pk_fma_f32 v[4:5], v[30:31], v[100:101], v[104:105] op_sel:[0,0,0] op_sel_hi:[0,1,1]
    v_pk_fma_f32 v[2:3], v[156:157], v[18:19], v[2:3] op_sel:[0,0,0] op_sel_hi:[1,0,1]
    v_pk_fma_f32 v[4:5], v[220:221], v[18:19], v[4:5] op_sel:[0,0,0] op_sel_hi:[1,0,1]
    v_exp_f32 v10, v2
    v_exp_f32 v11, v3
    v_pk_mul_f32 v[4:5], v[2:3], v[4:5]
    v_pk_fma_f32 v[10:11], v[10:11], v[36:37], v[36:37]
    v_rcp_f32 v10, v10
    v_rcp_f32 v11, v11
    s_nop 0
    v_pk_mul_f32 v[4:5], v[4:5], v[10:11]
    v_cvt_pk_bf16_f32 v108, v4, v5
    v_pk_fma_f32 v[6:7], v[30:31], v[94:95], v[98:99] op_sel:[0,0,0] op_sel_hi:[0,1,1]
    v_pk_fma_f32 v[8:9], v[30:31], v[102:103], v[106:107] op_sel:[0,0,0] op_sel_hi:[0,1,1]
    v_pk_fma_f32 v[6:7], v[158:159], v[18:19], v[6:7] op_sel:[0,0,0] op_sel_hi:[1,0,1]
    v_pk_fma_f32 v[8:9], v[222:223], v[18:19], v[8:9] op_sel:[0,0,0] op_sel_hi:[1,0,1]
    v_exp_f32 v42, v6
    v_exp_f32 v43, v7
    v_pk_mul_f32 v[8:9], v[6:7], v[8:9]
    v_pk_fma_f32 v[42:43], v[42:43], v[36:37], v[36:37]
    v_rcp_f32 v42, v42
    v_rcp_f32 v43, v43
    s_nop 0
    v_pk_mul_f32 v[8:9], v[8:9], v[42:43]
    v_cvt_pk_bf16_f32 v109, v8, v9
    v_pk_fma_f32 v[2:3], v[30:31], v[60:61], v[64:65] op_sel:[0,0,0] op_sel_hi:[0,1,1]
    v_pk_fma_f32 v[4:5], v[30:31], v[68:69], v[72:73] op_sel:[0,0,0] op_sel_hi:[0,1,1]
    v_pk_fma_f32 v[2:3], v[172:173], v[18:19], v[2:3] op_sel:[0,0,0] op_sel_hi:[1,0,1]
    v_pk_fma_f32 v[4:5], v[236:237], v[18:19], v[4:5] op_sel:[0,0,0] op_sel_hi:[1,0,1]
    v_exp_f32 v10, v2
    v_exp_f32 v11, v3
    v_pk_mul_f32 v[4:5], v[2:3], v[4:5]
    v_pk_fma_f32 v[10:11], v[10:11], v[36:37], v[36:37]
    v_rcp_f32 v10, v10
    v_rcp_f32 v11, v11
    s_nop 0
    v_pk_mul_f32 v[4:5], v[4:5], v[10:11]
    v_cvt_pk_bf16_f32 v110, v4, v5
    v_pk_fma_f32 v[6:7], v[30:31], v[62:63], v[66:67] op_sel:[0,0,0] op_sel_hi:[0,1,1]
    v_pk_fma_f32 v[8:9], v[30:31], v[70:71], v[74:75] op_sel:[0,0,0] op_sel_hi:[0,1,1]
    v_pk_fma_f32 v[6:7], v[174:175], v[18:19], v[6:7] op_sel:[0,0,0] op_sel_hi:[1,0,1]
    v_pk_fma_f32 v[8:9], v[238:239], v[18:19], v[8:9] op_sel:[0,0,0] op_sel_hi:[1,0,1]
    v_exp_f32 v42, v6
    v_exp_f32 v43, v7
    v_pk_mul_f32 v[8:9], v[6:7], v[8:9]
    v_pk_fma_f32 v[42:43], v[42:43], v[36:37], v[36:37]
    v_rcp_f32 v42, v42
    v_rcp_f32 v43, v43
    s_nop 0
    v_pk_mul_f32 v[8:9], v[8:9], v[42:43]
    v_cvt_pk_bf16_f32 v111, v8, v9
    buffer_store_dwordx4 v[108:111], v0, s[40:43], s59 offen sc0 sc1
    s_waitcnt vmcnt(8)
    v_permlane32_swap_b32 v240, v244
    v_permlane32_swap_b32 v241, v245
    v_permlane32_swap_b32 v242, v246
    v_permlane32_swap_b32 v243, v247
    v_pk_fma_f32 v[2:3], v[32:33], v[112:113], v[128:129] op_sel:[0,0,0] op_sel_hi:[0,1,1]
    v_pk_fma_f32 v[4:5], v[32:33], v[176:177], v[192:193] op_sel:[0,0,0] op_sel_hi:[0,1,1]
    v_pk_fma_f32 v[2:3], v[240:241], v[20:21], v[2:3] op_sel:[0,0,0] op_sel_hi:[1,0,1]
    v_pk_fma_f32 v[4:5], v[244:245], v[20:21], v[4:5] op_sel:[0,0,0] op_sel_hi:[1,0,1]
    v_exp_f32 v10, v2
    v_exp_f32 v11, v3
    v_pk_mul_f32 v[4:5], v[2:3], v[4:5]
    v_pk_fma_f32 v[10:11], v[10:11], v[36:37], v[36:37]
    v_rcp_f32 v10, v10
    v_rcp_f32 v11, v11
    s_nop 0
    v_pk_mul_f32 v[4:5], v[4:5], v[10:11]
    v_cvt_pk_bf16_f32 v108, v4, v5
    v_pk_fma_f32 v[6:7], v[32:33], v[114:115], v[130:131] op_sel:[0,0,0] op_sel_hi:[0,1,1]
    v_pk_fma_f32 v[8:9], v[32:33], v[178:179], v[194:195] op_sel:[0,0,0] op_sel_hi:[0,1,1]
    v_pk_fma_f32 v[6:7], v[242:243], v[20:21], v[6:7] op_sel:[0,0,0] op_sel_hi:[1,0,1]
    v_pk_fma_f32 v[8:9], v[246:247], v[20:21], v[8:9] op_sel:[0,0,0] op_sel_hi:[1,0,1]
    v_exp_f32 v42, v6
    v_exp_f32 v43, v7
    v_pk_mul_f32 v[8:9], v[6:7], v[8:9]
    v_pk_fma_f32 v[42:43], v[42:43], v[36:37], v[36:37]
    v_rcp_f32 v42, v42
    v_rcp_f32 v43, v43
    s_nop 0
    v_pk_mul_f32 v[8:9], v[8:9], v[42:43]
    v_cvt_pk_bf16_f32 v109, v8, v9
    v_permlane32_swap_b32 v248, v252
    v_permlane32_swap_b32 v249, v253
    v_permlane32_swap_b32 v250, v254
    v_permlane32_swap_b32 v251, v255
    v_pk_fma_f32 v[2:3], v[34:35], v[112:113], v[128:129] op_sel:[0,0,0] op_sel_hi:[0,1,1]
    v_pk_fma_f32 v[4:5], v[34:35], v[176:177], v[192:193] op_sel:[0,0,0] op_sel_hi:[0,1,1]
    v_pk_fma_f32 v[2:3], v[248:249], v[22:23], v[2:3] op_sel:[0,0,0] op_sel_hi:[1,0,1]
    v_pk_fma_f32 v[4:5], v[252:253], v[22:23], v[4:5] op_sel:[0,0,0] op_sel_hi:[1,0,1]
    v_exp_f32 v10, v2
    v_exp_f32 v11, v3
    v_pk_mul_f32 v[4:5], v[2:3], v[4:5]
    v_pk_fma_f32 v[10:11], v[10:11], v[36:37], v[36:37]
    v_rcp_f32 v10, v10
    v_rcp_f32 v11, v11
    s_nop 0
    v_pk_mul_f32 v[4:5], v[4:5], v[10:11]
    v_cvt_pk_bf16_f32 v110, v4, v5
    v_pk_fma_f32 v[6:7], v[34:35], v[114:115], v[130:131] op_sel:[0,0,0] op_sel_hi:[0,1,1]
    v_pk_fma_f32 v[8:9], v[34:35], v[178:179], v[194:195] op_sel:[0,0,0] op_sel_hi:[0,1,1]
    v_pk_fma_f32 v[6:7], v[250:251], v[22:23], v[6:7] op_sel:[0,0,0] op_sel_hi:[1,0,1]
    v_pk_fma_f32 v[8:9], v[254:255], v[22:23], v[8:9] op_sel:[0,0,0] op_sel_hi:[1,0,1]
    v_exp_f32 v42, v6
    v_exp_f32 v43, v7
    v_pk_mul_f32 v[8:9], v[6:7], v[8:9]
    v_pk_fma_f32 v[42:43], v[42:43], v[36:37], v[36:37]
    v_rcp_f32 v42, v42
    v_rcp_f32 v43, v43
    s_nop 0
    v_pk_mul_f32 v[8:9], v[8:9], v[42:43]
    v_cvt_pk_bf16_f32 v111, v8, v9
    v_permlane16_swap_b32 v108, v110
    s_nop 0
    v_permlane16_swap_b32 v109, v111
    buffer_store_dwordx4 v[108:111], v38, s[40:43], s56 offen sc0 sc1
    s_add_u32 s72, s8, 0x350000
    s_addc_u32 s73, s9, 0
    s_mov_b32 s74, 0x4000
    s_mov_b32 s75, 0x00020000
    s_lshl_b32 s22, s5, 2
    s_add_u32 s22, s22, s20
    s_lshl_b32 s22, s22, 5
    s_add_u32 s22, s22, s6
    s_lshl_b32 s22, s22, 1
    s_add_u32 s22, s22, s21
    s_lshl_b32 s22, s22, 2
    v_mov_b32 v2, 0
    v_mov_b32 v3, 1
    s_waitcnt vmcnt(0)
    s_mov_b64 exec, 1
    buffer_store_dword v3, v2, s[72:75], s22 offen sc0 sc1
    s_mov_b64 exec, -1
    s_and_b32 s46, s2, 7
    s_lshr_b32 s47, s2, 3
    s_lshr_b32 s5, s46, 1
    s_lshr_b32 s20, s47, 3
    s_and_b32 s47, s47, 7
    s_lshl_b32 s47, s47, 1
    s_and_b32 s46, s46, 1
    s_add_u32 s6, s47, s46
    s_lshr_b32 s21, s7, 1
    s_and_b32 s22, s7, 1
    v_mov_b32 v2, v0
    v_add_u32 v3, 147456, v2
    s_lshl_b32 s23, s6, 3
    s_lshl_b32 s24, s21, 1
    s_add_u32 s23, s23, s24
    s_mul_i32 s23, s23, 144
    s_mul_i32 s24, s5, 36
    s_add_u32 s23, s23, s24
    s_add_u32 s23, s23, s22
    s_lshl_b32 s32, s23, 10
    s_add_u32 s16, s8, 0x1000000
    s_addc_u32 s17, s9, 0
    s_mov_b32 s18, 0x1200000
    s_mov_b32 s19, 0x00020000
    s_lshl_b32 s23, s6, 1
    s_lshr_b32 s24, s21, 1
    s_add_u32 s23, s23, s24
    s_lshl_b32 s23, s23, 8
    s_lshl_b32 s24, s5, 6
    s_add_u32 s23, s23, s24
    v_and_b32 v4, 15, v1
    v_lshlrev_b32 v4, 2, v4
    buffer_load_dword v5, v4, s[72:75], s23 offen sc0 sc1
    s_add_u32 m0, s53, 0
    s_nop 0
    buffer_load_dwordx4 v2, s[12:15], s48 offen lds
    s_add_u32 s48, s48, 147456
    s_add_u32 m0, s53, 8192
    s_nop 0
    buffer_load_dwordx4 v2, s[12:15], s49 offen lds
    s_add_u32 s49, s49, 147456
    s_add_u32 m0, s53, 16384
    s_nop 0
    buffer_load_dwordx4 v2, s[12:15], s50 offen lds
    s_add_u32 s50, s50, 147456
    s_add_u32 m0, s53, 24576
    s_nop 0
    buffer_load_dwordx4 v2, s[12:15], s51 offen lds
    s_add_u32 s51, s51, 147456
    s_add_u32 m0, s54, 0
    s_mov_b64 exec, 0xffffffff
    buffer_load_dwordx4 v2, s[12:15], s52 offen lds
    s_mov_b64 exec, -1
    s_add_u32 s52, s52, 147456
    s_add_u32 m0, s53, 36864
    s_nop 0
    buffer_load_dwordx4 v2, s[12:15], s48 offen lds
    s_add_u32 s48, s48, 147456
    s_add_u32 m0, s53, 45056
    s_nop 0
    buffer_load_dwordx4 v2, s[12:15], s49 offen lds
    s_add_u32 s49, s49, 147456
    s_add_u32 m0, s53, 53248
    s_nop 0
    buffer_load_dwordx4 v2, s[12:15], s50 offen lds
    s_add_u32 s50, s50, 147456
    s_add_u32 m0, s53, 61440
    s_nop 0
    buffer_load_dwordx4 v2, s[12:15], s51 offen lds
    s_add_u32 s51, s51, 147456
    s_add_u32 m0, s54, 36864
    s_mov_b64 exec, 0xffffffff
    buffer_load_dwordx4 v2, s[12:15], s52 offen lds
    s_mov_b64 exec, -1
    s_add_u32 s52, s52, 147456
    s_add_u32 s28, s8, 0x2400000
    s_addc_u32 s29, s9, 0
    s_mov_b32 s30, 0x6c0000
    s_mov_b32 s31, 0x00020000
    s_add_u32 s44, s8, 0x800000
    s_addc_u32 s45, s9, 0
    s_mov_b32 s46, 0x240000
    s_mov_b32 s47, 0x00020000
    s_add_u32 s36, s8, 0x310000
    s_addc_u32 s37, s9, 0
    s_mov_b32 s38, 0x3600
    s_mov_b32 s39, 0x00020000
    s_load_dwordx2 s[40:41], s[0:1], 120
    v_and_b32 v8, 15, v1
    v_mul_u32_u24 v8, 1152, v8
    v_lshrrev_b32 v9, 4, v1
    v_lshlrev_b32 v10, 3, v9
    v_add_u32 v8, v8, v10
    v_lshlrev_b32 v9, 4, v9
    s_lshl_b32 s24, s6, 7
    s_lshl_b32 s25, s21, 5
    s_add_u32 s24, s24, s25
    s_lshl_b32 s25, s22, 4
    s_add_u32 s24, s24, s25
    s_lshl_b32 s68, s24, 1
    s_mul_i32 s69, s20, 589824
    s_add_u32 s68, s68, s69
    s_mul_i32 s60, s24, 1152
    s_mul_i32 s24, s20, 288
    s_add_u32 s60, s60, s24
    s_mul_i32 s61, s20, 576
    s_add_u32 s61, s61, 11520
    v_and_b32 v12, 15, v1
    v_lshlrev_b32 v12, 1, v12
    v_lshrrev_b32 v13, 4, v1
    v_lshlrev_b32 v13, 14, v13
    v_add_u32 v12, v12, v13
    s_lshl_b32 s62, s6, 2
    s_add_u32 s62, s62, s20
    s_lshl_b32 s62, s62, 3
    s_add_u32 s62, s62, s7
    s_mul_i32 s62, s62, 13824
    s_cmp_eq_u32 s21, s5
    s_cselect_b64 s[66:67], -1, 0
    s_mul_i32 s25, s7, 9216
    v_add_u32 v10, s25, v2
    s_xor_b32 s24, s7, 1
    s_mul_i32 s24, s24, 9216
    v_add_u32 v11, s24, v2
    s_mov_b32 s57, 0
    s_waitcnt vmcnt(10) lgkmcnt(0)
GG_SPIN:
    v_cmp_eq_u32 vcc, 0, v5
    s_nop 0
    s_cmp_eq_u64 vcc, 0
    s_cbranch_scc1 GG_OK
    buffer_load_dword v5, v4, s[72:75], s23 offen sc0 sc1
    s_waitcnt vmcnt(0)
    s_add_u32 s57, s57, 1
    s_cmp_lt_u32 s57, 20000
    s_nop 0
    s_cbranch_scc1 GG_SPIN
GG_OK:
    buffer_load_dwordx4 v[160:163], v2, s[16:19], s32 offen sc0 sc1
    buffer_load_dwordx4 v[164:167], v3, s[16:19], s32 offen sc0 sc1
    buffer_load_dwordx4 v[168:171], v2, s[16:19], s32 offen offset:2048 sc0 sc1
    buffer_load_dwordx4 v[172:175], v3, s[16:19], s32 offen offset:2048 sc0 sc1
    s_add_u32 s32, s32, 4096
    buffer_load_dwordx4 v[176:179], v2, s[16:19], s32 offen sc0 sc1
    buffer_load_dwordx4 v[180:183], v3, s[16:19], s32 offen sc0 sc1
    buffer_load_dwordx4 v[184:187], v2, s[16:19], s32 offen offset:2048 sc0 sc1
    buffer_load_dwordx4 v[188:191], v3, s[16:19], s32 offen offset:2048 sc0 sc1
    s_add_u32 s32, s32, 4096
    s_mov_b32 s42, 0x240000
    s_mov_b32 s43, 0x00020000
    s_mul_i32 s23, s22, 9216
    v_add_u32 v4, s23, v2
    v_add_u32 v5, 36864, v4
    v_add_u32 v6, 73728, v4
    v_add_u32 v7, 110592, v4
    s_waitcnt vmcnt(13)
    s_barrier
    ds_read_b128 v[88:91], v4 offset:0
    ds_read_b128 v[92:95], v4 offset:1024
    ds_read_b128 v[96:99], v4 offset:2048
    ds_read_b128 v[100:103], v4 offset:3072
    ds_read_b128 v[104:107], v4 offset:4096
    ds_read_b128 v[108:111], v4 offset:5120
    ds_read_b128 v[112:115], v4 offset:6144
    ds_read_b128 v[116:119], v4 offset:7168
    ds_read_b128 v[120:123], v4 offset:8192
    s_waitcnt vmcnt(4)
    s_waitcnt lgkmcnt(8)
    v_mfma_f32_16x16x32_bf16 v[16:19], v[88:91], v[160:163], 0
    ds_read_b128 v[124:127], v4 offset:18432
    s_add_u32 m0, s53, 73728
    s_nop 0
    buffer_load_dwordx4 v2, s[12:15], s48 offen lds
    s_add_u32 s48, s48, 147456
    v_mfma_f32_16x16x32_bf16 v[20:23], v[88:91], v[164:167], 0
    s_add_u32 m0, s53, 81920
    s_nop 0
    buffer_load_dwordx4 v2, s[12:15], s49 offen lds
    s_add_u32 s49, s49, 147456
    s_waitcnt lgkmcnt(8)
    v_mfma_f32_16x16x32_bf16 v[24:27], v[92:95], v[160:163], 0
    ds_read_b128 v[128:131], v4 offset:19456
    s_add_u32 m0, s53, 90112
    s_nop 0
    buffer_load_dwordx4 v2, s[12:15], s50 offen lds
    s_add_u32 s50, s50, 147456
    v_mfma_f32_16x16x32_bf16 v[28:31], v[92:95], v[164:167], 0
    s_add_u32 m0, s53, 98304
    s_nop 0
    buffer_load_dwordx4 v2, s[12:15], s51 offen lds
    s_add_u32 s51, s51, 147456
    s_waitcnt lgkmcnt(8)
    v_mfma_f32_16x16x32_bf16 v[32:35], v[96:99], v[160:163], 0
    ds_read_b128 v[132:135], v4 offset:20480
    s_add_u32 m0, s54, 73728
    s_mov_b64 exec, 0xffffffff
    buffer_load_dwordx4 v2, s[12:15], s52 offen lds
    s_mov_b64 exec, -1
    s_add_u32 s52, s52, 147456
    v_mfma_f32_16x16x32_bf16 v[36:39], v[96:99], v[164:167], 0
    buffer_load_dwordx4 v[192:195], v2, s[16:19], s32 offen sc0 sc1
    s_waitcnt lgkmcnt(8)
    v_mfma_f32_16x16x32_bf16 v[40:43], v[100:103], v[160:163], 0
    ds_read_b128 v[136:139], v4 offset:21504
    buffer_load_dwordx4 v[196:199], v3, s[16:19], s32 offen sc0 sc1
    v_mfma_f32_16x16x32_bf16 v[44:47], v[100:103], v[164:167], 0
    buffer_load_dwordx4 v[200:203], v2, s[16:19], s32 offen offset:2048 sc0 sc1
    s_waitcnt lgkmcnt(8)
    v_mfma_f32_16x16x32_bf16 v[48:51], v[104:107], v[160:163], 0
    ds_read_b128 v[140:143], v4 offset:22528
    v_mfma_f32_16x16x32_bf16 v[52:55], v[104:107], v[164:167], 0
    buffer_load_dwordx4 v[204:207], v3, s[16:19], s32 offen offset:2048 sc0 sc1
    s_add_u32 s32, s32, 4096
    s_waitcnt lgkmcnt(8)
    v_mfma_f32_16x16x32_bf16 v[56:59], v[108:111], v[160:163], 0
    ds_read_b128 v[144:147], v4 offset:23552
    v_mfma_f32_16x16x32_bf16 v[60:63], v[108:111], v[164:167], 0
    buffer_load_dwordx4 v[208:211], v2, s[16:19], s32 offen sc0 sc1
    s_waitcnt lgkmcnt(8)
    v_mfma_f32_16x16x32_bf16 v[64:67], v[112:115], v[160:163], 0
    ds_read_b128 v[148:151], v4 offset:24576
    v_mfma_f32_16x16x32_bf16 v[68:71], v[112:115], v[164:167], 0
    buffer_load_dwordx4 v[212:215], v3, s[16:19], s32 offen sc0 sc1
    s_waitcnt lgkmcnt(8)
    v_mfma_f32_16x16x32_bf16 v[72:75], v[116:119], v[160:163], 0
    ds_read_b128 v[152:155], v4 offset:25600
    v_mfma_f32_16x16x32_bf16 v[76:79], v[116:119], v[164:167], 0
    buffer_load_dwordx4 v[216:219], v2, s[16:19], s32 offen offset:2048 sc0 sc1
    s_waitcnt lgkmcnt(8)
    v_mfma_f32_16x16x32_bf16 v[80:83], v[120:123], v[160:163], 0
    ds_read_b128 v[156:159], v4 offset:26624
    v_mfma_f32_16x16x32_bf16 v[84:87], v[120:123], v[164:167], 0
    buffer_load_dwordx4 v[220:223], v3, s[16:19], s32 offen offset:2048 sc0 sc1
    s_add_u32 s32, s32, 4096
    s_waitcnt lgkmcnt(0)
    s_barrier
    v_mfma_f32_16x16x32_bf16 v[16:19], v[124:127], v[168:171], v[16:19]
    ds_read_b128 v[88:91], v5 offset:0
    s_add_u32 m0, s53, 110592
    s_nop 0
    buffer_load_dwordx4 v2, s[12:15], s48 offen lds
    s_add_u32 s48, s48, 147456
    v_mfma_f32_16x16x32_bf16 v[20:23], v[124:127], v[172:175], v[20:23]
    s_add_u32 m0, s53, 118784
    s_nop 0
    buffer_load_dwordx4 v2, s[12:15], s49 offen lds
    s_add_u32 s49, s49, 147456
    v_mfma_f32_16x16x32_bf16 v[24:27], v[128:131], v[168:171], v[24:27]
    ds_read_b128 v[92:95], v5 offset:1024
    v_mfma_f32_16x16x32_bf16 v[28:31], v[128:131], v[172:175], v[28:31]
    s_add_u32 m0, s53, 126976
    s_nop 0
    buffer_load_dwordx4 v2, s[12:15], s50 offen lds
    s_add_u32 s50, s50, 147456
    v_mfma_f32_16x16x32_bf16 v[32:35], v[132:135], v[168:171], v[32:35]
    ds_read_b128 v[96:99], v5 offset:2048
    v_mfma_f32_16x16x32_bf16 v[36:39], v[132:135], v[172:175], v[36:39]
    s_add_u32 m0, s53, 135168
    s_nop 0
    buffer_load_dwordx4 v2, s[12:15], s51 offen lds
    s_add_u32 s51, s51, 147456
    v_mfma_f32_16x16x32_bf16 v[40:43], v[136:139], v[168:171], v[40:43]
    ds_read_b128 v[100:103], v5 offset:3072
    v_mfma_f32_16x16x32_bf16 v[44:47], v[136:139], v[172:175], v[44:47]
    s_add_u32 m0, s54, 110592
    s_mov_b64 exec, 0xffffffff
    buffer_load_dwordx4 v2, s[12:15], s52 offen lds
    s_mov_b64 exec, -1
    s_add_u32 s52, s52, 147456
    v_mfma_f32_16x16x32_bf16 v[48:51], v[140:143], v[168:171], v[48:51]
    ds_read_b128 v[104:107], v5 offset:4096
    v_mfma_f32_16x16x32_bf16 v[52:55], v[140:143], v[172:175], v[52:55]
    s_add_u32 m0, s53, 0
    s_nop 0
    buffer_load_dwordx4 v2, s[12:15], s48 offen lds
    s_add_u32 s48, s48, 147456
    v_mfma_f32_16x16x32_bf16 v[56:59], v[144:147], v[168:171], v[56:59]
    ds_read_b128 v[108:111], v5 offset:5120
    v_mfma_f32_16x16x32_bf16 v[60:63], v[144:147], v[172:175], v[60:63]
    s_add_u32 m0, s53, 8192
    s_nop 0
    buffer_load_dwordx4 v2, s[12:15], s49 offen lds
    s_add_u32 s49, s49, 147456
    v_mfma_f32_16x16x32_bf16 v[64:67], v[148:151], v[168:171], v[64:67]
    ds_read_b128 v[112:115], v5 offset:6144
    v_mfma_f32_16x16x32_bf16 v[68:71], v[148:151], v[172:175], v[68:71]
    s_add_u32 m0, s53, 16384
    s_nop 0
    buffer_load_dwordx4 v2, s[12:15], s50 offen lds
    s_add_u32 s50, s50, 147456
    v_mfma_f32_16x16x32_bf16 v[72:75], v[152:155], v[168:171], v[72:75]
    ds_read_b128 v[116:119], v5 offset:7168
    v_mfma_f32_16x16x32_bf16 v[76:79], v[152:155], v[172:175], v[76:79]
    s_add_u32 m0, s53, 24576
    s_nop 0
    buffer_load_dwordx4 v2, s[12:15], s51 offen lds
    s_add_u32 s51, s51, 147456
    v_mfma_f32_16x16x32_bf16 v[80:83], v[156:159], v[168:171], v[80:83]
    ds_read_b128 v[120:123], v5 offset:8192
    v_mfma_f32_16x16x32_bf16 v[84:87], v[156:159], v[172:175], v[84:87]
    s_add_u32 m0, s54, 0
    s_mov_b64 exec, 0xffffffff
    buffer_load_dwordx4 v2, s[12:15], s52 offen lds
    s_mov_b64 exec, -1
    s_add_u32 s52, s52, 147456
    s_waitcnt vmcnt(23)
    s_waitcnt lgkmcnt(8)
    v_mfma_f32_16x16x32_bf16 v[16:19], v[88:91], v[176:179], v[16:19]
    ds_read_b128 v[124:127], v5 offset:18432
    v_mfma_f32_16x16x32_bf16 v[20:23], v[88:91], v[180:183], v[20:23]
    s_waitcnt lgkmcnt(8)
    v_mfma_f32_16x16x32_bf16 v[24:27], v[92:95], v[176:179], v[24:27]
    ds_read_b128 v[128:131], v5 offset:19456
    v_mfma_f32_16x16x32_bf16 v[28:31], v[92:95], v[180:183], v[28:31]
    buffer_load_dwordx4 v[160:163], v2, s[16:19], s32 offen sc0 sc1
    s_waitcnt lgkmcnt(8)
    v_mfma_f32_16x16x32_bf16 v[32:35], v[96:99], v[176:179], v[32:35]
    ds_read_b128 v[132:135], v5 offset:20480
    v_mfma_f32_16x16x32_bf16 v[36:39], v[96:99], v[180:183], v[36:39]
    buffer_load_dwordx4 v[164:167], v3, s[16:19], s32 offen sc0 sc1
    s_waitcnt lgkmcnt(8)
    v_mfma_f32_16x16x32_bf16 v[40:43], v[100:103], v[176:179], v[40:43]
    ds_read_b128 v[136:139], v5 offset:21504
    v_mfma_f32_16x16x32_bf16 v[44:47], v[100:103], v[180:183], v[44:47]
    buffer_load_dwordx4 v[168:171], v2, s[16:19], s32 offen offset:2048 sc0 sc1
    s_waitcnt lgkmcnt(8)
    v_mfma_f32_16x16x32_bf16 v[48:51], v[104:107], v[176:179], v[48:51]
    ds_read_b128 v[140:143], v5 offset:22528
    v_mfma_f32_16x16x32_bf16 v[52:55], v[104:107], v[180:183], v[52:55]
    buffer_load_dwordx4 v[172:175], v3, s[16:19], s32 offen offset:2048 sc0 sc1
    s_add_u32 s32, s32, 4096
    s_waitcnt lgkmcnt(8)
    v_mfma_f32_16x16x32_bf16 v[56:59], v[108:111], v[176:179], v[56:59]
    ds_read_b128 v[144:147], v5 offset:23552
    v_mfma_f32_16x16x32_bf16 v[60:63], v[108:111], v[180:183], v[60:63]
    s_waitcnt lgkmcnt(8)
    v_mfma_f32_16x16x32_bf16 v[64:67], v[112:115], v[176:179], v[64:67]
    ds_read_b128 v[148:151], v5 offset:24576
    v_mfma_f32_16x16x32_bf16 v[68:71], v[112:115], v[180:183], v[68:71]
    s_waitcnt lgkmcnt(8)
    v_mfma_f32_16x16x32_bf16 v[72:75], v[116:119], v[176:179], v[72:75]
    ds_read_b128 v[152:155], v5 offset:25600
    v_mfma_f32_16x16x32_bf16 v[76:79], v[116:119], v[180:183], v[76:79]
    s_waitcnt lgkmcnt(8)
    v_mfma_f32_16x16x32_bf16 v[80:83], v[120:123], v[176:179], v[80:83]
    ds_read_b128 v[156:159], v5 offset:26624
    v_mfma_f32_16x16x32_bf16 v[84:87], v[120:123], v[180:183], v[84:87]
    s_waitcnt vmcnt(22) lgkmcnt(0)
    s_barrier
    v_mfma_f32_16x16x32_bf16 v[16:19], v[124:127], v[184:187], v[16:19]
    ds_read_b128 v[88:91], v6 offset:0
    v_mfma_f32_16x16x32_bf16 v[20:23], v[124:127], v[188:191], v[20:23]
    v_mfma_f32_16x16x32_bf16 v[24:27], v[128:131], v[184:187], v[24:27]
    ds_read_b128 v[92:95], v6 offset:1024
    v_mfma_f32_16x16x32_bf16 v[28:31], v[128:131], v[188:191], v[28:31]
    s_add_u32 m0, s53, 36864
    s_nop 0
    buffer_load_dwordx4 v2, s[12:15], s48 offen lds
    s_add_u32 s48, s48, 147456
    v_mfma_f32_16x16x32_bf16 v[32:35], v[132:135], v[184:187], v[32:35]
    ds_read_b128 v[96:99], v6 offset:2048
    v_mfma_f32_16x16x32_bf16 v[36:39], v[132:135], v[188:191], v[36:39]
    s_add_u32 m0, s53, 45056
    s_nop 0
    buffer_load_dwordx4 v2, s[12:15], s49 offen lds
    s_add_u32 s49, s49, 147456
    v_mfma_f32_16x16x32_bf16 v[40:43], v[136:139], v[184:187], v[40:43]
    ds_read_b128 v[100:103], v6 offset:3072
    v_mfma_f32_16x16x32_bf16 v[44:47], v[136:139], v[188:191], v[44:47]
    s_add_u32 m0, s53, 53248
    s_nop 0
    buffer_load_dwordx4 v2, s[12:15], s50 offen lds
    s_add_u32 s50, s50, 147456
    v_mfma_f32_16x16x32_bf16 v[48:51], v[140:143], v[184:187], v[48:51]
    ds_read_b128 v[104:107], v6 offset:4096
    v_mfma_f32_16x16x32_bf16 v[52:55], v[140:143], v[188:191], v[52:55]
    s_add_u32 m0, s53, 61440
    s_nop 0
    buffer_load_dwordx4 v2, s[12:15], s51 offen lds
    s_add_u32 s51, s51, 147456
    v_mfma_f32_16x16x32_bf16 v[56:59], v[144:147], v[184:187], v[56:59]
    ds_read_b128 v[108:111], v6 offset:5120
    v_mfma_f32_16x16x32_bf16 v[60:63], v[144:147], v[188:191], v[60:63]
    s_add_u32 m0, s54, 36864
    s_mov_b64 exec, 0xffffffff
    buffer_load_dwordx4 v2, s[12:15], s52 offen lds
    s_mov_b64 exec, -1
    s_add_u32 s52, s52, 147456
    v_mfma_f32_16x16x32_bf16 v[64:67], v[148:151], v[184:187], v[64:67]
    ds_read_b128 v[112:115], v6 offset:6144
    v_mfma_f32_16x16x32_bf16 v[68:71], v[148:151], v[188:191], v[68:71]
    v_mfma_f32_16x16x32_bf16 v[72:75], v[152:155], v[184:187], v[72:75]
    ds_read_b128 v[116:119], v6 offset:7168
    v_mfma_f32_16x16x32_bf16 v[76:79], v[152:155], v[188:191], v[76:79]
    v_mfma_f32_16x16x32_bf16 v[80:83], v[156:159], v[184:187], v[80:83]
    ds_read_b128 v[120:123], v6 offset:8192
    v_mfma_f32_16x16x32_bf16 v[84:87], v[156:159], v[188:191], v[84:87]
    s_waitcnt vmcnt(23)
    s_waitcnt lgkmcnt(8)
    v_mfma_f32_16x16x32_bf16 v[16:19], v[88:91], v[192:195], v[16:19]
    ds_read_b128 v[124:127], v6 offset:18432
    v_mfma_f32_16x16x32_bf16 v[20:23], v[88:91], v[196:199], v[20:23]
    s_waitcnt lgkmcnt(8)
    v_mfma_f32_16x16x32_bf16 v[24:27], v[92:95], v[192:195], v[24:27]
    ds_read_b128 v[128:131], v6 offset:19456
    v_mfma_f32_16x16x32_bf16 v[28:31], v[92:95], v[196:199], v[28:31]
    buffer_load_dwordx4 v[176:179], v2, s[16:19], s32 offen sc0 sc1
    s_waitcnt lgkmcnt(8)
    v_mfma_f32_16x16x32_bf16 v[32:35], v[96:99], v[192:195], v[32:35]
    ds_read_b128 v[132:135], v6 offset:20480
    v_mfma_f32_16x16x32_bf16 v[36:39], v[96:99], v[196:199], v[36:39]
    buffer_load_dwordx4 v[180:183], v3, s[16:19], s32 offen sc0 sc1
    s_waitcnt lgkmcnt(8)
    v_mfma_f32_16x16x32_bf16 v[40:43], v[100:103], v[192:195], v[40:43]
    ds_read_b128 v[136:139], v6 offset:21504
    v_mfma_f32_16x16x32_bf16 v[44:47], v[100:103], v[196:199], v[44:47]
    buffer_load_dwordx4 v[184:187], v2, s[16:19], s32 offen offset:2048 sc0 sc1
    s_waitcnt lgkmcnt(8)
    v_mfma_f32_16x16x32_bf16 v[48:51], v[104:107], v[192:195], v[48:51]
    ds_read_b128 v[140:143], v6 offset:22528
    v_mfma_f32_16x16x32_bf16 v[52:55], v[104:107], v[196:199], v[52:55]
    buffer_load_dwordx4 v[188:191], v3, s[16:19], s32 offen offset:2048 sc0 sc1
    s_add_u32 s32, s32, 4096
    s_waitcnt lgkmcnt(8)
    v_mfma_f32_16x16x32_bf16 v[56:59], v[108:111], v[192:195], v[56:59]
    ds_read_b128 v[144:147], v6 offset:23552
    v_mfma_f32_16x16x32_bf16 v[60:63], v[108:111], v[196:199], v[60:63]
    s_waitcnt lgkmcnt(8)
    v_mfma_f32_16x16x32_bf16 v[64:67], v[112:115], v[192:195], v[64:67]
    ds_read_b128 v[148:151], v6 offset:24576
    v_mfma_f32_16x16x32_bf16 v[68:71], v[112:115], v[196:199], v[68:71]
    s_waitcnt lgkmcnt(8)
    v_mfma_f32_16x16x32_bf16 v[72:75], v[116:119], v[192:195], v[72:75]
    ds_read_b128 v[152:155], v6 offset:25600
    v_mfma_f32_16x16x32_bf16 v[76:79], v[116:119], v[196:199], v[76:79]
    s_waitcnt lgkmcnt(8)
    v_mfma_f32_16x16x32_bf16 v[80:83], v[120:123], v[192:195], v[80:83]
    ds_read_b128 v[156:159], v6 offset:26624
    v_mfma_f32_16x16x32_bf16 v[84:87], v[120:123], v[196:199], v[84:87]
    s_waitcnt vmcnt(18) lgkmcnt(0)
    s_barrier
    v_mfma_f32_16x16x32_bf16 v[16:19], v[124:127], v[200:203], v[16:19]
    ds_read_b128 v[88:91], v7 offset:0
    v_mfma_f32_16x16x32_bf16 v[20:23], v[124:127], v[204:207], v[20:23]
    v_mfma_f32_16x16x32_bf16 v[24:27], v[128:131], v[200:203], v[24:27]
    ds_read_b128 v[92:95], v7 offset:1024
    v_mfma_f32_16x16x32_bf16 v[28:31], v[128:131], v[204:207], v[28:31]
    s_add_u32 m0, s53, 73728
    s_nop 0
    buffer_load_dwordx4 v2, s[12:15], s48 offen lds
    s_add_u32 s48, s48, 147456
    v_mfma_f32_16x16x32_bf16 v[32:35], v[132:135], v[200:203], v[32:35]
    ds_read_b128 v[96:99], v7 offset:2048
    v_mfma_f32_16x16x32_bf16 v[36:39], v[132:135], v[204:207], v[36:39]
    s_add_u32 m0, s53, 81920
    s_nop 0
    buffer_load_dwordx4 v2, s[12:15], s49 offen lds
    s_add_u32 s49, s49, 147456
    v_mfma_f32_16x16x32_bf16 v[40:43], v[136:139], v[200:203], v[40:43]
    ds_read_b128 v[100:103], v7 offset:3072
    v_mfma_f32_16x16x32_bf16 v[44:47], v[136:139], v[204:207], v[44:47]
    s_add_u32 m0, s53, 90112
    s_nop 0
    buffer_load_dwordx4 v2, s[12:15], s50 offen lds
    s_add_u32 s50, s50, 147456
    v_mfma_f32_16x16x32_bf16 v[48:51], v[140:143], v[200:203], v[48:51]
    ds_read_b128 v[104:107], v7 offset:4096
    v_mfma_f32_16x16x32_bf16 v[52:55], v[140:143], v[204:207], v[52:55]
    s_add_u32 m0, s53, 98304
    s_nop 0
    buffer_load_dwordx4 v2, s[12:15], s51 offen lds
    s_add_u32 s51, s51, 147456
    v_mfma_f32_16x16x32_bf16 v[56:59], v[144:147], v[200:203], v[56:59]
    ds_read_b128 v[108:111], v7 offset:5120
    v_mfma_f32_16x16x32_bf16 v[60:63], v[144:147], v[204:207], v[60:63]
    s_add_u32 m0, s54, 73728
    s_mov_b64 exec, 0xffffffff
    buffer_load_dwordx4 v2, s[12:15], s52 offen lds
    s_mov_b64 exec, -1
    s_add_u32 s52, s52, 147456
    v_mfma_f32_16x16x32_bf16 v[64:67], v[148:151], v[200:203], v[64:67]
    ds_read_b128 v[112:115], v7 offset:6144
    v_mfma_f32_16x16x32_bf16 v[68:71], v[148:151], v[204:207], v[68:71]
    v_mfma_f32_16x16x32_bf16 v[72:75], v[152:155], v[200:203], v[72:75]
    ds_read_b128 v[116:119], v7 offset:7168
    v_mfma_f32_16x16x32_bf16 v[76:79], v[152:155], v[204:207], v[76:79]
    v_mfma_f32_16x16x32_bf16 v[80:83], v[156:159], v[200:203], v[80:83]
    ds_read_b128 v[120:123], v7 offset:8192
    v_mfma_f32_16x16x32_bf16 v[84:87], v[156:159], v[204:207], v[84:87]
    s_waitcnt lgkmcnt(8)
    v_mfma_f32_16x16x32_bf16 v[16:19], v[88:91], v[208:211], v[16:19]
    ds_read_b128 v[124:127], v7 offset:18432
    v_mfma_f32_16x16x32_bf16 v[20:23], v[88:91], v[212:215], v[20:23]
    s_waitcnt lgkmcnt(8)
    v_mfma_f32_16x16x32_bf16 v[24:27], v[92:95], v[208:211], v[24:27]
    ds_read_b128 v[128:131], v7 offset:19456
    v_mfma_f32_16x16x32_bf16 v[28:31], v[92:95], v[212:215], v[28:31]
    buffer_load_dwordx4 v[192:195], v2, s[16:19], s32 offen sc0 sc1
    s_waitcnt lgkmcnt(8)
    v_mfma_f32_16x16x32_bf16 v[32:35], v[96:99], v[208:211], v[32:35]
    ds_read_b128 v[132:135], v7 offset:20480
    v_mfma_f32_16x16x32_bf16 v[36:39], v[96:99], v[212:215], v[36:39]
    buffer_load_dwordx4 v[196:199], v3, s[16:19], s32 offen sc0 sc1
    s_waitcnt lgkmcnt(8)
    v_mfma_f32_16x16x32_bf16 v[40:43], v[100:103], v[208:211], v[40:43]
    ds_read_b128 v[136:139], v7 offset:21504
    v_mfma_f32_16x16x32_bf16 v[44:47], v[100:103], v[212:215], v[44:47]
    buffer_load_dwordx4 v[200:203], v2, s[16:19], s32 offen offset:2048 sc0 sc1
    s_waitcnt lgkmcnt(8)
    v_mfma_f32_16x16x32_bf16 v[48:51], v[104:107], v[208:211], v[48:51]
    ds_read_b128 v[140:143], v7 offset:22528
    v_mfma_f32_16x16x32_bf16 v[52:55], v[104:107], v[212:215], v[52:55]
    buffer_load_dwordx4 v[204:207], v3, s[16:19], s32 offen offset:2048 sc0 sc1
    s_add_u32 s32, s32, 4096
    s_waitcnt lgkmcnt(8)
    v_mfma_f32_16x16x32_bf16 v[56:59], v[108:111], v[208:211], v[56:59]
    ds_read_b128 v[144:147], v7 offset:23552
    v_mfma_f32_16x16x32_bf16 v[60:63], v[108:111], v[212:215], v[60:63]
    s_waitcnt lgkmcnt(8)
    v_mfma_f32_16x16x32_bf16 v[64:67], v[112:115], v[208:211], v[64:67]
    ds_read_b128 v[148:151], v7 offset:24576
    v_mfma_f32_16x16x32_bf16 v[68:71], v[112:115], v[212:215], v[68:71]
    s_waitcnt lgkmcnt(8)
    v_mfma_f32_16x16x32_bf16 v[72:75], v[116:119], v[208:211], v[72:75]
    ds_read_b128 v[152:155], v7 offset:25600
    v_mfma_f32_16x16x32_bf16 v[76:79], v[116:119], v[212:215], v[76:79]
    s_waitcnt lgkmcnt(8)
    v_mfma_f32_16x16x32_bf16 v[80:83], v[120:123], v[208:211], v[80:83]
    ds_read_b128 v[156:159], v7 offset:26624
    v_mfma_f32_16x16x32_bf16 v[84:87], v[120:123], v[212:215], v[84:87]
    s_waitcnt vmcnt(22) lgkmcnt(0)
    s_barrier
    v_mfma_f32_16x16x32_bf16 v[16:19], v[124:127], v[216:219], v[16:19]
    ds_read_b128 v[88:91], v4 offset:0
    v_mfma_f32_16x16x32_bf16 v[20:23], v[124:127], v[220:223], v[20:23]
    v_mfma_f32_16x16x32_bf16 v[24:27], v[128:131], v[216:219], v[24:27]
    ds_read_b128 v[92:95], v4 offset:1024
    v_mfma_f32_16x16x32_bf16 v[28:31], v[128:131], v[220:223], v[28:31]
    s_add_u32 m0, s53, 110592
    s_nop 0
    buffer_load_dwordx4 v2, s[12:15], s48 offen lds
    s_add_u32 s48, s48, 147456
    v_mfma_f32_16x16x32_bf16 v[32:35], v[132:135], v[216:219], v[32:35]
    ds_read_b128 v[96:99], v4 offset:2048
    v_mfma_f32_16x16x32_bf16 v[36:39], v[132:135], v[220:223], v[36:39]
    s_add_u32 m0, s53, 118784
    s_nop 0
    buffer_load_dwordx4 v2, s[12:15], s49 offen lds
    s_add_u32 s49, s49, 147456
    v_mfma_f32_16x16x32_bf16 v[40:43], v[136:139], v[216:219], v[40:43]
    ds_read_b128 v[100:103], v4 offset:3072
    v_mfma_f32_16x16x32_bf16 v[44:47], v[136:139], v[220:223], v[44:47]
    s_add_u32 m0, s53, 126976
    s_nop 0
    buffer_load_dwordx4 v2, s[12:15], s50 offen lds
    s_add_u32 s50, s50, 147456
    v_mfma_f32_16x16x32_bf16 v[48:51], v[140:143], v[216:219], v[48:51]
    ds_read_b128 v[104:107], v4 offset:4096
    v_mfma_f32_16x16x32_bf16 v[52:55], v[140:143], v[220:223], v[52:55]
    s_add_u32 m0, s53, 135168
    s_nop 0
    buffer_load_dwordx4 v2, s[12:15], s51 offen lds
    s_add_u32 s51, s51, 147456
    v_mfma_f32_16x16x32_bf16 v[56:59], v[144:147], v[216:219], v[56:59]
    ds_read_b128 v[108:111], v4 offset:5120
    v_mfma_f32_16x16x32_bf16 v[60:63], v[144:147], v[220:223], v[60:63]
    s_add_u32 m0, s54, 110592
    s_mov_b64 exec, 0xffffffff
    buffer_load_dwordx4 v2, s[12:15], s52 offen lds
    s_mov_b64 exec, -1
    s_add_u32 s52, s52, 147456
    v_mfma_f32_16x16x32_bf16 v[64:67], v[148:151], v[216:219], v[64:67]
    ds_read_b128 v[112:115], v4 offset:6144
    v_mfma_f32_16x16x32_bf16 v[68:71], v[148:151], v[220:223], v[68:71]
    v_mfma_f32_16x16x32_bf16 v[72:75], v[152:155], v[216:219], v[72:75]
    ds_read_b128 v[116:119], v4 offset:7168
    v_mfma_f32_16x16x32_bf16 v[76:79], v[152:155], v[220:223], v[76:79]
    v_mfma_f32_16x16x32_bf16 v[80:83], v[156:159], v[216:219], v[80:83]
    ds_read_b128 v[120:123], v4 offset:8192
    v_mfma_f32_16x16x32_bf16 v[84:87], v[156:159], v[220:223], v[84:87]
    s_waitcnt vmcnt(23)
    s_waitcnt lgkmcnt(8)
    v_mfma_f32_16x16x32_bf16 v[16:19], v[88:91], v[160:163], v[16:19]
    ds_read_b128 v[124:127], v4 offset:18432
    v_mfma_f32_16x16x32_bf16 v[20:23], v[88:91], v[164:167], v[20:23]
    s_waitcnt lgkmcnt(8)
    v_mfma_f32_16x16x32_bf16 v[24:27], v[92:95], v[160:163], v[24:27]
    ds_read_b128 v[128:131], v4 offset:19456
    v_mfma_f32_16x16x32_bf16 v[28:31], v[92:95], v[164:167], v[28:31]
    buffer_load_dwordx4 v[208:211], v2, s[16:19], s32 offen sc0 sc1
    s_waitcnt lgkmcnt(8)
    v_mfma_f32_16x16x32_bf16 v[32:35], v[96:99], v[160:163], v[32:35]
    ds_read_b128 v[132:135], v4 offset:20480
    v_mfma_f32_16x16x32_bf16 v[36:39], v[96:99], v[164:167], v[36:39]
    buffer_load_dwordx4 v[212:215], v3, s[16:19], s32 offen sc0 sc1
    s_waitcnt lgkmcnt(8)
    v_mfma_f32_16x16x32_bf16 v[40:43], v[100:103], v[160:163], v[40:43]
    ds_read_b128 v[136:139], v4 offset:21504
    v_mfma_f32_16x16x32_bf16 v[44:47], v[100:103], v[164:167], v[44:47]
    buffer_load_dwordx4 v[216:219], v2, s[16:19], s32 offen offset:2048 sc0 sc1
    s_waitcnt lgkmcnt(8)
    v_mfma_f32_16x16x32_bf16 v[48:51], v[104:107], v[160:163], v[48:51]
    ds_read_b128 v[140:143], v4 offset:22528
    v_mfma_f32_16x16x32_bf16 v[52:55], v[104:107], v[164:167], v[52:55]
    buffer_load_dwordx4 v[220:223], v3, s[16:19], s32 offen offset:2048 sc0 sc1
    s_add_u32 s32, s32, 4096
    s_waitcnt lgkmcnt(8)
    v_mfma_f32_16x16x32_bf16 v[56:59], v[108:111], v[160:163], v[56:59]
    ds_read_b128 v[144:147], v4 offset:23552
    v_mfma_f32_16x16x32_bf16 v[60:63], v[108:111], v[164:167], v[60:63]
    s_waitcnt lgkmcnt(8)
    v_mfma_f32_16x16x32_bf16 v[64:67], v[112:115], v[160:163], v[64:67]
    ds_read_b128 v[148:151], v4 offset:24576
    v_mfma_f32_16x16x32_bf16 v[68:71], v[112:115], v[164:167], v[68:71]
    s_waitcnt lgkmcnt(8)
    v_mfma_f32_16x16x32_bf16 v[72:75], v[116:119], v[160:163], v[72:75]
    ds_read_b128 v[152:155], v4 offset:25600
    v_mfma_f32_16x16x32_bf16 v[76:79], v[116:119], v[164:167], v[76:79]
    s_waitcnt lgkmcnt(8)
    v_mfma_f32_16x16x32_bf16 v[80:83], v[120:123], v[160:163], v[80:83]
    ds_read_b128 v[156:159], v4 offset:26624
    v_mfma_f32_16x16x32_bf16 v[84:87], v[120:123], v[164:167], v[84:87]
    s_waitcnt vmcnt(22) lgkmcnt(0)
    s_barrier
    v_mfma_f32_16x16x32_bf16 v[16:19], v[124:127], v[168:171], v[16:19]
    ds_read_b128 v[88:91], v5 offset:0
    v_mfma_f32_16x16x32_bf16 v[20:23], v[124:127], v[172:175], v[20:23]
    v_mfma_f32_16x16x32_bf16 v[24:27], v[128:131], v[168:171], v[24:27]
    ds_read_b128 v[92:95], v5 offset:1024
    v_mfma_f32_16x16x32_bf16 v[28:31], v[128:131], v[172:175], v[28:31]
    s_add_u32 m0, s53, 0
    s_nop 0
    buffer_load_dwordx4 v2, s[12:15], s48 offen lds
    s_add_u32 s48, s48, 147456
    v_mfma_f32_16x16x32_bf16 v[32:35], v[132:135], v[168:171], v[32:35]
    ds_read_b128 v[96:99], v5 offset:2048
    v_mfma_f32_16x16x32_bf16 v[36:39], v[132:135], v[172:175], v[36:39]
    s_add_u32 m0, s53, 8192
    s_nop 0
    buffer_load_dwordx4 v2, s[12:15], s49 offen lds
    s_add_u32 s49, s49, 147456
    v_mfma_f32_16x16x32_bf16 v[40:43], v[136:139], v[168:171], v[40:43]
    ds_read_b128 v[100:103], v5 offset:3072
    v_mfma_f32_16x16x32_bf16 v[44:47], v[136:139], v[172:175], v[44:47]
    s_add_u32 m0, s53, 16384
    s_nop 0
    buffer_load_dwordx4 v2, s[12:15], s50 offen lds
    s_add_u32 s50, s50, 147456
    v_mfma_f32_16x16x32_bf16 v[48:51], v[140:143], v[168:171], v[48:51]
    ds_read_b128 v[104:107], v5 offset:4096
    v_mfma_f32_16x16x32_bf16 v[52:55], v[140:143], v[172:175], v[52:55]
    s_add_u32 m0, s53, 24576
    s_nop 0
    buffer_load_dwordx4 v2, s[12:15], s51 offen lds
    s_add_u32 s51, s51, 147456
    v_mfma_f32_16x16x32_bf16 v[56:59], v[144:147], v[168:171], v[56:59]
    ds_read_b128 v[108:111], v5 offset:5120
    v_mfma_f32_16x16x32_bf16 v[60:63], v[144:147], v[172:175], v[60:63]
    s_add_u32 m0, s54, 0
    s_mov_b64 exec, 0xffffffff
    buffer_load_dwordx4 v2, s[12:15], s52 offen lds
    s_mov_b64 exec, -1
    s_add_u32 s52, s52, 147456
    v_mfma_f32_16x16x32_bf16 v[64:67], v[148:151], v[168:171], v[64:67]
    ds_read_b128 v[112:115], v5 offset:6144
    v_mfma_f32_16x16x32_bf16 v[68:71], v[148:151], v[172:175], v[68:71]
    v_mfma_f32_16x16x32_bf16 v[72:75], v[152:155], v[168:171], v[72:75]
    ds_read_b128 v[116:119], v5 offset:7168
    v_mfma_f32_16x16x32_bf16 v[76:79], v[152:155], v[172:175], v[76:79]
    v_mfma_f32_16x16x32_bf16 v[80:83], v[156:159], v[168:171], v[80:83]
    ds_read_b128 v[120:123], v5 offset:8192
    v_mfma_f32_16x16x32_bf16 v[84:87], v[156:159], v[172:175], v[84:87]
    s_waitcnt vmcnt(23)
    s_waitcnt lgkmcnt(8)
    v_mfma_f32_16x16x32_bf16 v[16:19], v[88:91], v[176:179], v[16:19]
    ds_read_b128 v[124:127], v5 offset:18432
    v_mfma_f32_16x16x32_bf16 v[20:23], v[88:91], v[180:183], v[20:23]
    s_waitcnt lgkmcnt(8)
    v_mfma_f32_16x16x32_bf16 v[24:27], v[92:95], v[176:179], v[24:27]
    ds_read_b128 v[128:131], v5 offset:19456
    v_mfma_f32_16x16x32_bf16 v[28:31], v[92:95], v[180:183], v[28:31]
    buffer_load_dwordx4 v[160:163], v2, s[16:19], s32 offen sc0 sc1
    s_waitcnt lgkmcnt(8)
    v_mfma_f32_16x16x32_bf16 v[32:35], v[96:99], v[176:179], v[32:35]
    ds_read_b128 v[132:135], v5 offset:20480
    v_mfma_f32_16x16x32_bf16 v[36:39], v[96:99], v[180:183], v[36:39]
    buffer_load_dwordx4 v[164:167], v3, s[16:19], s32 offen sc0 sc1
    s_waitcnt lgkmcnt(8)
    v_mfma_f32_16x16x32_bf16 v[40:43], v[100:103], v[176:179], v[40:43]
    ds_read_b128 v[136:139], v5 offset:21504
    v_mfma_f32_16x16x32_bf16 v[44:47], v[100:103], v[180:183], v[44:47]
    buffer_load_dwordx4 v[168:171], v2, s[16:19], s32 offen offset:2048 sc0 sc1
    s_waitcnt lgkmcnt(8)
    v_mfma_f32_16x16x32_bf16 v[48:51], v[104:107], v[176:179], v[48:51]
    ds_read_b128 v[140:143], v5 offset:22528
    v_mfma_f32_16x16x32_bf16 v[52:55], v[104:107], v[180:183], v[52:55]
    buffer_load_dwordx4 v[172:175], v3, s[16:19], s32 offen offset:2048 sc0 sc1
    s_add_u32 s32, s32, 4096
    s_waitcnt lgkmcnt(8)
    v_mfma_f32_16x16x32_bf16 v[56:59], v[108:111], v[176:179], v[56:59]
    ds_read_b128 v[144:147], v5 offset:23552
    v_mfma_f32_16x16x32_bf16 v[60:63], v[108:111], v[180:183], v[60:63]
    s_waitcnt lgkmcnt(8)
    v_mfma_f32_16x16x32_bf16 v[64:67], v[112:115], v[176:179], v[64:67]
    ds_read_b128 v[148:151], v5 offset:24576
    v_mfma_f32_16x16x32_bf16 v[68:71], v[112:115], v[180:183], v[68:71]
    s_waitcnt lgkmcnt(8)
    v_mfma_f32_16x16x32_bf16 v[72:75], v[116:119], v[176:179], v[72:75]
    ds_read_b128 v[152:155], v5 offset:25600
    v_mfma_f32_16x16x32_bf16 v[76:79], v[116:119], v[180:183], v[76:79]
    s_waitcnt lgkmcnt(8)
    v_mfma_f32_16x16x32_bf16 v[80:83], v[120:123], v[176:179], v[80:83]
    ds_read_b128 v[156:159], v5 offset:26624
    v_mfma_f32_16x16x32_bf16 v[84:87], v[120:123], v[180:183], v[84:87]
    s_waitcnt vmcnt(22) lgkmcnt(0)
    s_barrier
    v_mfma_f32_16x16x32_bf16 v[16:19], v[124:127], v[184:187], v[16:19]
    ds_read_b128 v[88:91], v6 offset:0
    v_mfma_f32_16x16x32_bf16 v[20:23], v[124:127], v[188:191], v[20:23]
    v_mfma_f32_16x16x32_bf16 v[24:27], v[128:131], v[184:187], v[24:27]
    ds_read_b128 v[92:95], v6 offset:1024
    v_mfma_f32_16x16x32_bf16 v[28:31], v[128:131], v[188:191], v[28:31]
    v_mfma_f32_16x16x32_bf16 v[32:35], v[132:135], v[184:187], v[32:35]
    ds_read_b128 v[96:99], v6 offset:2048
    v_mfma_f32_16x16x32_bf16 v[36:39], v[132:135], v[188:191], v[36:39]
    v_mfma_f32_16x16x32_bf16 v[40:43], v[136:139], v[184:187], v[40:43]
    ds_read_b128 v[100:103], v6 offset:3072
    v_mfma_f32_16x16x32_bf16 v[44:47], v[136:139], v[188:191], v[44:47]
    v_mfma_f32_16x16x32_bf16 v[48:51], v[140:143], v[184:187], v[48:51]
    ds_read_b128 v[104:107], v6 offset:4096
    v_mfma_f32_16x16x32_bf16 v[52:55], v[140:143], v[188:191], v[52:55]
    v_mfma_f32_16x16x32_bf16 v[56:59], v[144:147], v[184:187], v[56:59]
    ds_read_b128 v[108:111], v6 offset:5120
    v_mfma_f32_16x16x32_bf16 v[60:63], v[144:147], v[188:191], v[60:63]
    v_mfma_f32_16x16x32_bf16 v[64:67], v[148:151], v[184:187], v[64:67]
    ds_read_b128 v[112:115], v6 offset:6144
    v_mfma_f32_16x16x32_bf16 v[68:71], v[148:151], v[188:191], v[68:71]
    v_mfma_f32_16x16x32_bf16 v[72:75], v[152:155], v[184:187], v[72:75]
    ds_read_b128 v[116:119], v6 offset:7168
    v_mfma_f32_16x16x32_bf16 v[76:79], v[152:155], v[188:191], v[76:79]
    v_mfma_f32_16x16x32_bf16 v[80:83], v[156:159], v[184:187], v[80:83]
    ds_read_b128 v[120:123], v6 offset:8192
    v_mfma_f32_16x16x32_bf16 v[84:87], v[156:159], v[188:191], v[84:87]
    s_waitcnt vmcnt(18)
    s_waitcnt lgkmcnt(8)
    v_mfma_f32_16x16x32_bf16 v[16:19], v[88:91], v[192:195], v[16:19]
    ds_read_b128 v[124:127], v6 offset:18432
    v_mfma_f32_16x16x32_bf16 v[20:23], v[88:91], v[196:199], v[20:23]
    s_waitcnt lgkmcnt(8)
    v_mfma_f32_16x16x32_bf16 v[24:27], v[92:95], v[192:195], v[24:27]
    ds_read_b128 v[128:131], v6 offset:19456
    v_mfma_f32_16x16x32_bf16 v[28:31], v[92:95], v[196:199], v[28:31]
    s_waitcnt lgkmcnt(8)
    v_mfma_f32_16x16x32_bf16 v[32:35], v[96:99], v[192:195], v[32:35]
    ds_read_b128 v[132:135], v6 offset:20480
    v_mfma_f32_16x16x32_bf16 v[36:39], v[96:99], v[196:199], v[36:39]
    s_waitcnt lgkmcnt(8)
    v_mfma_f32_16x16x32_bf16 v[40:43], v[100:103], v[192:195], v[40:43]
    ds_read_b128 v[136:139], v6 offset:21504
    v_mfma_f32_16x16x32_bf16 v[44:47], v[100:103], v[196:199], v[44:47]
    s_waitcnt lgkmcnt(8)
    v_mfma_f32_16x16x32_bf16 v[48:51], v[104:107], v[192:195], v[48:51]
    ds_read_b128 v[140:143], v6 offset:22528
    v_mfma_f32_16x16x32_bf16 v[52:55], v[104:107], v[196:199], v[52:55]
    s_waitcnt lgkmcnt(8)
    v_mfma_f32_16x16x32_bf16 v[56:59], v[108:111], v[192:195], v[56:59]
    ds_read_b128 v[144:147], v6 offset:23552
    v_mfma_f32_16x16x32_bf16 v[60:63], v[108:111], v[196:199], v[60:63]
    s_waitcnt lgkmcnt(8)
    v_mfma_f32_16x16x32_bf16 v[64:67], v[112:115], v[192:195], v[64:67]
    ds_read_b128 v[148:151], v6 offset:24576
    v_mfma_f32_16x16x32_bf16 v[68:71], v[112:115], v[196:199], v[68:71]
    s_waitcnt lgkmcnt(8)
    v_mfma_f32_16x16x32_bf16 v[72:75], v[116:119], v[192:195], v[72:75]
    ds_read_b128 v[152:155], v6 offset:25600
    v_mfma_f32_16x16x32_bf16 v[76:79], v[116:119], v[196:199], v[76:79]
    s_waitcnt lgkmcnt(8)
    v_mfma_f32_16x16x32_bf16 v[80:83], v[120:123], v[192:195], v[80:83]
    ds_read_b128 v[156:159], v6 offset:26624
    v_mfma_f32_16x16x32_bf16 v[84:87], v[120:123], v[196:199], v[84:87]
    s_waitcnt vmcnt(13) lgkmcnt(0)
    s_barrier
    s_mov_b64 exec, s[66:67]
    buffer_load_ushort v224, v12, s[44:47], s68 offen
    s_add_u32 s68, s68, 4096
    buffer_load_ushort v225, v12, s[44:47], s68 offen
    s_add_u32 s68, s68, 4096
    buffer_load_ushort v226, v12, s[44:47], s68 offen
    s_add_u32 s68, s68, 4096
    buffer_load_ushort v227, v12, s[44:47], s68 offen
    s_add_u32 s68, s68, 53248
    buffer_load_ushort v228, v12, s[44:47], s68 offen
    s_add_u32 s68, s68, 4096
    buffer_load_ushort v229, v12, s[44:47], s68 offen
    s_add_u32 s68, s68, 4096
    buffer_load_ushort v230, v12, s[44:47], s68 offen
    s_add_u32 s68, s68, 4096
    buffer_load_ushort v231, v12, s[44:47], s68 offen
    s_add_u32 s68, s68, 53248
    buffer_load_ushort v232, v12, s[44:47], s68 offen
    s_add_u32 s68, s68, 4096
    buffer_load_ushort v233, v12, s[44:47], s68 offen
    s_add_u32 s68, s68, 4096
    buffer_load_ushort v234, v12, s[44:47], s68 offen
    s_add_u32 s68, s68, 4096
    buffer_load_ushort v235, v12, s[44:47], s68 offen
    s_add_u32 s68, s68, 53248
    buffer_load_ushort v236, v12, s[44:47], s68 offen
    s_add_u32 s68, s68, 4096
    buffer_load_ushort v237, v12, s[44:47], s68 offen
    s_add_u32 s68, s68, 4096
    buffer_load_ushort v238, v12, s[44:47], s68 offen
    s_add_u32 s68, s68, 4096
    buffer_load_ushort v239, v12, s[44:47], s68 offen
    s_add_u32 s68, s68, 53248
    s_mov_b64 exec, -1
    v_mfma_f32_16x16x32_bf16 v[16:19], v[124:127], v[200:203], v[16:19]
    ds_read_b128 v[88:91], v7 offset:0
    v_mfma_f32_16x16x32_bf16 v[20:23], v[124:127], v[204:207], v[20:23]
    v_mfma_f32_16x16x32_bf16 v[24:27], v[128:131], v[200:203], v[24:27]
    ds_read_b128 v[92:95], v7 offset:1024
    v_mfma_f32_16x16x32_bf16 v[28:31], v[128:131], v[204:207], v[28:31]
    v_mfma_f32_16x16x32_bf16 v[32:35], v[132:135], v[200:203], v[32:35]
    ds_read_b128 v[96:99], v7 offset:2048
    v_mfma_f32_16x16x32_bf16 v[36:39], v[132:135], v[204:207], v[36:39]
    v_mfma_f32_16x16x32_bf16 v[40:43], v[136:139], v[200:203], v[40:43]
    ds_read_b128 v[100:103], v7 offset:3072
    v_mfma_f32_16x16x32_bf16 v[44:47], v[136:139], v[204:207], v[44:47]
    v_mfma_f32_16x16x32_bf16 v[48:51], v[140:143], v[200:203], v[48:51]
    ds_read_b128 v[104:107], v7 offset:4096
    v_mfma_f32_16x16x32_bf16 v[52:55], v[140:143], v[204:207], v[52:55]
    v_mfma_f32_16x16x32_bf16 v[56:59], v[144:147], v[200:203], v[56:59]
    ds_read_b128 v[108:111], v7 offset:5120
    v_mfma_f32_16x16x32_bf16 v[60:63], v[144:147], v[204:207], v[60:63]
    v_mfma_f32_16x16x32_bf16 v[64:67], v[148:151], v[200:203], v[64:67]
    ds_read_b128 v[112:115], v7 offset:6144
    v_mfma_f32_16x16x32_bf16 v[68:71], v[148:151], v[204:207], v[68:71]
    v_mfma_f32_16x16x32_bf16 v[72:75], v[152:155], v[200:203], v[72:75]
    ds_read_b128 v[116:119], v7 offset:7168
    v_mfma_f32_16x16x32_bf16 v[76:79], v[152:155], v[204:207], v[76:79]
    v_mfma_f32_16x16x32_bf16 v[80:83], v[156:159], v[200:203], v[80:83]
    ds_read_b128 v[120:123], v7 offset:8192
    v_mfma_f32_16x16x32_bf16 v[84:87], v[156:159], v[204:207], v[84:87]
    s_waitcnt vmcnt(9)
    s_waitcnt lgkmcnt(8)
    v_mfma_f32_16x16x32_bf16 v[16:19], v[88:91], v[208:211], v[16:19]
    ds_read_b128 v[124:127], v7 offset:18432
    v_mfma_f32_16x16x32_bf16 v[20:23], v[88:91], v[212:215], v[20:23]
    s_waitcnt lgkmcnt(8)
    v_mfma_f32_16x16x32_bf16 v[24:27], v[92:95], v[208:211], v[24:27]
    ds_read_b128 v[128:131], v7 offset:19456
    v_mfma_f32_16x16x32_bf16 v[28:31], v[92:95], v[212:215], v[28:31]
    s_waitcnt lgkmcnt(8)
    v_mfma_f32_16x16x32_bf16 v[32:35], v[96:99], v[208:211], v[32:35]
    ds_read_b128 v[132:135], v7 offset:20480
    v_mfma_f32_16x16x32_bf16 v[36:39], v[96:99], v[212:215], v[36:39]
    s_waitcnt lgkmcnt(8)
    v_mfma_f32_16x16x32_bf16 v[40:43], v[100:103], v[208:211], v[40:43]
    ds_read_b128 v[136:139], v7 offset:21504
    v_mfma_f32_16x16x32_bf16 v[44:47], v[100:103], v[212:215], v[44:47]
    s_waitcnt lgkmcnt(8)
    v_mfma_f32_16x16x32_bf16 v[48:51], v[104:107], v[208:211], v[48:51]
    ds_read_b128 v[140:143], v7 offset:22528
    v_mfma_f32_16x16x32_bf16 v[52:55], v[104:107], v[212:215], v[52:55]
    s_waitcnt lgkmcnt(8)
    v_mfma_f32_16x16x32_bf16 v[56:59], v[108:111], v[208:211], v[56:59]
    ds_read_b128 v[144:147], v7 offset:23552
    v_mfma_f32_16x16x32_bf16 v[60:63], v[108:111], v[212:215], v[60:63]
    s_waitcnt lgkmcnt(8)
    v_mfma_f32_16x16x32_bf16 v[64:67], v[112:115], v[208:211], v[64:67]
    ds_read_b128 v[148:151], v7 offset:24576
    v_mfma_f32_16x16x32_bf16 v[68:71], v[112:115], v[212:215], v[68:71]
    s_waitcnt lgkmcnt(8)
    v_mfma_f32_16x16x32_bf16 v[72:75], v[116:119], v[208:211], v[72:75]
    ds_read_b128 v[152:155], v7 offset:25600
    v_mfma_f32_16x16x32_bf16 v[76:79], v[116:119], v[212:215], v[76:79]
    s_waitcnt lgkmcnt(8)
    v_mfma_f32_16x16x32_bf16 v[80:83], v[120:123], v[208:211], v[80:83]
    ds_read_b128 v[156:159], v7 offset:26624
    v_mfma_f32_16x16x32_bf16 v[84:87], v[120:123], v[212:215], v[84:87]
    s_waitcnt vmcnt(4) lgkmcnt(0)
    s_barrier
    s_mov_b64 exec, s[66:67]
    buffer_load_ushort v240, v12, s[44:47], s68 offen
    s_add_u32 s68, s68, 4096
    buffer_load_ushort v241, v12, s[44:47], s68 offen
    s_add_u32 s68, s68, 4096
    buffer_load_ushort v242, v12, s[44:47], s68 offen
    s_add_u32 s68, s68, 4096
    buffer_load_ushort v243, v12, s[44:47], s68 offen
    s_add_u32 s68, s68, 53248
    buffer_load_ushort v244, v12, s[44:47], s68 offen
    s_add_u32 s68, s68, 4096
    buffer_load_ushort v245, v12, s[44:47], s68 offen
    s_add_u32 s68, s68, 4096
    buffer_load_ushort v246, v12, s[44:47], s68 offen
    s_add_u32 s68, s68, 4096
    buffer_load_ushort v247, v12, s[44:47], s68 offen
    s_add_u32 s68, s68, 53248
    buffer_load_ushort v248, v12, s[44:47], s68 offen
    s_add_u32 s68, s68, 4096
    buffer_load_ushort v249, v12, s[44:47], s68 offen
    s_add_u32 s68, s68, 4096
    buffer_load_ushort v250, v12, s[44:47], s68 offen
    s_add_u32 s68, s68, 4096
    buffer_load_ushort v251, v12, s[44:47], s68 offen
    s_add_u32 s68, s68, 53248
    buffer_load_ushort v252, v12, s[44:47], s68 offen
    s_add_u32 s68, s68, 4096
    buffer_load_ushort v253, v12, s[44:47], s68 offen
    s_add_u32 s68, s68, 4096
    buffer_load_ushort v254, v12, s[44:47], s68 offen
    s_add_u32 s68, s68, 4096
    buffer_load_ushort v255, v12, s[44:47], s68 offen
    s_add_u32 s68, s68, 53248
    s_mov_b64 exec, -1
    v_mfma_f32_16x16x32_bf16 v[16:19], v[124:127], v[216:219], v[16:19]
    ds_read_b128 v[88:91], v4 offset:0
    v_mfma_f32_16x16x32_bf16 v[20:23], v[124:127], v[220:223], v[20:23]
    v_mfma_f32_16x16x32_bf16 v[24:27], v[128:131], v[216:219], v[24:27]
    ds_read_b128 v[92:95], v4 offset:1024
    v_mfma_f32_16x16x32_bf16 v[28:31], v[128:131], v[220:223], v[28:31]
    v_mfma_f32_16x16x32_bf16 v[32:35], v[132:135], v[216:219], v[32:35]
    ds_read_b128 v[96:99], v4 offset:2048
    v_mfma_f32_16x16x32_bf16 v[36:39], v[132:135], v[220:223], v[36:39]
    v_mfma_f32_16x16x32_bf16 v[40:43], v[136:139], v[216:219], v[40:43]
    ds_read_b128 v[100:103], v4 offset:3072
    v_mfma_f32_16x16x32_bf16 v[44:47], v[136:139], v[220:223], v[44:47]
    v_mfma_f32_16x16x32_bf16 v[48:51], v[140:143], v[216:219], v[48:51]
    ds_read_b128 v[104:107], v4 offset:4096
    v_mfma_f32_16x16x32_bf16 v[52:55], v[140:143], v[220:223], v[52:55]
    v_mfma_f32_16x16x32_bf16 v[56:59], v[144:147], v[216:219], v[56:59]
    ds_read_b128 v[108:111], v4 offset:5120
    v_mfma_f32_16x16x32_bf16 v[60:63], v[144:147], v[220:223], v[60:63]
    v_mfma_f32_16x16x32_bf16 v[64:67], v[148:151], v[216:219], v[64:67]
    ds_read_b128 v[112:115], v4 offset:6144
    v_mfma_f32_16x16x32_bf16 v[68:71], v[148:151], v[220:223], v[68:71]
    v_mfma_f32_16x16x32_bf16 v[72:75], v[152:155], v[216:219], v[72:75]
    ds_read_b128 v[116:119], v4 offset:7168
    v_mfma_f32_16x16x32_bf16 v[76:79], v[152:155], v[220:223], v[76:79]
    v_mfma_f32_16x16x32_bf16 v[80:83], v[156:159], v[216:219], v[80:83]
    ds_read_b128 v[120:123], v4 offset:8192
    v_mfma_f32_16x16x32_bf16 v[84:87], v[156:159], v[220:223], v[84:87]
    s_waitcnt vmcnt(0)
    s_waitcnt lgkmcnt(8)
    v_mfma_f32_16x16x32_bf16 v[16:19], v[88:91], v[160:163], v[16:19]
    ds_read_b128 v[124:127], v4 offset:18432
    v_mfma_f32_16x16x32_bf16 v[20:23], v[88:91], v[164:167], v[20:23]
    s_waitcnt lgkmcnt(8)
    v_mfma_f32_16x16x32_bf16 v[24:27], v[92:95], v[160:163], v[24:27]
    ds_read_b128 v[128:131], v4 offset:19456
    v_mfma_f32_16x16x32_bf16 v[28:31], v[92:95], v[164:167], v[28:31]
    s_waitcnt lgkmcnt(8)
    v_mfma_f32_16x16x32_bf16 v[32:35], v[96:99], v[160:163], v[32:35]
    ds_read_b128 v[132:135], v4 offset:20480
    v_mfma_f32_16x16x32_bf16 v[36:39], v[96:99], v[164:167], v[36:39]
    s_waitcnt lgkmcnt(8)
    v_mfma_f32_16x16x32_bf16 v[40:43], v[100:103], v[160:163], v[40:43]
    ds_read_b128 v[136:139], v4 offset:21504
    v_mfma_f32_16x16x32_bf16 v[44:47], v[100:103], v[164:167], v[44:47]
    s_waitcnt lgkmcnt(8)
    v_mfma_f32_16x16x32_bf16 v[48:51], v[104:107], v[160:163], v[48:51]
    ds_read_b128 v[140:143], v4 offset:22528
    v_mfma_f32_16x16x32_bf16 v[52:55], v[104:107], v[164:167], v[52:55]
    s_waitcnt lgkmcnt(8)
    v_mfma_f32_16x16x32_bf16 v[56:59], v[108:111], v[160:163], v[56:59]
    ds_read_b128 v[144:147], v4 offset:23552
    v_mfma_f32_16x16x32_bf16 v[60:63], v[108:111], v[164:167], v[60:63]
    s_waitcnt lgkmcnt(8)
    v_mfma_f32_16x16x32_bf16 v[64:67], v[112:115], v[160:163], v[64:67]
    ds_read_b128 v[148:151], v4 offset:24576
    v_mfma_f32_16x16x32_bf16 v[68:71], v[112:115], v[164:167], v[68:71]
    s_waitcnt lgkmcnt(8)
    v_mfma_f32_16x16x32_bf16 v[72:75], v[116:119], v[160:163], v[72:75]
    ds_read_b128 v[152:155], v4 offset:25600
    v_mfma_f32_16x16x32_bf16 v[76:79], v[116:119], v[164:167], v[76:79]
    s_waitcnt lgkmcnt(8)
    v_mfma_f32_16x16x32_bf16 v[80:83], v[120:123], v[160:163], v[80:83]
    ds_read_b128 v[156:159], v4 offset:26624
    v_mfma_f32_16x16x32_bf16 v[84:87], v[120:123], v[164:167], v[84:87]
    s_waitcnt lgkmcnt(0)
    s_barrier
    s_mov_b64 exec, s[66:67]
    buffer_load_dwordx4 v[176:179], v9, s[36:39], s61 offen offset:0
    buffer_load_dwordx4 v[180:183], v9, s[36:39], s61 offen offset:64
    buffer_load_dwordx4 v[184:187], v9, s[36:39], s61 offen offset:128
    buffer_load_dwordx4 v[188:191], v9, s[36:39], s61 offen offset:192
    buffer_load_dwordx4 v[192:195], v9, s[36:39], s61 offen offset:256
    buffer_load_dwordx4 v[196:199], v9, s[36:39], s61 offen offset:320
    buffer_load_dwordx4 v[200:203], v9, s[36:39], s61 offen offset:384
    buffer_load_dwordx4 v[204:207], v9, s[36:39], s61 offen offset:448
    buffer_load_dwordx4 v[208:211], v9, s[36:39], s61 offen offset:512
    buffer_load_ushort v212, v12, s[44:47], s68 offen
    s_add_u32 s68, s68, 4096
    buffer_load_ushort v213, v12, s[44:47], s68 offen
    s_add_u32 s68, s68, 4096
    buffer_load_ushort v214, v12, s[44:47], s68 offen
    s_add_u32 s68, s68, 4096
    buffer_load_ushort v215, v12, s[44:47], s68 offen
    s_add_u32 s68, s68, 4096
    s_mov_b64 exec, -1
    v_mfma_f32_16x16x32_bf16 v[16:19], v[124:127], v[168:171], v[16:19]
    v_mfma_f32_16x16x32_bf16 v[20:23], v[124:127], v[172:175], v[20:23]
    v_mfma_f32_16x16x32_bf16 v[24:27], v[128:131], v[168:171], v[24:27]
    v_mfma_f32_16x16x32_bf16 v[28:31], v[128:131], v[172:175], v[28:31]
    v_mfma_f32_16x16x32_bf16 v[32:35], v[132:135], v[168:171], v[32:35]
    v_mfma_f32_16x16x32_bf16 v[36:39], v[132:135], v[172:175], v[36:39]
    v_mfma_f32_16x16x32_bf16 v[40:43], v[136:139], v[168:171], v[40:43]
    v_mfma_f32_16x16x32_bf16 v[44:47], v[136:139], v[172:175], v[44:47]
    v_mfma_f32_16x16x32_bf16 v[48:51], v[140:143], v[168:171], v[48:51]
    v_mfma_f32_16x16x32_bf16 v[52:55], v[140:143], v[172:175], v[52:55]
    v_mfma_f32_16x16x32_bf16 v[56:59], v[144:147], v[168:171], v[56:59]
    v_mfma_f32_16x16x32_bf16 v[60:63], v[144:147], v[172:175], v[60:63]
    v_mfma_f32_16x16x32_bf16 v[64:67], v[148:151], v[168:171], v[64:67]
    v_mfma_f32_16x16x32_bf16 v[68:71], v[148:151], v[172:175], v[68:71]
    v_mfma_f32_16x16x32_bf16 v[72:75], v[152:155], v[168:171], v[72:75]
    v_mfma_f32_16x16x32_bf16 v[76:79], v[152:155], v[172:175], v[76:79]
    v_mfma_f32_16x16x32_bf16 v[80:83], v[156:159], v[168:171], v[80:83]
    v_mfma_f32_16x16x32_bf16 v[84:87], v[156:159], v[172:175], v[84:87]
    s_cmp_eq_u32 s22, 0
    s_cbranch_scc0 G2_K1
    ds_write_b128 v10, v[20:23] offset:0
    ds_write_b128 v10, v[28:31] offset:1024
    ds_write_b128 v10, v[36:39] offset:2048
    ds_write_b128 v10, v[44:47] offset:3072
    ds_write_b128 v10, v[52:55] offset:4096
    ds_write_b128 v10, v[60:63] offset:5120
    ds_write_b128 v10, v[68:71] offset:6144
    ds_write_b128 v10, v[76:79] offset:7168
    ds_write_b128 v10, v[84:87] offset:8192
    s_branch G2_KJ
G2_K1:
    ds_write_b128 v10, v[16:19] offset:0
    ds_write_b128 v10, v[24:27] offset:1024
    ds_write_b128 v10, v[32:35] offset:2048
    ds_write_b128 v10, v[40:43] offset:3072
    ds_write_b128 v10, v[48:51] offset:4096
    ds_write_b128 v10, v[56:59] offset:5120
    ds_write_b128 v10, v[64:67] offset:6144
    ds_write_b128 v10, v[72:75] offset:7168
    ds_write_b128 v10, v[80:83] offset:8192
    s_nop 1
    v_pk_mov_b32 v[16:17], v[20:21], v[20:21] op_sel:[0,1]
    v_pk_mov_b32 v[18:19], v[22:23], v[22:23] op_sel:[0,1]
    v_pk_mov_b32 v[24:25], v[28:29], v[28:29] op_sel:[0,1]
    v_pk_mov_b32 v[26:27], v[30:31], v[30:31] op_sel:[0,1]
    v_pk_mov_b32 v[32:33], v[36:37], v[36:37] op_sel:[0,1]
    v_pk_mov_b32 v[34:35], v[38:39], v[38:39] op_sel:[0,1]
    v_pk_mov_b32 v[40:41], v[44:45], v[44:45] op_sel:[0,1]
    v_pk_mov_b32 v[42:43], v[46:47], v[46:47] op_sel:[0,1]
    v_pk_mov_b32 v[48:49], v[52:53], v[52:53] op_sel:[0,1]
    v_pk_mov_b32 v[50:51], v[54:55], v[54:55] op_sel:[0,1]
    v_pk_mov_b32 v[56:57], v[60:61], v[60:61] op_sel:[0,1]
    v_pk_mov_b32 v[58:59], v[62:63], v[62:63] op_sel:[0,1]
    v_pk_mov_b32 v[64:65], v[68:69], v[68:69] op_sel:[0,1]
    v_pk_mov_b32 v[66:67], v[70:71], v[70:71] op_sel:[0,1]
    v_pk_mov_b32 v[72:73], v[76:77], v[76:77] op_sel:[0,1]
    v_pk_mov_b32 v[74:75], v[78:79], v[78:79] op_sel:[0,1]
    v_pk_mov_b32 v[80:81], v[84:85], v[84:85] op_sel:[0,1]
    v_pk_mov_b32 v[82:83], v[86:87], v[86:87] op_sel:[0,1]
G2_KJ:
    s_waitcnt lgkmcnt(0)
    s_barrier
    ds_read_b128 v[88:91], v11 offset:0
    ds_read_b128 v[92:95], v11 offset:1024
    ds_read_b128 v[96:99], v11 offset:2048
    ds_read_b128 v[100:103], v11 offset:3072
    ds_read_b128 v[104:107], v11 offset:4096
    ds_read_b128 v[108:111], v11 offset:5120
    ds_read_b128 v[112:115], v11 offset:6144
    ds_read_b128 v[116:119], v11 offset:7168
    ds_read_b128 v[120:123], v11 offset:8192
    s_cmp_eq_u32 s21, s5
    s_cbranch_scc1 G2_FIN
    s_sub_u32 s24, s5, s21
    s_sub_u32 s24, s24, 1
    s_and_b32 s24, s24, 3
    s_mul_i32 s24, s24, 4608
    s_add_u32 s62, s62, s24
    v_lshlrev_b32 v12, 3, v1
    s_waitcnt lgkmcnt(8)
    v_pk_add_f32 v[88:89], v[88:89], v[16:17]
    v_pk_add_f32 v[90:91], v[90:91], v[18:19]
    v_cvt_pk_bf16_f32 v124, v88, v89
    v_cvt_pk_bf16_f32 v125, v90, v91
    s_waitcnt lgkmcnt(7)
    v_pk_add_f32 v[92:93], v[92:93], v[24:25]
    v_pk_add_f32 v[94:95], v[94:95], v[26:27]
    v_cvt_pk_bf16_f32 v126, v92, v93
    v_cvt_pk_bf16_f32 v127, v94, v95
    buffer_store_dwordx4 v[124:127], v2, s[28:31], s62 offen offset:0 sc0 sc1
    s_waitcnt lgkmcnt(6)
    v_pk_add_f32 v[96:97], v[96:97], v[32:33]
    v_pk_add_f32 v[98:99], v[98:99], v[34:35]
    v_cvt_pk_bf16_f32 v128, v96, v97
    v_cvt_pk_bf16_f32 v129, v98, v99
    s_waitcnt lgkmcnt(5)
    v_pk_add_f32 v[100:101], v[100:101], v[40:41]
    v_pk_add_f32 v[102:103], v[102:103], v[42:43]
    v_cvt_pk_bf16_f32 v130, v100, v101
    v_cvt_pk_bf16_f32 v131, v102, v103
    buffer_store_dwordx4 v[128:131], v2, s[28:31], s62 offen offset:1024 sc0 sc1
    s_waitcnt lgkmcnt(4)
    v_pk_add_f32 v[104:105], v[104:105], v[48:49]
    v_pk_add_f32 v[106:107], v[106:107], v[50:51]
    v_cvt_pk_bf16_f32 v132, v104, v105
    v_cvt_pk_bf16_f32 v133, v106, v107
    s_waitcnt lgkmcnt(3)
    v_pk_add_f32 v[108:109], v[108:109], v[56:57]
    v_pk_add_f32 v[110:111], v[110:111], v[58:59]
    v_cvt_pk_bf16_f32 v134, v108, v109
    v_cvt_pk_bf16_f32 v135, v110, v111
    buffer_store_dwordx4 v[132:135], v2, s[28:31], s62 offen offset:2048 sc0 sc1
    s_waitcnt lgkmcnt(2)
    v_pk_add_f32 v[112:113], v[112:113], v[64:65]
    v_pk_add_f32 v[114:115], v[114:115], v[66:67]
    v_cvt_pk_bf16_f32 v136, v112, v113
    v_cvt_pk_bf16_f32 v137, v114, v115
    s_waitcnt lgkmcnt(1)
    v_pk_add_f32 v[116:117], v[116:117], v[72:73]
    v_pk_add_f32 v[118:119], v[118:119], v[74:75]
    v_cvt_pk_bf16_f32 v138, v116, v117
    v_cvt_pk_bf16_f32 v139, v118, v119
    buffer_store_dwordx4 v[136:139], v2, s[28:31], s62 offen offset:3072 sc0 sc1
    s_waitcnt lgkmcnt(0)
    v_pk_add_f32 v[120:121], v[120:121], v[80:81]
    v_pk_add_f32 v[122:123], v[122:123], v[82:83]
    v_cvt_pk_bf16_f32 v140, v120, v121
    v_cvt_pk_bf16_f32 v141, v122, v123
    s_add_u32 s62, s62, 4096
    buffer_store_dwordx2 v[140:141], v12, s[28:31], s62 offen sc0 sc1
    s_endpgm
G2_FIN:
    v_lshlrev_b32 v12, 3, v1
    s_add_u32 s63, s62, 4096
    s_add_u32 s64, s62, 9216
    s_add_u32 s65, s62, 4608
    s_add_u32 s70, s65, 4096
    s_add_u32 s71, s64, 4096
    s_mov_b32 s57, 0
    s_waitcnt lgkmcnt(8)
    v_pk_add_f32 v[16:17], v[88:89], v[16:17]
    v_pk_add_f32 v[18:19], v[90:91], v[18:19]
    s_waitcnt lgkmcnt(7)
    v_pk_add_f32 v[24:25], v[92:93], v[24:25]
    v_pk_add_f32 v[26:27], v[94:95], v[26:27]
    s_waitcnt lgkmcnt(6)
    v_pk_add_f32 v[32:33], v[96:97], v[32:33]
    v_pk_add_f32 v[34:35], v[98:99], v[34:35]
    s_waitcnt lgkmcnt(5)
    v_pk_add_f32 v[40:41], v[100:101], v[40:41]
    v_pk_add_f32 v[42:43], v[102:103], v[42:43]
    s_waitcnt lgkmcnt(4)
    v_pk_add_f32 v[48:49], v[104:105], v[48:49]
    v_pk_add_f32 v[50:51], v[106:107], v[50:51]
    s_waitcnt lgkmcnt(3)
    v_pk_add_f32 v[56:57], v[108:109], v[56:57]
    v_pk_add_f32 v[58:59], v[110:111], v[58:59]
    s_waitcnt lgkmcnt(2)
    v_pk_add_f32 v[64:65], v[112:113], v[64:65]
    v_pk_add_f32 v[66:67], v[114:115], v[66:67]
    s_waitcnt lgkmcnt(1)
    v_pk_add_f32 v[72:73], v[116:117], v[72:73]
    v_pk_add_f32 v[74:75], v[118:119], v[74:75]
    s_waitcnt lgkmcnt(0)
    v_pk_add_f32 v[80:81], v[120:121], v[80:81]
    v_pk_add_f32 v[82:83], v[122:123], v[82:83]
G2_SPIN:
    buffer_load_dwordx4 v[124:127], v2, s[28:31], s62 offen offset:0 sc0 sc1
    buffer_load_dwordx4 v[128:131], v2, s[28:31], s62 offen offset:1024 sc0 sc1
    buffer_load_dwordx4 v[132:135], v2, s[28:31], s62 offen offset:2048 sc0 sc1
    buffer_load_dwordx4 v[136:139], v2, s[28:31], s62 offen offset:3072 sc0 sc1
    buffer_load_dwordx4 v[142:145], v2, s[28:31], s65 offen offset:0 sc0 sc1
    buffer_load_dwordx4 v[146:149], v2, s[28:31], s65 offen offset:1024 sc0 sc1
    buffer_load_dwordx4 v[150:153], v2, s[28:31], s65 offen offset:2048 sc0 sc1
    buffer_load_dwordx4 v[154:157], v2, s[28:31], s65 offen offset:3072 sc0 sc1
    buffer_load_dwordx4 v[88:91], v2, s[28:31], s64 offen offset:0 sc0 sc1
    buffer_load_dwordx4 v[92:95], v2, s[28:31], s64 offen offset:1024 sc0 sc1
    buffer_load_dwordx4 v[96:99], v2, s[28:31], s64 offen offset:2048 sc0 sc1
    buffer_load_dwordx4 v[100:103], v2, s[28:31], s64 offen offset:3072 sc0 sc1
    buffer_load_dwordx2 v[140:141], v12, s[28:31], s63 offen sc0 sc1
    buffer_load_dwordx2 v[158:159], v12, s[28:31], s70 offen sc0 sc1
    buffer_load_dwordx2 v[104:105], v12, s[28:31], s71 offen sc0 sc1
    v_mov_b32 v14, 0
    s_waitcnt vmcnt(11)
    v_max3_u32 v14, v14, v124, v125
    v_max3_u32 v14, v14, v126, v127
    v_max3_u32 v14, v14, v128, v129
    v_max3_u32 v14, v14, v130, v131
    v_max3_u32 v14, v14, v132, v133
    v_max3_u32 v14, v14, v134, v135
    v_max3_u32 v14, v14, v136, v137
    v_max3_u32 v14, v14, v138, v139
    s_waitcnt vmcnt(7)
    v_max3_u32 v14, v14, v142, v143
    v_max3_u32 v14, v14, v144, v145
    v_max3_u32 v14, v14, v146, v147
    v_max3_u32 v14, v14, v148, v149
    v_max3_u32 v14, v14, v150, v151
    v_max3_u32 v14, v14, v152, v153
    v_max3_u32 v14, v14, v154, v155
    v_max3_u32 v14, v14, v156, v157
    s_waitcnt vmcnt(3)
    v_max3_u32 v14, v14, v88, v89
    v_max3_u32 v14, v14, v90, v91
    v_max3_u32 v14, v14, v92, v93
    v_max3_u32 v14, v14, v94, v95
    v_max3_u32 v14, v14, v96, v97
    v_max3_u32 v14, v14, v98, v99
    v_max3_u32 v14, v14, v100, v101
    v_max3_u32 v14, v14, v102, v103
    s_waitcnt vmcnt(0)
    v_max3_u32 v14, v14, v140, v141
    v_max3_u32 v14, v14, v158, v159
    v_max3_u32 v14, v14, v104, v105
    v_cmp_eq_u32 vcc, -1, v14
    s_nop 0
    s_cmp_eq_u64 vcc, 0
    s_cbranch_scc1 G2_OK2
    s_add_u32 s57, s57, 1
    s_cmp_lt_u32 s57, 20000
    s_cbranch_scc1 G2_SPIN
G2_OK2:
    v_mov_b32 v10, 0x3f80
    v_mov_b32 v11, 0x3f800000
    v_dot2_f32_bf16 v16, v124, v10, v16
    v_dot2_f32_bf16 v17, v124, v11, v17
    v_dot2_f32_bf16 v18, v125, v10, v18
    v_dot2_f32_bf16 v19, v125, v11, v19
    v_dot2_f32_bf16 v16, v142, v10, v16
    v_dot2_f32_bf16 v17, v142, v11, v17
    v_dot2_f32_bf16 v18, v143, v10, v18
    v_dot2_f32_bf16 v19, v143, v11, v19
    v_dot2_f32_bf16 v16, v88, v10, v16
    v_dot2_f32_bf16 v17, v88, v11, v17
    v_dot2_f32_bf16 v18, v89, v10, v18
    v_dot2_f32_bf16 v19, v89, v11, v19
    v_lshlrev_b32 v12, 16, v224
    v_lshlrev_b32 v13, 16, v225
    v_lshlrev_b32 v14, 16, v226
    v_lshlrev_b32 v15, 16, v227
    v_pk_fma_f32 v[12:13], v[16:17], v[176:177], v[12:13]
    v_pk_fma_f32 v[14:15], v[18:19], v[178:179], v[14:15]
    v_cvt_pk_bf16_f32 v20, v12, v13
    v_cvt_pk_bf16_f32 v21, v14, v15
    buffer_store_dwordx2 v[20:21], v8, s[40:43], s60 offen offset:0
    v_dot2_f32_bf16 v24, v126, v10, v24
    v_dot2_f32_bf16 v25, v126, v11, v25
    v_dot2_f32_bf16 v26, v127, v10, v26
    v_dot2_f32_bf16 v27, v127, v11, v27
    v_dot2_f32_bf16 v24, v144, v10, v24
    v_dot2_f32_bf16 v25, v144, v11, v25
    v_dot2_f32_bf16 v26, v145, v10, v26
    v_dot2_f32_bf16 v27, v145, v11, v27
    v_dot2_f32_bf16 v24, v90, v10, v24
    v_dot2_f32_bf16 v25, v90, v11, v25
    v_dot2_f32_bf16 v26, v91, v10, v26
    v_dot2_f32_bf16 v27, v91, v11, v27
    v_lshlrev_b32 v12, 16, v228
    v_lshlrev_b32 v13, 16, v229
    v_lshlrev_b32 v14, 16, v230
    v_lshlrev_b32 v15, 16, v231
    v_pk_fma_f32 v[12:13], v[24:25], v[180:181], v[12:13]
    v_pk_fma_f32 v[14:15], v[26:27], v[182:183], v[14:15]
    v_cvt_pk_bf16_f32 v28, v12, v13
    v_cvt_pk_bf16_f32 v29, v14, v15
    buffer_store_dwordx2 v[28:29], v8, s[40:43], s60 offen offset:32
    v_dot2_f32_bf16 v32, v128, v10, v32
    v_dot2_f32_bf16 v33, v128, v11, v33
    v_dot2_f32_bf16 v34, v129, v10, v34
    v_dot2_f32_bf16 v35, v129, v11, v35
    v_dot2_f32_bf16 v32, v146, v10, v32
    v_dot2_f32_bf16 v33, v146, v11, v33
    v_dot2_f32_bf16 v34, v147, v10, v34
    v_dot2_f32_bf16 v35, v147, v11, v35
    v_dot2_f32_bf16 v32, v92, v10, v32
    v_dot2_f32_bf16 v33, v92, v11, v33
    v_dot2_f32_bf16 v34, v93, v10, v34
    v_dot2_f32_bf16 v35, v93, v11, v35
    v_lshlrev_b32 v12, 16, v232
    v_lshlrev_b32 v13, 16, v233
    v_lshlrev_b32 v14, 16, v234
    v_lshlrev_b32 v15, 16, v235
    v_pk_fma_f32 v[12:13], v[32:33], v[184:185], v[12:13]
    v_pk_fma_f32 v[14:15], v[34:35], v[186:187], v[14:15]
    v_cvt_pk_bf16_f32 v36, v12, v13
    v_cvt_pk_bf16_f32 v37, v14, v15
    buffer_store_dwordx2 v[36:37], v8, s[40:43], s60 offen offset:64
    v_dot2_f32_bf16 v40, v130, v10, v40
    v_dot2_f32_bf16 v41, v130, v11, v41
    v_dot2_f32_bf16 v42, v131, v10, v42
    v_dot2_f32_bf16 v43, v131, v11, v43
    v_dot2_f32_bf16 v40, v148, v10, v40
    v_dot2_f32_bf16 v41, v148, v11, v41
    v_dot2_f32_bf16 v42, v149, v10, v42
    v_dot2_f32_bf16 v43, v149, v11, v43
    v_dot2_f32_bf16 v40, v94, v10, v40
    v_dot2_f32_bf16 v41, v94, v11, v41
    v_dot2_f32_bf16 v42, v95, v10, v42
    v_dot2_f32_bf16 v43, v95, v11, v43
    v_lshlrev_b32 v12, 16, v236
    v_lshlrev_b32 v13, 16, v237
    v_lshlrev_b32 v14, 16, v238
    v_lshlrev_b32 v15, 16, v239
    v_pk_fma_f32 v[12:13], v[40:41], v[188:189], v[12:13]
    v_pk_fma_f32 v[14:15], v[42:43], v[190:191], v[14:15]
    v_cvt_pk_bf16_f32 v44, v12, v13
    v_cvt_pk_bf16_f32 v45, v14, v15
    buffer_store_dwordx2 v[44:45], v8, s[40:43], s60 offen offset:96
    v_dot2_f32_bf16 v48, v132, v10, v48
    v_dot2_f32_bf16 v49, v132, v11, v49
    v_dot2_f32_bf16 v50, v133, v10, v50
    v_dot2_f32_bf16 v51, v133, v11, v51
    v_dot2_f32_bf16 v48, v150, v10, v48
    v_dot2_f32_bf16 v49, v150, v11, v49
    v_dot2_f32_bf16 v50, v151, v10, v50
    v_dot2_f32_bf16 v51, v151, v11, v51
    v_dot2_f32_bf16 v48, v96, v10, v48
    v_dot2_f32_bf16 v49, v96, v11, v49
    v_dot2_f32_bf16 v50, v97, v10, v50
    v_dot2_f32_bf16 v51, v97, v11, v51
    v_lshlrev_b32 v12, 16, v240
    v_lshlrev_b32 v13, 16, v241
    v_lshlrev_b32 v14, 16, v242
    v_lshlrev_b32 v15, 16, v243
    v_pk_fma_f32 v[12:13], v[48:49], v[192:193], v[12:13]
    v_pk_fma_f32 v[14:15], v[50:51], v[194:195], v[14:15]
    v_cvt_pk_bf16_f32 v52, v12, v13
    v_cvt_pk_bf16_f32 v53, v14, v15
    buffer_store_dwordx2 v[52:53], v8, s[40:43], s60 offen offset:128
    v_dot2_f32_bf16 v56, v134, v10, v56
    v_dot2_f32_bf16 v57, v134, v11, v57
    v_dot2_f32_bf16 v58, v135, v10, v58
    v_dot2_f32_bf16 v59, v135, v11, v59
    v_dot2_f32_bf16 v56, v152, v10, v56
    v_dot2_f32_bf16 v57, v152, v11, v57
    v_dot2_f32_bf16 v58, v153, v10, v58
    v_dot2_f32_bf16 v59, v153, v11, v59
    v_dot2_f32_bf16 v56, v98, v10, v56
    v_dot2_f32_bf16 v57, v98, v11, v57
    v_dot2_f32_bf16 v58, v99, v10, v58
    v_dot2_f32_bf16 v59, v99, v11, v59
    v_lshlrev_b32 v12, 16, v244
    v_lshlrev_b32 v13, 16, v245
    v_lshlrev_b32 v14, 16, v246
    v_lshlrev_b32 v15, 16, v247
    v_pk_fma_f32 v[12:13], v[56:57], v[196:197], v[12:13]
    v_pk_fma_f32 v[14:15], v[58:59], v[198:199], v[14:15]
    v_cvt_pk_bf16_f32 v60, v12, v13
    v_cvt_pk_bf16_f32 v61, v14, v15
    buffer_store_dwordx2 v[60:61], v8, s[40:43], s60 offen offset:160
    v_dot2_f32_bf16 v64, v136, v10, v64
    v_dot2_f32_bf16 v65, v136, v11, v65
    v_dot2_f32_bf16 v66, v137, v10, v66
    v_dot2_f32_bf16 v67, v137, v11, v67
    v_dot2_f32_bf16 v64, v154, v10, v64
    v_dot2_f32_bf16 v65, v154, v11, v65
    v_dot2_f32_bf16 v66, v155, v10, v66
    v_dot2_f32_bf16 v67, v155, v11, v67
    v_dot2_f32_bf16 v64, v100, v10, v64
    v_dot2_f32_bf16 v65, v100, v11, v65
    v_dot2_f32_bf16 v66, v101, v10, v66
    v_dot2_f32_bf16 v67, v101, v11, v67
    v_lshlrev_b32 v12, 16, v248
    v_lshlrev_b32 v13, 16, v249
    v_lshlrev_b32 v14, 16, v250
    v_lshlrev_b32 v15, 16, v251
    v_pk_fma_f32 v[12:13], v[64:65], v[200:201], v[12:13]
    v_pk_fma_f32 v[14:15], v[66:67], v[202:203], v[14:15]
    v_cvt_pk_bf16_f32 v68, v12, v13
    v_cvt_pk_bf16_f32 v69, v14, v15
    buffer_store_dwordx2 v[68:69], v8, s[40:43], s60 offen offset:192
    v_dot2_f32_bf16 v72, v138, v10, v72
    v_dot2_f32_bf16 v73, v138, v11, v73
    v_dot2_f32_bf16 v74, v139, v10, v74
    v_dot2_f32_bf16 v75, v139, v11, v75
    v_dot2_f32_bf16 v72, v156, v10, v72
    v_dot2_f32_bf16 v73, v156, v11, v73
    v_dot2_f32_bf16 v74, v157, v10, v74
    v_dot2_f32_bf16 v75, v157, v11, v75
    v_dot2_f32_bf16 v72, v102, v10, v72
    v_dot2_f32_bf16 v73, v102, v11, v73
    v_dot2_f32_bf16 v74, v103, v10, v74
    v_dot2_f32_bf16 v75, v103, v11, v75
    v_lshlrev_b32 v12, 16, v252
    v_lshlrev_b32 v13, 16, v253
    v_lshlrev_b32 v14, 16, v254
    v_lshlrev_b32 v15, 16, v255
    v_pk_fma_f32 v[12:13], v[72:73], v[204:205], v[12:13]
    v_pk_fma_f32 v[14:15], v[74:75], v[206:207], v[14:15]
    v_cvt_pk_bf16_f32 v76, v12, v13
    v_cvt_pk_bf16_f32 v77, v14, v15
    buffer_store_dwordx2 v[76:77], v8, s[40:43], s60 offen offset:224
    v_dot2_f32_bf16 v80, v140, v10, v80
    v_dot2_f32_bf16 v81, v140, v11, v81
    v_dot2_f32_bf16 v82, v141, v10, v82
    v_dot2_f32_bf16 v83, v141, v11, v83
    v_dot2_f32_bf16 v80, v158, v10, v80
    v_dot2_f32_bf16 v81, v158, v11, v81
    v_dot2_f32_bf16 v82, v159, v10, v82
    v_dot2_f32_bf16 v83, v159, v11, v83
    v_dot2_f32_bf16 v80, v104, v10, v80
    v_dot2_f32_bf16 v81, v104, v11, v81
    v_dot2_f32_bf16 v82, v105, v10, v82
    v_dot2_f32_bf16 v83, v105, v11, v83
    v_lshlrev_b32 v12, 16, v212
    v_lshlrev_b32 v13, 16, v213
    v_lshlrev_b32 v14, 16, v214
    v_lshlrev_b32 v15, 16, v215
    v_pk_fma_f32 v[12:13], v[80:81], v[208:209], v[12:13]
    v_pk_fma_f32 v[14:15], v[82:83], v[210:211], v[14:15]
    v_cvt_pk_bf16_f32 v84, v12, v13
    v_cvt_pk_bf16_f32 v85, v14, v15
    buffer_store_dwordx2 v[84:85], v8, s[40:43], s60 offen offset:256
G1_END:
    s_endpgm
.section .rodata,"a"
.p2align 6
.amdhsa_kernel p1_kernel
  .amdhsa_next_free_vgpr 208
  .amdhsa_next_free_sgpr 102
  .amdhsa_accum_offset 208
  .amdhsa_group_segment_fixed_size 0
  .amdhsa_kernarg_size 144
  .amdhsa_user_sgpr_count 2
  .amdhsa_user_sgpr_kernarg_segment_ptr 1
  .amdhsa_system_sgpr_workgroup_id_x 1
  .amdhsa_float_denorm_mode_32 3
.end_amdhsa_kernel
.p2align 6
.amdhsa_kernel p2_kernel
  .amdhsa_next_free_vgpr 192
  .amdhsa_next_free_sgpr 102
  .amdhsa_accum_offset 192
  .amdhsa_group_segment_fixed_size 0
  .amdhsa_kernarg_size 144
  .amdhsa_user_sgpr_count 2
  .amdhsa_user_sgpr_kernarg_segment_ptr 1
  .amdhsa_system_sgpr_workgroup_id_x 1
  .amdhsa_float_denorm_mode_32 3
.end_amdhsa_kernel
.p2align 6
.amdhsa_kernel gg_kernel
  .amdhsa_next_free_vgpr 256
  .amdhsa_next_free_sgpr 102
  .amdhsa_accum_offset 256
  .amdhsa_group_segment_fixed_size 0
  .amdhsa_kernarg_size 144
  .amdhsa_user_sgpr_count 2
  .amdhsa_user_sgpr_kernarg_segment_ptr 1
  .amdhsa_system_sgpr_workgroup_id_x 1
  .amdhsa_float_denorm_mode_32 3
.end_amdhsa_kernel
```
